```python
import torch

def _softmax(x, axis=-1):
    return torch.softmax(x, dim=axis)
def _gelu(x):
    return torch.nn.functional.gelu(x, approximate="tanh")
def _silu(x):
    return torch.nn.functional.silu(x)
def _sigmoid(x):
    return torch.sigmoid(x)
def _layernorm(x, axis=-1, eps=1e-5):
    m = x.mean(dim=axis, keepdim=True)
    v = x.var(dim=axis, keepdim=True, unbiased=False)
    return (x - m) / torch.sqrt(v + eps)
def _scatter_add(tgt, idx, src, axis=0):
    return tgt.clone().index_add_(axis, idx, src)
def _segment_sum(src, seg, n):
    out = torch.zeros((n,) + src.shape[1:], dtype=src.dtype)
    return out.index_add_(0, seg, src)
def _pad(x, pw):
    flat = tuple(v for pair in reversed(pw) for v in pair)
    return torch.nn.functional.pad(x, flat)

kernel_name = 'interleave_layers__linear_attn_block__glu_gated_swiglu__prompt'

def setup_inputs():

    _w = (lambda a: (lambda t: t.to(torch.bfloat16) if t.is_floating_point() else t)(torch.as_tensor(a)))
    def _A_setup():
        B, S, D = 1, 2048, 448
        return {
            "x": _w((lambda *s: torch.randn(*s, dtype=torch.bfloat16) * 0.05)(B, S, D)),
            "wqkv": _w((lambda *s: torch.randn(*s, dtype=torch.bfloat16) * 0.05)(D, 3 * D)),
            "wo": _w((lambda *s: torch.randn(*s, dtype=torch.bfloat16) * 0.05)(D, D)),
        }
    _A_in = _A_setup()

    def _B_setup():
        B, S, D, F = 1, 2048, 448, 1792
        return {
            "x": _w((lambda *s: torch.randn(*s, dtype=torch.bfloat16) * 0.05)(B, S, D)),
            "w1": _w((lambda *s: torch.randn(*s, dtype=torch.bfloat16) * 0.4)(D, F) * (2.0 / D) ** 0.5),
            "w3": _w((lambda *s: torch.randn(*s, dtype=torch.bfloat16) * 0.4)(D, F) * (2.0 / D) ** 0.5),
            "w2": _w((lambda *s: torch.randn(*s, dtype=torch.bfloat16) * 0.4)(F, D) * (2.0 / F) ** 0.5),
        }
    _B_in = _B_setup()

    return {
        "A_x": _A_in["x"],
        "A_wqkv": _A_in["wqkv"],
        "A_wo": _A_in["wo"],
        "B_x": _B_in["x"],
        "B_w1": _B_in["w1"],
        "B_w3": _B_in["w3"],
        "B_w2": _B_in["w2"],
    }

def reference(A_x, A_wqkv, A_wo, B_x, B_w1, B_w3, B_w2):
    def _A_ref(x, wqkv, wo):
        B, S, D = x.shape
        H = 16; Dh = D // H
        qkv = (lambda x, *d: x.permute(*d))((x @ wqkv).reshape(B, S, 3, H, Dh), 2, 0, 3, 1, 4)
        q, k, v = qkv[0], qkv[1], qkv[2]
        phi = lambda t: torch.where(t > 0, t + 1, torch.exp(t)) + 1e-6
        pq, pk = phi(q), phi(k)
        kv = torch.einsum("bhsd,bhse->bhde", pk, v)
        z = torch.einsum("bhsd->bhd", pk)
        num = torch.einsum("bhqd,bhde->bhqe", pq, kv)
        den = torch.einsum("bhqd,bhd->bhq", pq, z)[..., None] + 1e-6
        o = num / den
        return (lambda x, *d: x.permute(*d))(o, 0, 2, 1, 3).reshape(B, S, D) @ wo

    def _B_ref(x, w1, w3, w2):
        gate = torch.einsum("bsd,df->bsf", x, w1)
        up = torch.einsum("bsd,df->bsf", x, w3)
        h = _silu(gate) * up
        out = torch.einsum("bsf,fd->bsd", h, w2)
        return out

    x = A_x
    x = x + _A_ref(_layernorm(x, axis=-1), A_wqkv, A_wo)
    x = x + _B_ref(_layernorm(x, axis=-1), B_w1, B_w3, B_w2)
    x = x + _A_ref(_layernorm(x, axis=-1), A_wqkv, A_wo)
    x = x + _B_ref(_layernorm(x, axis=-1), B_w1, B_w3, B_w2)
    return x
```

```asm
; @launch kernel=k0_kernel grid=(256,1,1) block=(704,1,1) lds=0
; @launch kernel=interleave_layers__linear_attn_block__glu_gated_swiglu__prompt_kernel grid=(256,1,1) block=(256,1,1) lds=163840
.amdgcn_target "amdgcn-amd-amdhsa--gfx950"
.text
.globl k0_kernel
.p2align 8
.type k0_kernel,@function
k0_kernel:
    s_load_dwordx16 s[32:47], s[0:1], 0
    s_load_dwordx2 s[50:51], s[0:1], 72
    s_getpc_b64 s[68:69]
k0_pc:
    s_cmp_ge_u32 s2, 256
    s_cbranch_scc1 k0_end
    v_lshrrev_b32 v1, 6, v0
    v_and_b32 v0, 63, v0
    v_lshlrev_b32 v27, 7, v0
    v_readfirstlane_b32 s3, v1
    s_lshr_b32 s53, s2, 3
    s_cmp_lg_u32 s3, 4
    s_cbranch_scc1 k0_nopf
    s_lshl_b32 s52, s53, 11
    v_add_u32 v26, s52, v27
    v_cmp_gt_u32 vcc, 32, v0
    s_nop 1
    v_cndmask_b32 v26, v26, v27, vcc
    v_min_u32 v26, code_end-k0_pc-8, v26
    s_mov_b32 exec_hi, 0xffff
    global_load_dword v31, v26, s[68:69]
    s_mov_b64 exec, -1
k0_nopf:
    s_and_b32 s54, s2, 7
    s_lshl_b32 s54, s54, 5
    s_add_u32 s54, s54, s53
    s_lshl_b32 s52, s3, 8
    s_add_u32 s54, s54, s52
    s_mov_b32 s58, 0
    s_cmp_ge_u32 s54, 196
    s_cselect_b32 s58, 196, s58
    s_cmp_ge_u32 s54, 392
    s_cselect_b32 s58, 392, s58
    s_cmp_ge_u32 s54, 539
    s_cselect_b32 s58, 539, s58
    s_cmp_ge_u32 s54, 735
    s_cselect_b32 s58, 735, s58
    s_cmp_ge_u32 s54, 959
    s_cselect_b32 s58, 959, s58
    s_sub_u32 s58, s54, s58
    s_lshl_b32 s58, s58, 13
    v_add_u32 v27, s58, v27
    s_waitcnt lgkmcnt(0)
    s_cmp_ge_u32 s54, 1008
    s_cbranch_scc1 k0_noearly
    s_mov_b64 s[56:57], s[40:41]
    s_cmp_ge_u32 s54, 196
    s_cselect_b64 s[56:57], s[42:43], s[56:57]
    s_cmp_ge_u32 s54, 392
    s_cselect_b64 s[56:57], s[34:35], s[56:57]
    s_cmp_ge_u32 s54, 539
    s_cselect_b64 s[56:57], s[44:45], s[56:57]
    s_cmp_ge_u32 s54, 735
    s_cselect_b64 s[56:57], s[32:33], s[56:57]
    s_cmp_ge_u32 s54, 959
    s_cselect_b64 s[56:57], s[36:37], s[56:57]
    global_load_dword v23, v27, s[56:57]
k0_noearly:
    v_lshlrev_b32 v1, 4, v0
    v_and_b32 v2, 15, v0
    v_lshrrev_b32 v3, 4, v0
    s_mov_b32 s8, s50
    s_and_b32 s9, s51, 0xffff
    s_mov_b32 s10, 0x2400000
    s_mov_b32 s11, 0x00020000
    s_getreg_b32 s4, hwreg(HW_REG_XCC_ID)
    s_and_b32 s4, s4, 7
    s_lshr_b32 s52, s2, 3
    s_cmp_ge_u32 s3, 8
    s_cbranch_scc1 k0_nopt
    s_lshl_b32 s55, s4, 5
    s_add_u32 s52, s52, s55
    s_lshl_b32 s52, s52, 3
    s_add_u32 s52, s52, s3
    s_mul_i32 s55, s52, 3584
    s_add_u32 s55, s55, 12058624
    s_mul_i32 s56, s52, 896
    s_add_u32 s56, s56, 8384512
    v_lshlrev_b32 v26, 7, v0
    v_add_u32 v27, s55, v26
    v_add_u32 v28, s56, v26
    v_mov_b32 v29, 0x7ffffff0
    v_cmp_gt_u32 vcc, 0, v0
    s_nop 1
    v_cndmask_b32 v27, v29, v27, vcc
    v_cmp_gt_u32 vcc, 39, v0
    s_nop 1
    v_cndmask_b32 v28, v29, v28, vcc
    v_cmp_gt_u32 vcc, 32, v0
    s_nop 1
    v_cndmask_b32 v27, v28, v27, vcc
    buffer_load_dword v21, v27, s[8:11], 0 offen
k0_nopt:
    s_cmp_lt_u32 s54, 448
    s_cbranch_scc1 A_w13
    s_cmp_lt_u32 s54, 840
    s_cbranch_scc1 A_w2
    s_cmp_lt_u32 s54, 938
    s_cbranch_scc1 A_wo
    s_cmp_lt_u32 s54, 944
    s_cbranch_scc1 k0_end
    s_cmp_lt_u32 s54, 1616
    s_cbranch_scc1 A_q
    s_cmp_lt_u32 s54, 2512
    s_cbranch_scc1 A_x
    s_sub_u32 s55, s54, 2512
    s_cmp_ge_u32 s55, 36
    s_cbranch_scc1 A_sent
    v_mov_b32 v32, 0
    v_mov_b32 v33, 0
    v_mov_b32 v34, 0
    v_mov_b32 v35, 0
    s_lshl_b32 s52, s55, 10
    s_add_u32 s52, s52, 5767168
    buffer_store_dwordx4 v[32:35], v1, s[8:11], s52 offen sc1
    s_endpgm
A_sent:
    s_cmp_ge_u32 s55, 164
    s_cbranch_scc1 k0_end
    v_mov_b32 v32, -1
    v_mov_b32 v33, -1
    v_mov_b32 v34, -1
    v_mov_b32 v35, -1
    s_sub_u32 s55, s55, 36
    s_lshl_b32 s52, s55, 13
    s_add_u32 s52, s52, 6291456
    s_add_u32 s55, s52, 4096
    buffer_store_dwordx4 v[32:35], v1, s[8:11], s52 offen offset:0 sc1
    buffer_store_dwordx4 v[32:35], v1, s[8:11], s52 offen offset:1024 sc1
    buffer_store_dwordx4 v[32:35], v1, s[8:11], s52 offen offset:2048 sc1
    buffer_store_dwordx4 v[32:35], v1, s[8:11], s52 offen offset:3072 sc1
    buffer_store_dwordx4 v[32:35], v1, s[8:11], s55 offen offset:0 sc1
    buffer_store_dwordx4 v[32:35], v1, s[8:11], s55 offen offset:1024 sc1
    buffer_store_dwordx4 v[32:35], v1, s[8:11], s55 offen offset:2048 sc1
    buffer_store_dwordx4 v[32:35], v1, s[8:11], s55 offen offset:3072 sc1
    s_endpgm
A_x:
    s_sub_u32 s55, s54, 1616
    s_mul_i32 s56, s55, 9363
    s_lshr_b32 s56, s56, 16
    s_mul_i32 s52, s56, 7
    s_sub_u32 s55, s55, s52
    s_mov_b32 s60, s32
    s_and_b32 s61, s33, 0xffff
    s_mov_b32 s62, 0x1c0000
    s_mov_b32 s63, 0x00020000
    v_mul_u32_u24 v24, 896, v2
    v_lshl_add_u32 v24, v3, 4, v24
    s_mul_i32 s57, s56, 14336
    s_lshl_b32 s52, s55, 7
    s_add_u32 s57, s57, s52
    buffer_load_dwordx4 v[32:35], v24, s[60:63], s57 offen offset:0
    buffer_load_dwordx4 v[36:39], v24, s[60:63], s57 offen offset:64
    s_mul_i32 s58, s56, 14336
    s_lshl_b32 s52, s55, 11
    s_add_u32 s58, s58, s52
    s_add_u32 s58, s58, 10223616
    s_lshl_b32 s59, s55, 14
    s_lshl_b32 s52, s56, 7
    s_add_u32 s59, s59, s52
    s_add_u32 s59, s59, 6029312
    s_mov_b32 s70, 0x3f803f80
    v_lshlrev_b32 v28, 3, v2
    v_lshrrev_b32 v29, 5, v0
    v_lshl_add_u32 v28, v29, 2, v28
    s_waitcnt vmcnt(1)
    buffer_store_dwordx4 v[32:35], v1, s[8:11], s58 offen offset:0 sc1
    s_waitcnt vmcnt(1)
    buffer_store_dwordx4 v[36:39], v1, s[8:11], s58 offen offset:1024 sc1
    v_dot2_f32_bf16 v24, v32, s70, 0
    v_dot2_f32_bf16 v25, v32, v32, 0
    v_dot2_f32_bf16 v24, v33, s70, v24
    v_dot2_f32_bf16 v25, v33, v33, v25
    v_dot2_f32_bf16 v24, v34, s70, v24
    v_dot2_f32_bf16 v25, v34, v34, v25
    v_dot2_f32_bf16 v24, v35, s70, v24
    v_dot2_f32_bf16 v25, v35, v35, v25
    v_dot2_f32_bf16 v24, v36, s70, v24
    v_dot2_f32_bf16 v25, v36, v36, v25
    v_dot2_f32_bf16 v24, v37, s70, v24
    v_dot2_f32_bf16 v25, v37, v37, v25
    v_dot2_f32_bf16 v24, v38, s70, v24
    v_dot2_f32_bf16 v25, v38, v38, v25
    v_dot2_f32_bf16 v24, v39, s70, v24
    v_dot2_f32_bf16 v25, v39, v39, v25
    s_nop 2
    v_permlane32_swap_b32 v24, v25
    v_add_f32 v24, v24, v25
    v_mov_b32 v25, v24
    s_nop 1
    v_permlane16_swap_b32 v24, v25
    v_add_f32 v24, v24, v25
    buffer_store_dword v24, v28, s[8:11], s59 offen sc1
    s_endpgm
A_q:
    s_sub_u32 s55, s54, 944
    s_and_b32 s56, s55, 15
    s_lshr_b32 s55, s55, 4
    s_mul_i32 s57, s55, 43
    s_lshr_b32 s57, s57, 7
    s_mul_i32 s52, s57, 3
    s_sub_u32 s55, s55, s52
    s_mov_b32 s60, s34
    s_and_b32 s61, s35, 0xffff
    s_mov_b32 s62, 0x126000
    s_mov_b32 s63, 0x00020000
    v_mul_u32_u24 v24, 21504, v3
    v_lshl_add_u32 v24, v2, 2, v24
    v_mov_b32 v25, 0x7ffffff0
    v_cmp_gt_u32 vcc, 14, v2
    s_nop 1
    v_cndmask_b32 v24, v25, v24, vcc
    s_add_u32 s52, s55, 1
    s_cmp_eq_u32 s55, 2
    s_cselect_b32 s52, 0, s52
    s_mul_i32 s58, s52, 896
    s_mul_i32 s52, s57, 86016
    s_add_u32 s58, s58, s52
    s_mul_i32 s52, s56, 56
    s_add_u32 s58, s58, s52
    buffer_load_dword v32, v24, s[60:63], s58 offen offset:0
    buffer_load_dword v33, v24, s[60:63], s58 offen offset:2688
    s_add_u32 s58, s58, 5376
    buffer_load_dword v34, v24, s[60:63], s58 offen offset:0
    buffer_load_dword v35, v24, s[60:63], s58 offen offset:2688
    s_add_u32 s58, s58, 5376
    buffer_load_dword v36, v24, s[60:63], s58 offen offset:0
    buffer_load_dword v37, v24, s[60:63], s58 offen offset:2688
    s_add_u32 s58, s58, 5376
    buffer_load_dword v38, v24, s[60:63], s58 offen offset:0
    buffer_load_dword v39, v24, s[60:63], s58 offen offset:2688
    s_add_u32 s58, s58, 5376
    s_mov_b32 s66, 0x05040100
    s_mov_b32 s67, 0x07060302
    s_lshl_b32 s59, s57, 2
    s_lshl_b32 s52, s55, 1
    s_add_u32 s59, s59, s52
    s_lshl_b32 s52, s57, 1
    s_add_u32 s52, s52, 56
    s_cmp_eq_u32 s55, 2
    s_cselect_b32 s59, s52, s59
    s_mul_i32 s52, s56, 84
    s_add_u32 s59, s59, s52
    s_lshl_b32 s59, s59, 10
    s_add_u32 s59, s59, 19398656
    s_mul_i32 s58, s56, 14
    s_add_u32 s58, s58, s57
    s_mul_i32 s58, s58, 384
    s_lshl_b32 s52, s55, 7
    s_add_u32 s58, s58, s52
    s_add_u32 s58, s58, 5898240
    v_mov_b32 v124, 0x3f803f80
    v_mov_b32 v125, 0x3f803f80
    v_mov_b32 v126, 0x3f803f80
    v_mov_b32 v127, 0x3f803f80
    v_lshlrev_b32 v27, 6, v2
    v_lshl_add_u32 v27, v3, 4, v27
    v_cmp_gt_u32 vcc, 2, v2
    s_nop 1
    v_cndmask_b32 v27, v25, v27, vcc
    v_cmp_eq_u32 vcc, 1, v2
    s_waitcnt vmcnt(6)
    v_perm_b32 v64, v33, v32, s66
    s_waitcnt vmcnt(4)
    v_perm_b32 v65, v35, v34, s66
    s_waitcnt vmcnt(2)
    v_perm_b32 v66, v37, v36, s66
    s_waitcnt vmcnt(0)
    v_perm_b32 v67, v39, v38, s66
    buffer_store_dwordx4 v[64:67], v1, s[8:11], s59 offen offset:0 sc1
    s_nop 0
    v_mfma_f32_16x16x32_bf16 v[96:99], v[64:67], v[124:127], 0
    v_perm_b32 v68, v33, v32, s67
    v_perm_b32 v69, v35, v34, s67
    v_perm_b32 v70, v37, v36, s67
    v_perm_b32 v71, v39, v38, s67
    buffer_store_dwordx4 v[68:71], v1, s[8:11], s59 offen offset:1024 sc1
    s_nop 0
    v_mfma_f32_16x16x32_bf16 v[100:103], v[68:71], v[124:127], 0
    s_nop 7
    v_cndmask_b32 v96, v96, v100, vcc
    v_cndmask_b32 v97, v97, v101, vcc
    v_cndmask_b32 v98, v98, v102, vcc
    v_cndmask_b32 v99, v99, v103, vcc
    buffer_store_dwordx4 v[96:99], v27, s[8:11], s58 offen sc1
    s_endpgm
A_wo:
    s_sub_u32 s55, s54, 840
    s_mul_i32 s56, s55, 9363
    s_lshr_b32 s56, s56, 16
    s_mul_i32 s52, s56, 7
    s_sub_u32 s55, s55, s52
    s_mov_b32 s60, s36
    s_and_b32 s61, s37, 0xffff
    s_mov_b32 s62, 0x62000
    s_mov_b32 s63, 0x00020000
    v_mul_u32_u24 v24, 7168, v3
    v_lshl_add_u32 v24, v2, 3, v24
    v_add_u32 v25, 896, v24
    s_mul_i32 s57, s56, 28672
    s_lshl_b32 s52, s55, 7
    s_add_u32 s57, s57, s52
    s_mov_b32 s58, 1792
    s_mul_i32 s59, s55, 14
    s_add_u32 s59, s59, s56
    s_lshl_b32 s59, s59, 12
    s_add_u32 s59, s59, 0
    s_branch A_x2
A_w2:
    s_sub_u32 s55, s54, 448
    s_mul_i32 s56, s55, 9363
    s_lshr_b32 s56, s56, 16
    s_mul_i32 s52, s56, 7
    s_sub_u32 s55, s55, s52
    s_mov_b32 s60, s44
    s_and_b32 s61, s45, 0xffff
    s_mov_b32 s62, 0x188000
    s_mov_b32 s63, 0x00020000
    s_mul_i32 s57, s56, 4682
    s_lshr_b32 s57, s57, 16
    s_mul_i32 s52, s57, 14
    s_sub_u32 s58, s56, s52
    s_lshl_b32 s57, s57, 3
    s_and_b32 s52, s58, 1
    s_lshl_b32 s52, s52, 2
    s_add_u32 s57, s57, s52
    s_mul_i32 s57, s57, 56
    s_lshr_b32 s58, s58, 1
    s_add_u32 s52, s58, 6
    s_cmp_eq_u32 s58, 0
    s_cselect_b32 s52, 13, s52
    s_add_u32 s58, s58, s57
    s_add_u32 s52, s52, s57
    v_mul_u32_u24 v26, 56, v3
    v_add_u32 v24, s58, v26
    v_add_u32 v25, s52, v26
    v_mul_u32_u24 v24, 896, v24
    v_lshl_add_u32 v24, v2, 3, v24
    v_mul_u32_u24 v25, 896, v25
    v_lshl_add_u32 v25, v2, 3, v25
    s_lshl_b32 s57, s55, 7
    s_mov_b32 s58, 12544
    s_mul_i32 s59, s55, 56
    s_add_u32 s59, s59, s56
    s_lshl_b32 s59, s59, 12
    s_add_u32 s59, s59, 524288
A_x2:
    buffer_load_dwordx2 v[32:33], v24, s[60:63], s57 offen
    buffer_load_dwordx2 v[34:35], v25, s[60:63], s57 offen
    s_add_u32 s57, s57, s58
    buffer_load_dwordx2 v[36:37], v24, s[60:63], s57 offen
    buffer_load_dwordx2 v[38:39], v25, s[60:63], s57 offen
    s_add_u32 s57, s57, s58
    buffer_load_dwordx2 v[40:41], v24, s[60:63], s57 offen
    buffer_load_dwordx2 v[42:43], v25, s[60:63], s57 offen
    s_add_u32 s57, s57, s58
    buffer_load_dwordx2 v[44:45], v24, s[60:63], s57 offen
    buffer_load_dwordx2 v[46:47], v25, s[60:63], s57 offen
    s_add_u32 s57, s57, s58
    s_mov_b32 s66, 0x05040100
    s_mov_b32 s67, 0x07060302
    s_waitcnt vmcnt(6)
    v_perm_b32 v64, v34, v32, s66
    s_waitcnt vmcnt(4)
    v_perm_b32 v65, v38, v36, s66
    s_waitcnt vmcnt(2)
    v_perm_b32 v66, v42, v40, s66
    s_waitcnt vmcnt(0)
    v_perm_b32 v67, v46, v44, s66
    buffer_store_dwordx4 v[64:67], v1, s[8:11], s59 offen offset:0 sc1
    v_perm_b32 v68, v34, v32, s67
    v_perm_b32 v69, v38, v36, s67
    v_perm_b32 v70, v42, v40, s67
    v_perm_b32 v71, v46, v44, s67
    buffer_store_dwordx4 v[68:71], v1, s[8:11], s59 offen offset:1024 sc1
    v_perm_b32 v72, v35, v33, s66
    v_perm_b32 v73, v39, v37, s66
    v_perm_b32 v74, v43, v41, s66
    v_perm_b32 v75, v47, v45, s66
    buffer_store_dwordx4 v[72:75], v1, s[8:11], s59 offen offset:2048 sc1
    v_perm_b32 v76, v35, v33, s67
    v_perm_b32 v77, v39, v37, s67
    v_perm_b32 v78, v43, v41, s67
    v_perm_b32 v79, v47, v45, s67
    buffer_store_dwordx4 v[76:79], v1, s[8:11], s59 offen offset:3072 sc1
    s_endpgm
A_w13:
    s_and_b32 s55, s54, 31
    s_lshr_b32 s56, s54, 5
    s_mul_i32 s61, s55, 14
    s_add_u32 s61, s61, s56
    v_lshrrev_b32 v26, 2, v2
    v_mul_u32_u24 v26, 28, v26
    v_and_b32 v27, 1, v2
    v_mul_u32_u24 v28, 12, v27
    v_add_u32 v26, v26, v28
    v_mul_u32_u24 v28, 28672, v3
    v_add_u32 v26, v26, v28
    s_mul_i32 s57, s56, 114688
    s_mul_i32 s52, s55, 112
    s_add_u32 s57, s57, s52
    v_add_u32 v26, s57, v26
    v_and_b32 v27, 2, v2
    v_cmp_ne_u32 vcc, 0, v27
    v_mov_b32 v24, s40
    v_mov_b32 v25, s41
    v_mov_b32 v27, s42
    v_mov_b32 v28, s43
    v_cndmask_b32 v24, v24, v27, vcc
    v_cndmask_b32 v25, v25, v28, vcc
    v_add_co_u32 v24, vcc, v24, v26
    s_nop 1
    v_addc_co_u32 v25, vcc, 0, v25, vcc
    s_mov_b32 s58, 7168
    s_mov_b32 s59, 0
    global_load_dwordx4 v[32:35], v[24:25], off offset:0
    global_load_dwordx4 v[36:39], v[24:25], off offset:3584
    v_lshl_add_u64 v[24:25], v[24:25], 0, s[58:59]
    global_load_dwordx4 v[40:43], v[24:25], off offset:0
    global_load_dwordx4 v[44:47], v[24:25], off offset:3584
    v_lshl_add_u64 v[24:25], v[24:25], 0, s[58:59]
    global_load_dwordx4 v[48:51], v[24:25], off offset:0
    global_load_dwordx4 v[52:55], v[24:25], off offset:3584
    v_lshl_add_u64 v[24:25], v[24:25], 0, s[58:59]
    global_load_dwordx4 v[56:59], v[24:25], off offset:0
    global_load_dwordx4 v[60:63], v[24:25], off offset:3584
    s_mov_b32 s66, 0x05040100
    s_mov_b32 s67, 0x07060302
    s_mul_i32 s59, s56, 7
    s_add_u32 s52, s56, 48
    s_cmp_lt_u32 s56, 8
    s_cselect_b32 s59, s59, s52
    s_cselect_b32 s57, 1, 6
    s_lshl_b32 s57, s57, 10
    s_mul_i32 s52, s55, 98
    s_add_u32 s59, s59, s52
    s_lshl_b32 s59, s59, 10
    s_add_u32 s59, s59, 2228224
    s_mov_b32 s58, s59
    v_and_b32 v27, 1, v2
    v_cmp_ne_u32 vcc, 0, v27
    v_mov_b32 v27, s66
    v_mov_b32 v28, s67
    v_cndmask_b32 v27, v27, v28, vcc
    v_mov_b32 v124, 0x3f803f80
    v_mov_b32 v125, 0x3f803f80
    v_mov_b32 v126, 0x3f803f80
    v_mov_b32 v127, 0x3f803f80
    s_waitcnt vmcnt(6)
    v_perm_b32 v68, v36, v32, s67
    s_waitcnt vmcnt(4)
    v_perm_b32 v69, v44, v40, s67
    s_waitcnt vmcnt(2)
    v_perm_b32 v70, v52, v48, s67
    s_waitcnt vmcnt(0)
    v_perm_b32 v71, v60, v56, s67
    s_add_u32 s58, s58, s57
    buffer_store_dwordx4 v[68:71], v1, s[8:11], s58 offen sc1
    v_mfma_f32_16x16x32_bf16 v[100:103], v[68:71], v[124:127], 0
    v_perm_b32 v72, v37, v33, s66
    v_perm_b32 v73, v45, v41, s66
    v_perm_b32 v74, v53, v49, s66
    v_perm_b32 v75, v61, v57, s66
    s_add_u32 s58, s58, s57
    buffer_store_dwordx4 v[72:75], v1, s[8:11], s58 offen sc1
    v_mfma_f32_16x16x32_bf16 v[104:107], v[72:75], v[124:127], 0
    v_perm_b32 v76, v37, v33, s67
    v_perm_b32 v77, v45, v41, s67
    v_perm_b32 v78, v53, v49, s67
    v_perm_b32 v79, v61, v57, s67
    s_add_u32 s58, s58, s57
    buffer_store_dwordx4 v[76:79], v1, s[8:11], s58 offen sc1
    v_mfma_f32_16x16x32_bf16 v[108:111], v[76:79], v[124:127], 0
    v_perm_b32 v80, v38, v34, s66
    v_perm_b32 v81, v46, v42, s66
    v_perm_b32 v82, v54, v50, s66
    v_perm_b32 v83, v62, v58, s66
    s_add_u32 s58, s58, s57
    buffer_store_dwordx4 v[80:83], v1, s[8:11], s58 offen sc1
    v_mfma_f32_16x16x32_bf16 v[112:115], v[80:83], v[124:127], 0
    v_perm_b32 v84, v38, v34, s67
    v_perm_b32 v85, v46, v42, s67
    v_perm_b32 v86, v54, v50, s67
    v_perm_b32 v87, v62, v58, s67
    s_add_u32 s58, s58, s57
    buffer_store_dwordx4 v[84:87], v1, s[8:11], s58 offen sc1
    v_mfma_f32_16x16x32_bf16 v[116:119], v[84:87], v[124:127], 0
    v_perm_b32 v88, v39, v35, s66
    v_perm_b32 v89, v47, v43, s66
    v_perm_b32 v90, v55, v51, s66
    v_perm_b32 v91, v63, v59, s66
    s_add_u32 s58, s58, s57
    buffer_store_dwordx4 v[88:91], v1, s[8:11], s58 offen sc1
    v_mfma_f32_16x16x32_bf16 v[120:123], v[88:91], v[124:127], 0
    v_cndmask_b32 v32, v32, v35, vcc
    v_cndmask_b32 v36, v36, v39, vcc
    v_cndmask_b32 v40, v40, v43, vcc
    v_cndmask_b32 v44, v44, v47, vcc
    v_cndmask_b32 v48, v48, v51, vcc
    v_cndmask_b32 v52, v52, v55, vcc
    v_cndmask_b32 v56, v56, v59, vcc
    v_cndmask_b32 v60, v60, v63, vcc
    v_perm_b32 v64, v36, v32, v27
    v_perm_b32 v65, v44, v40, v27
    v_perm_b32 v66, v52, v48, v27
    v_perm_b32 v67, v60, v56, v27
    buffer_store_dwordx4 v[64:67], v1, s[8:11], s59 offen sc1
    s_nop 0
    v_mfma_f32_16x16x32_bf16 v[96:99], v[64:67], v[124:127], 0
    v_cmp_eq_u32 vcc, 1, v2
    s_nop 6
    v_cndmask_b32 v96, v96, v100, vcc
    v_cndmask_b32 v97, v97, v101, vcc
    v_cndmask_b32 v98, v98, v102, vcc
    v_cndmask_b32 v99, v99, v103, vcc
    v_cmp_eq_u32 vcc, 2, v2
    s_nop 1
    v_cndmask_b32 v96, v96, v104, vcc
    v_cndmask_b32 v97, v97, v105, vcc
    v_cndmask_b32 v98, v98, v106, vcc
    v_cndmask_b32 v99, v99, v107, vcc
    v_cmp_eq_u32 vcc, 3, v2
    s_nop 1
    v_cndmask_b32 v96, v96, v108, vcc
    v_cndmask_b32 v97, v97, v109, vcc
    v_cndmask_b32 v98, v98, v110, vcc
    v_cndmask_b32 v99, v99, v111, vcc
    v_cmp_eq_u32 vcc, 4, v2
    s_nop 1
    v_cndmask_b32 v96, v96, v112, vcc
    v_cndmask_b32 v97, v97, v113, vcc
    v_cndmask_b32 v98, v98, v114, vcc
    v_cndmask_b32 v99, v99, v115, vcc
    v_cmp_eq_u32 vcc, 5, v2
    s_nop 1
    v_cndmask_b32 v96, v96, v116, vcc
    v_cndmask_b32 v97, v97, v117, vcc
    v_cndmask_b32 v98, v98, v118, vcc
    v_cndmask_b32 v99, v99, v119, vcc
    v_cmp_eq_u32 vcc, 6, v2
    s_nop 1
    v_cndmask_b32 v96, v96, v120, vcc
    v_cndmask_b32 v97, v97, v121, vcc
    v_cndmask_b32 v98, v98, v122, vcc
    v_cndmask_b32 v99, v99, v123, vcc
    v_mov_b32 v26, 0x7ffffff0
    v_lshlrev_b32 v27, 6, v2
    v_lshl_add_u32 v27, v3, 4, v27
    v_cmp_gt_u32 vcc, 7, v2
    s_nop 1
    v_cndmask_b32 v27, v26, v27, vcc
    s_mul_i32 s59, s61, 448
    s_add_u32 s59, s59, 5505024
    buffer_store_dwordx4 v[96:99], v27, s[8:11], s59 offen sc1
    s_endpgm
k0_end:
    s_endpgm
.globl interleave_layers__linear_attn_block__glu_gated_swiglu__prompt_kernel
.p2align 8
.type interleave_layers__linear_attn_block__glu_gated_swiglu__prompt_kernel,@function
interleave_layers__linear_attn_block__glu_gated_swiglu__prompt_kernel:
    s_cmp_ge_u32 s2, 256
    s_cbranch_scc1 the_end
    s_load_dwordx2 s[46:47], s[0:1], 56
    s_load_dwordx2 s[50:51], s[0:1], 72
    s_getreg_b32 s4, hwreg(HW_REG_XCC_ID)
    s_and_b32 s4, s4, 7
    s_lshr_b32 s5, s2, 3
    s_mov_b32 s98, 400000
    v_lshrrev_b32 v1, 6, v0
    v_and_b32 v0, 63, v0
    v_readfirstlane_b32 s3, v1
    v_lshlrev_b32 v1, 4, v0
    v_and_b32 v2, 15, v0
    v_lshrrev_b32 v3, 4, v0
    v_mov_b32 v4, 1
    v_mov_b32 v5, 0x7ffffff0
    v_cmp_eq_u32 vcc, 0, v0
    s_nop 1
    v_cndmask_b32 v5, v5, 0, vcc
    s_and_b32 s6, s5, 3
    s_lshr_b32 s7, s5, 2
    s_and_b32 s28, s5, 15
    s_lshr_b32 s29, s5, 4
    s_lshl_b32 s30, s4, 3
    s_lshl_b32 s52, s29, 2
    s_add_u32 s30, s30, s52
    s_add_u32 s30, s30, s3
    s_lshl_b32 s31, s4, 4
    s_lshl_b32 s52, s6, 2
    s_add_u32 s31, s31, s52
    s_add_u32 s31, s31, s3
    s_lshl_b32 s53, s3, 10
    s_lshl_b32 s83, s28, 15
    s_add_u32 s83, s83, 6291456
    s_lshl_b32 s52, s3, 9
    s_add_u32 s83, s83, s52
    s_mul_i32 s71, s28, 86016
    s_add_u32 s71, s71, s53
    s_add_u32 s71, s71, 19398656
    s_add_u32 s74, s71, 57344
    s_min_u32 s77, s7, 6
    s_mul_i32 s75, s77, 57344
    s_add_u32 s75, s75, s53
    s_add_u32 s75, s75, 0
    s_mul_i32 s76, s5, 100352
    s_add_u32 s76, s76, 2228224
    s_and_b32 s69, s53, 1024
    s_add_u32 s68, s76, s69
    s_add_u32 s76, s76, s53
    s_mul_i32 s77, s77, 229376
    s_mul_i32 s52, s3, 57344
    s_add_u32 s77, s77, s52
    s_add_u32 s77, s77, 524288
    s_lshl_b32 s78, s4, 11
    s_add_u32 s78, s78, 5767168
    s_lshr_b32 s84, s30, 2
    s_lshl_b32 s90, s4, 8
    s_add_u32 s90, s90, 5799936
    s_add_u32 s52, s90, s2
    s_cmp_lg_u32 s3, 0
    s_cselect_b32 s55, 0x7ffffff0, 0
    v_or_b32 v26, s55, v5
    v_lshlrev_b32 v12, 2, v0
    s_waitcnt lgkmcnt(0)
    s_mov_b32 s8, s50
    s_and_b32 s9, s51, 0xffff
    s_mov_b32 s10, 0x2400000
    s_mov_b32 s11, 0x00020000
    s_mov_b32 s20, s46
    s_and_b32 s21, s47, 0xffff
    s_mov_b32 s22, 0x1c0000
    s_mov_b32 s23, 0x00020000
    buffer_store_byte v4, v26, s[8:11], s52 offen
restart:
    v_add_u32 v25, 14336, v1
    s_mul_i32 s80, s30, 28672
    s_add_u32 s32, s80, 10223616
    s_add_u32 s33, s32, 4096
    s_add_u32 s34, s32, 8192
    s_add_u32 s35, s32, 12288
    v_lshrrev_b32 v26, 5, v0
    v_lshlrev_b32 v26, 14, v26
    v_and_b32 v27, 31, v0
    v_lshl_add_u32 v26, v27, 3, v26
    s_lshl_b32 s81, s30, 8
    s_add_u32 s36, s81, 6029312
    s_add_u32 s37, s36, 32768
    s_add_u32 s38, s36, 65536
    s_add_u32 s39, s36, 98304
    s_mov_b32 s64, 0x3fb8aa3b
    s_mov_b32 s65, 0x3fb8aa3b
    s_mov_b32 s66, 0x3fb8aa3b
    s_mov_b32 s67, 0x358637bd
    s_lshl_b32 s86, s3, 8
    s_add_u32 s86, s86, 157696
    s_add_u32 m0, s53, 100352
    s_add_u32 s72, s71, 0
    buffer_load_dwordx4 v1, s[8:11], s72 offen sc1 lds
    buffer_load_dwordx4 v[32:35], v1, s[8:11], s32 offen offset:0 sc1
    buffer_load_dwordx4 v[88:91], v25, s[8:11], s32 offen offset:0 sc1
    s_add_u32 m0, s53, 104448
    s_add_u32 s72, s71, 4096
    buffer_load_dwordx4 v1, s[8:11], s72 offen sc1 lds
    buffer_load_dwordx4 v[36:39], v1, s[8:11], s32 offen offset:1024 sc1
    buffer_load_dwordx4 v[92:95], v25, s[8:11], s32 offen offset:1024 sc1
    s_lshl_b32 s52, s3, 8
    v_lshl_add_u32 v9, v0, 2, s52
    s_lshl_b32 s52, s3, 1
    v_lshrrev_b32 v28, 5, v0
    v_add_u32 v28, s52, v28
    v_and_b32 v29, 31, v0
    v_mov_b32 v27, 0x7ffffff0
    v_mul_u32_u24 v8, 384, v28
    v_lshl_add_u32 v8, v29, 4, v8
    v_cmp_gt_u32 vcc, 24, v29
    s_nop 1
    v_cndmask_b32 v8, v27, v8, vcc
    v_mul_u32_u24 v7, 448, v28
    v_lshl_add_u32 v7, v29, 4, v7
    v_cmp_gt_u32 vcc, 28, v29
    s_nop 1
    v_cndmask_b32 v7, v27, v7, vcc
    s_cmp_eq_u32 s3, 3
    s_cselect_b32 s52, 0x7ffffff0, 0
    v_or_b32 v30, s52, v8
    v_or_b32 v6, s52, v7
    s_mul_i32 s40, s28, 5376
    s_add_u32 s40, s40, 5898240
    s_mul_i32 s42, s5, 6272
    s_add_u32 s42, s42, 5505024
    buffer_load_dwordx4 v[216:219], v8, s[8:11], s40 offen sc1
    buffer_load_dwordx4 v[220:223], v30, s[8:11], s40 offen offset:3072 sc1
    buffer_load_dwordx2 v[208:209], v26, s[8:11], s36 offen sc1
    buffer_load_dwordx2 v[210:211], v26, s[8:11], s37 offen sc1
    buffer_load_dwordx2 v[212:213], v26, s[8:11], s38 offen sc1
    buffer_load_dwordx2 v[214:215], v26, s[8:11], s39 offen sc1
    s_add_u32 m0, s53, 108544
    s_add_u32 s72, s71, 8192
    buffer_load_dwordx4 v1, s[8:11], s72 offen sc1 lds
    buffer_load_dwordx4 v[40:43], v1, s[8:11], s32 offen offset:2048 sc1
    buffer_load_dwordx4 v[96:99], v25, s[8:11], s32 offen offset:2048 sc1
    s_add_u32 m0, s53, 112640
    s_add_u32 s72, s71, 12288
    buffer_load_dwordx4 v1, s[8:11], s72 offen sc1 lds
    buffer_load_dwordx4 v[44:47], v1, s[8:11], s32 offen offset:3072 sc1
    buffer_load_dwordx4 v[100:103], v25, s[8:11], s32 offen offset:3072 sc1
    s_add_u32 m0, s53, 116736
    s_add_u32 s72, s71, 16384
    buffer_load_dwordx4 v1, s[8:11], s72 offen sc1 lds
    buffer_load_dwordx4 v[48:51], v1, s[8:11], s33 offen offset:0 sc1
    buffer_load_dwordx4 v[104:107], v25, s[8:11], s33 offen offset:0 sc1
    s_add_u32 m0, s53, 120832
    s_add_u32 s72, s71, 20480
    buffer_load_dwordx4 v1, s[8:11], s72 offen sc1 lds
    buffer_load_dwordx4 v[52:55], v1, s[8:11], s33 offen offset:1024 sc1
    buffer_load_dwordx4 v[108:111], v25, s[8:11], s33 offen offset:1024 sc1
    v_add_u32 v24, 100352, v1
    s_waitcnt vmcnt(16)
    v_pk_add_f32 v[216:217], v[216:217], v[220:221]
    v_pk_add_f32 v[218:219], v[218:219], v[222:223]
    v_min_u32 v8, 3072, v8
    v_add_u32 v8, 158720, v8
    ds_write_b128 v8, v[216:219]
    v_add_u32 v8, 158720, v9
    s_waitcnt lgkmcnt(0)
    s_barrier
    ds_read_b128 v[176:179], v24 offset:0
    ds_read_b128 v[180:183], v24 offset:1024
    ds_read_b128 v[184:187], v24 offset:2048
    ds_read_b128 v[188:191], v24 offset:3072
    ds_read_b32 v216, v8 offset:0
    ds_read_b32 v217, v8 offset:384
    ds_read_b32 v218, v8 offset:768
    ds_read_b32 v219, v8 offset:1152
    ds_read_b32 v220, v8 offset:1536
    ds_read_b32 v221, v8 offset:1920
    ds_read_b32 v222, v8 offset:2304
    ds_read_b32 v223, v8 offset:2688
    s_waitcnt lgkmcnt(11)
    v_mfma_f32_16x16x32_bf16 v[144:147], v[32:35], v[176:179], 0
    s_add_u32 m0, s53, 124928
    ds_read_b128 v[192:195], v24 offset:4096
    v_add_u32 v8, 162816, v9
    v_mfma_f32_16x16x32_bf16 v[160:163], v[88:91], v[176:179], 0
    s_waitcnt lgkmcnt(11)
    ds_read_b128 v[196:199], v24 offset:5120
    s_add_u32 s72, s71, 24576
    v_mfma_f32_16x16x32_bf16 v[148:151], v[32:35], v[180:183], 0
    ds_read_b128 v[200:203], v24 offset:6144
    v_min_u32 v8, 163200, v8
    v_mfma_f32_16x16x32_bf16 v[164:167], v[88:91], v[180:183], 0
    s_waitcnt lgkmcnt(12)
    ds_read_b128 v[204:207], v24 offset:7168
    buffer_load_dwordx4 v1, s[8:11], s72 offen sc1 lds
    v_mfma_f32_16x16x32_bf16 v[152:155], v[32:35], v[184:187], 0
    s_waitcnt lgkmcnt(10)
    v_add_f32 v216, v216, v217
    s_waitcnt lgkmcnt(9)
    v_add_f32 v216, v216, v218
    v_mfma_f32_16x16x32_bf16 v[168:171], v[88:91], v[184:187], 0
    buffer_load_dwordx4 v[56:59], v1, s[8:11], s33 offen offset:2048 sc1
    s_waitcnt lgkmcnt(8)
    v_add_f32 v216, v216, v219
    v_mfma_f32_16x16x32_bf16 v[156:159], v[32:35], v[188:191], 0
    s_waitcnt lgkmcnt(7)
    v_add_f32 v216, v216, v220
    s_waitcnt lgkmcnt(6)
    v_add_f32 v216, v216, v221
    v_mfma_f32_16x16x32_bf16 v[172:175], v[88:91], v[188:191], 0
    s_waitcnt lgkmcnt(0)
    buffer_load_dwordx4 v[112:115], v25, s[8:11], s33 offen offset:2048 sc1
    v_add_f32 v216, v216, v222
    s_waitcnt vmcnt(11)
    s_barrier
    v_mfma_f32_16x16x32_bf16 v[144:147], v[36:39], v[192:195], v[144:147]
    s_add_u32 m0, s53, 129024
    ds_read_b128 v[176:179], v24 offset:8192
    v_add_f32 v216, v216, v223
    v_mfma_f32_16x16x32_bf16 v[160:163], v[92:95], v[192:195], v[160:163]
    s_add_u32 s72, s71, 28672
    ds_read_b128 v[180:183], v24 offset:9216
    buffer_load_dwordx4 v1, s[8:11], s72 offen sc1 lds
    v_mfma_f32_16x16x32_bf16 v[148:151], v[36:39], v[196:199], v[148:151]
    ds_read_b128 v[184:187], v24 offset:10240
    ds_write_b32 v8, v216
    v_mfma_f32_16x16x32_bf16 v[164:167], v[92:95], v[196:199], v[164:167]
    ds_read_b128 v[188:191], v24 offset:11264
    buffer_load_dwordx4 v[60:63], v1, s[8:11], s33 offen offset:3072 sc1
    v_mfma_f32_16x16x32_bf16 v[152:155], v[36:39], v[200:203], v[152:155]
    v_cmp_gt_u32 vcc, 32, v0
    v_add_f32 v208, v208, v210
    v_mfma_f32_16x16x32_bf16 v[168:171], v[92:95], v[200:203], v[168:171]
    buffer_load_dwordx4 v[116:119], v25, s[8:11], s33 offen offset:3072 sc1
    v_add_f32 v209, v209, v211
    v_mfma_f32_16x16x32_bf16 v[156:159], v[36:39], v[204:207], v[156:159]
    s_add_u32 m0, s53, 133120
    v_cndmask_b32 v214, 0, v214, vcc
    v_cndmask_b32 v215, 0, v215, vcc
    v_mfma_f32_16x16x32_bf16 v[172:175], v[92:95], v[204:207], v[172:175]
    s_waitcnt lgkmcnt(0)
    s_add_u32 s72, s71, 32768
    buffer_load_dwordx4 v1, s[8:11], s72 offen sc1 lds
    v_mfma_f32_16x16x32_bf16 v[144:147], v[40:43], v[176:179], v[144:147]
    ds_read_b128 v[192:195], v24 offset:12288
    v_add_f32 v212, v212, v214
    v_mfma_f32_16x16x32_bf16 v[160:163], v[96:99], v[176:179], v[160:163]
    ds_read_b128 v[196:199], v24 offset:13312
    buffer_load_dwordx4 v[64:67], v1, s[8:11], s34 offen offset:0 sc1
    v_mfma_f32_16x16x32_bf16 v[148:151], v[40:43], v[180:183], v[148:151]
    ds_read_b128 v[200:203], v24 offset:14336
    v_add_f32 v213, v213, v215
    v_mfma_f32_16x16x32_bf16 v[164:167], v[96:99], v[180:183], v[164:167]
    ds_read_b128 v[204:207], v24 offset:15360
    buffer_load_dwordx4 v[120:123], v25, s[8:11], s34 offen offset:0 sc1
    v_mfma_f32_16x16x32_bf16 v[152:155], v[40:43], v[184:187], v[152:155]
    s_add_u32 m0, s53, 137216
    v_add_f32 v208, v208, v212
    v_add_f32 v209, v209, v213
    v_mfma_f32_16x16x32_bf16 v[168:171], v[96:99], v[184:187], v[168:171]
    s_add_u32 s72, s71, 36864
    buffer_load_dwordx4 v1, s[8:11], s72 offen sc1 lds
    v_mov_b32 v210, v208
    v_mfma_f32_16x16x32_bf16 v[156:159], v[40:43], v[188:191], v[156:159]
    v_mov_b32 v211, v209
    v_lshl_add_u32 v27, v0, 2, s86
    v_mfma_f32_16x16x32_bf16 v[172:175], v[96:99], v[188:191], v[172:175]
    s_waitcnt vmcnt(16) lgkmcnt(0)
    buffer_load_dwordx4 v[68:71], v1, s[8:11], s34 offen offset:1024 sc1
    s_waitcnt vmcnt(13)
    s_barrier
    v_mfma_f32_16x16x32_bf16 v[144:147], v[44:47], v[192:195], v[144:147]
    ds_read_b128 v[176:179], v24 offset:16384
    v_mfma_f32_16x16x32_bf16 v[160:163], v[100:103], v[192:195], v[160:163]
    ds_read_b128 v[180:183], v24 offset:17408
    buffer_load_dwordx4 v[124:127], v25, s[8:11], s34 offen offset:1024 sc1
    v_mfma_f32_16x16x32_bf16 v[148:151], v[44:47], v[196:199], v[148:151]
    s_add_u32 m0, s53, 141312
    ds_read_b128 v[184:187], v24 offset:18432
    v_mfma_f32_16x16x32_bf16 v[164:167], v[100:103], v[196:199], v[164:167]
    s_add_u32 s72, s71, 40960
    ds_read_b128 v[188:191], v24 offset:19456
    buffer_load_dwordx4 v1, s[8:11], s72 offen sc1 lds
    v_mfma_f32_16x16x32_bf16 v[152:155], v[44:47], v[200:203], v[152:155]
    v_permlane32_swap_b32 v208, v210
    v_mfma_f32_16x16x32_bf16 v[168:171], v[100:103], v[200:203], v[168:171]
    buffer_load_dwordx4 v[72:75], v1, s[8:11], s34 offen offset:2048 sc1
    v_mfma_f32_16x16x32_bf16 v[156:159], v[44:47], v[204:207], v[156:159]
    v_permlane32_swap_b32 v209, v211
    v_mfma_f32_16x16x32_bf16 v[172:175], v[100:103], v[204:207], v[172:175]
    s_waitcnt lgkmcnt(0)
    buffer_load_dwordx4 v[128:131], v25, s[8:11], s34 offen offset:2048 sc1
    v_add_f32 v208, v208, v210
    v_mfma_f32_16x16x32_bf16 v[144:147], v[48:51], v[176:179], v[144:147]
    s_add_u32 m0, s53, 145408
    ds_read_b128 v[192:195], v24 offset:20480
    v_add_f32 v209, v209, v211
    v_mfma_f32_16x16x32_bf16 v[160:163], v[104:107], v[176:179], v[160:163]
    s_add_u32 s72, s71, 45056
    ds_read_b128 v[196:199], v24 offset:21504
    buffer_load_dwordx4 v1, s[8:11], s72 offen sc1 lds
    v_mfma_f32_16x16x32_bf16 v[148:151], v[48:51], v[180:183], v[148:151]
    ds_read_b128 v[200:203], v24 offset:22528
    v_mul_f32 v208, 0xbb124925, v208
    v_mfma_f32_16x16x32_bf16 v[164:167], v[104:107], v[180:183], v[164:167]
    ds_read_b128 v[204:207], v24 offset:23552
    buffer_load_dwordx4 v[76:79], v1, s[8:11], s34 offen offset:3072 sc1
    v_mfma_f32_16x16x32_bf16 v[152:155], v[48:51], v[184:187], v[152:155]
    v_mul_f32 v209, 0x3b124925, v209
    v_fma_f32 v209, -v208, v208, v209
    v_mfma_f32_16x16x32_bf16 v[168:171], v[104:107], v[184:187], v[168:171]
    buffer_load_dwordx4 v[132:135], v25, s[8:11], s34 offen offset:3072 sc1
    v_max_f32 v209, 0, v209
    v_mfma_f32_16x16x32_bf16 v[156:159], v[48:51], v[188:191], v[156:159]
    s_add_u32 m0, s53, 149504
    v_add_f32 v209, 0x3727c5ac, v209
    v_mfma_f32_16x16x32_bf16 v[172:175], v[104:107], v[188:191], v[172:175]
    s_waitcnt vmcnt(18) lgkmcnt(0)
    s_add_u32 s72, s71, 49152
    buffer_load_dwordx4 v1, s[8:11], s72 offen sc1 lds
    s_waitcnt vmcnt(15)
    s_barrier
    v_mfma_f32_16x16x32_bf16 v[144:147], v[52:55], v[192:195], v[144:147]
    ds_read_b128 v[176:179], v24 offset:24576
    v_mfma_f32_16x16x32_bf16 v[160:163], v[108:111], v[192:195], v[160:163]
    ds_read_b128 v[180:183], v24 offset:25600
    buffer_load_dwordx4 v[80:83], v1, s[8:11], s35 offen offset:0 sc1
    v_mfma_f32_16x16x32_bf16 v[148:151], v[52:55], v[196:199], v[148:151]
    ds_read_b128 v[184:187], v24 offset:26624
    v_mfma_f32_16x16x32_bf16 v[164:167], v[108:111], v[196:199], v[164:167]
    ds_read_b128 v[188:191], v24 offset:27648
    buffer_load_dwordx4 v[136:139], v25, s[8:11], s35 offen offset:0 sc1
    v_mfma_f32_16x16x32_bf16 v[152:155], v[52:55], v[200:203], v[152:155]
    s_add_u32 m0, s53, 153600
    v_rsq_f32 v209, v209
    v_mfma_f32_16x16x32_bf16 v[168:171], v[108:111], v[200:203], v[168:171]
    s_add_u32 s72, s71, 53248
    buffer_load_dwordx4 v1, s[8:11], s72 offen sc1 lds
    v_lshlrev_b32 v210, 2, v2
    v_mfma_f32_16x16x32_bf16 v[156:159], v[52:55], v[204:207], v[156:159]
    v_cndmask_b32 v208, v209, v208, vcc
    ds_write_b32 v27, v208
    v_mfma_f32_16x16x32_bf16 v[172:175], v[108:111], v[204:207], v[172:175]
    s_waitcnt lgkmcnt(1)
    buffer_load_dwordx4 v[84:87], v1, s[8:11], s35 offen offset:1024 sc1
    v_lshl_add_u32 v27, v3, 4, s86
    v_mfma_f32_16x16x32_bf16 v[144:147], v[56:59], v[176:179], v[144:147]
    ds_read_b128 v[192:195], v24 offset:28672
    ds_read_b128 v[252:255], v27
    v_mfma_f32_16x16x32_bf16 v[160:163], v[112:115], v[176:179], v[160:163]
    ds_read_b128 v[196:199], v24 offset:29696
    buffer_load_dwordx4 v[140:143], v25, s[8:11], s35 offen offset:1024 sc1
    v_mfma_f32_16x16x32_bf16 v[148:151], v[56:59], v[180:183], v[148:151]
    ds_read_b128 v[200:203], v24 offset:30720
    ds_read_b128 v[28:31], v27 offset:64
    v_mfma_f32_16x16x32_bf16 v[164:167], v[112:115], v[180:183], v[164:167]
    ds_read_b128 v[204:207], v24 offset:31744
    ds_read_b128 v[240:243], v27 offset:128
    v_mfma_f32_16x16x32_bf16 v[152:155], v[56:59], v[184:187], v[152:155]
    ds_read_b128 v[244:247], v27 offset:192
    v_add_u32 v210, 162816, v210
    v_mfma_f32_16x16x32_bf16 v[168:171], v[112:115], v[184:187], v[168:171]
    v_lshlrev_b32 v211, 4, v3
    v_add_u32 v211, 162816, v211
    v_mfma_f32_16x16x32_bf16 v[156:159], v[56:59], v[188:191], v[156:159]
    ds_read_b32 v248, v210 offset:0
    ds_read_b32 v249, v210 offset:64
    v_mfma_f32_16x16x32_bf16 v[172:175], v[112:115], v[188:191], v[172:175]
    s_waitcnt vmcnt(18) lgkmcnt(4)
    ds_read_b32 v250, v210 offset:128
    ds_read_b32 v251, v210 offset:192
    s_waitcnt vmcnt(14)
    s_barrier
    v_mfma_f32_16x16x32_bf16 v[144:147], v[60:63], v[192:195], v[144:147]
    ds_read_b128 v[176:179], v24 offset:32768
    ds_read_b128 v[16:19], v211 offset:256
    v_mfma_f32_16x16x32_bf16 v[160:163], v[116:119], v[192:195], v[160:163]
    ds_read_b128 v[180:183], v24 offset:33792
    ds_read_b128 v[20:23], v211 offset:320
    v_mfma_f32_16x16x32_bf16 v[148:151], v[60:63], v[196:199], v[148:151]
    s_nop 0
    ds_read_b128 v[184:187], v24 offset:34816
    s_nop 0
    v_mfma_f32_16x16x32_bf16 v[164:167], v[116:119], v[196:199], v[164:167]
    s_nop 0
    ds_read_b128 v[188:191], v24 offset:35840
    s_nop 0
    v_mfma_f32_16x16x32_bf16 v[152:155], v[60:63], v[200:203], v[152:155]
    v_cmp_eq_u32 vcc, 14, v2
    v_mov_b32 v26, 0
    v_mfma_f32_16x16x32_bf16 v[168:171], v[116:119], v[200:203], v[168:171]
    s_nop 0
    v_cndmask_b32 v26, v26, 1.0, vcc
    s_waitcnt lgkmcnt(11)
    v_mul_f32 v252, v252, v240
    v_mfma_f32_16x16x32_bf16 v[156:159], v[60:63], v[204:207], v[156:159]
    v_mul_f32 v253, v253, v241
    v_mul_f32 v254, v254, v242
    v_mfma_f32_16x16x32_bf16 v[172:175], v[116:119], v[204:207], v[172:175]
    s_waitcnt lgkmcnt(0)
    v_mul_f32 v255, v255, v243
    v_mul_f32 v28, v28, v244
    v_mfma_f32_16x16x32_bf16 v[144:147], v[64:67], v[176:179], v[144:147]
    ds_read_b128 v[192:195], v24 offset:36864
    v_mul_f32 v29, v29, v245
    v_mfma_f32_16x16x32_bf16 v[160:163], v[120:123], v[176:179], v[160:163]
    ds_read_b128 v[196:199], v24 offset:37888
    v_mul_f32 v30, v30, v246
    v_mfma_f32_16x16x32_bf16 v[148:151], v[64:67], v[180:183], v[148:151]
    ds_read_b128 v[200:203], v24 offset:38912
    v_mul_f32 v31, v31, v247
    v_mfma_f32_16x16x32_bf16 v[164:167], v[120:123], v[180:183], v[164:167]
    ds_read_b128 v[204:207], v24 offset:39936
    v_fma_f32 v208, v252, v248, s67
    v_mfma_f32_16x16x32_bf16 v[152:155], v[64:67], v[184:187], v[152:155]
    v_fma_f32 v209, v253, v248, s67
    v_fma_f32 v210, v254, v248, s67
    v_mfma_f32_16x16x32_bf16 v[168:171], v[120:123], v[184:187], v[168:171]
    v_fma_f32 v211, v255, v248, s67
    v_fma_f32 v224, v28, v248, s67
    v_mfma_f32_16x16x32_bf16 v[156:159], v[64:67], v[188:191], v[156:159]
    v_fma_f32 v225, v29, v248, s67
    v_fma_f32 v226, v30, v248, s67
    v_mfma_f32_16x16x32_bf16 v[172:175], v[120:123], v[188:191], v[172:175]
    s_waitcnt vmcnt(12) lgkmcnt(0)
    v_fma_f32 v227, v31, v248, s67
    v_fma_f32 v212, v252, v249, s67
    s_waitcnt vmcnt(8)
    s_barrier
    v_mfma_f32_16x16x32_bf16 v[144:147], v[68:71], v[192:195], v[144:147]
    s_add_u32 m0, s53, 100352
    ds_read_b128 v[176:179], v24 offset:40960
    v_fma_f32 v213, v253, v249, s67
    v_mfma_f32_16x16x32_bf16 v[160:163], v[124:127], v[192:195], v[160:163]
    s_add_u32 s72, s74, 0
    ds_read_b128 v[180:183], v24 offset:41984
    buffer_load_dwordx4 v1, s[8:11], s72 offen sc1 lds
    v_mfma_f32_16x16x32_bf16 v[148:151], v[68:71], v[196:199], v[148:151]
    s_add_u32 m0, s53, 104448
    ds_read_b128 v[184:187], v24 offset:43008
    v_fma_f32 v214, v254, v249, s67
    v_mfma_f32_16x16x32_bf16 v[164:167], v[124:127], v[196:199], v[164:167]
    s_add_u32 s72, s74, 4096
    ds_read_b128 v[188:191], v24 offset:44032
    buffer_load_dwordx4 v1, s[8:11], s72 offen sc1 lds
    v_mfma_f32_16x16x32_bf16 v[152:155], v[68:71], v[200:203], v[152:155]
    s_add_u32 m0, s53, 108544
    v_fma_f32 v215, v255, v249, s67
    v_fma_f32 v228, v28, v249, s67
    v_mfma_f32_16x16x32_bf16 v[168:171], v[124:127], v[200:203], v[168:171]
    s_add_u32 s72, s74, 8192
    buffer_load_dwordx4 v1, s[8:11], s72 offen sc1 lds
    v_fma_f32 v229, v29, v249, s67
    v_mfma_f32_16x16x32_bf16 v[156:159], v[68:71], v[204:207], v[156:159]
    s_add_u32 m0, s53, 112640
    v_fma_f32 v230, v30, v249, s67
    v_fma_f32 v231, v31, v249, s67
    v_mfma_f32_16x16x32_bf16 v[172:175], v[124:127], v[204:207], v[172:175]
    s_waitcnt lgkmcnt(0)
    s_add_u32 s72, s74, 12288
    buffer_load_dwordx4 v1, s[8:11], s72 offen sc1 lds
    v_mfma_f32_16x16x32_bf16 v[144:147], v[72:75], v[176:179], v[144:147]
    s_add_u32 m0, s53, 116736
    ds_read_b128 v[192:195], v24 offset:45056
    v_fma_f32 v216, v252, v250, v26
    v_mfma_f32_16x16x32_bf16 v[160:163], v[128:131], v[176:179], v[160:163]
    s_add_u32 s72, s74, 16384
    ds_read_b128 v[196:199], v24 offset:46080
    buffer_load_dwordx4 v1, s[8:11], s72 offen sc1 lds
    v_mfma_f32_16x16x32_bf16 v[148:151], v[72:75], v[180:183], v[148:151]
    s_add_u32 m0, s53, 120832
    ds_read_b128 v[200:203], v24 offset:47104
    v_fma_f32 v217, v253, v250, v26
    v_mfma_f32_16x16x32_bf16 v[164:167], v[128:131], v[180:183], v[164:167]
    s_add_u32 s72, s74, 20480
    ds_read_b128 v[204:207], v24 offset:48128
    buffer_load_dwordx4 v1, s[8:11], s72 offen sc1 lds
    v_mfma_f32_16x16x32_bf16 v[152:155], v[72:75], v[184:187], v[152:155]
    s_add_u32 m0, s53, 124928
    v_fma_f32 v218, v254, v250, v26
    v_fma_f32 v219, v255, v250, v26
    v_mfma_f32_16x16x32_bf16 v[168:171], v[128:131], v[184:187], v[168:171]
    s_add_u32 s72, s74, 24576
    buffer_load_dwordx4 v1, s[8:11], s72 offen sc1 lds
    v_fma_f32 v232, v28, v250, v26
    v_mfma_f32_16x16x32_bf16 v[156:159], v[72:75], v[188:191], v[156:159]
    v_fma_f32 v233, v29, v250, v26
    v_fma_f32 v234, v30, v250, v26
    v_mfma_f32_16x16x32_bf16 v[172:175], v[128:131], v[188:191], v[172:175]
    s_waitcnt vmcnt(13) lgkmcnt(0)
    buffer_load_dword v13, v12, s[8:11], s90 offen sc1
    v_fma_f32 v235, v31, v250, v26
    s_waitcnt vmcnt(10)
    s_barrier
    v_mfma_f32_16x16x32_bf16 v[144:147], v[76:79], v[192:195], v[144:147]
    ds_read_b128 v[176:179], v24 offset:49152
    v_mul_f32 v220, v252, v251
    v_mfma_f32_16x16x32_bf16 v[160:163], v[132:135], v[192:195], v[160:163]
    ds_read_b128 v[180:183], v24 offset:50176
    v_mul_f32 v221, v253, v251
    v_mfma_f32_16x16x32_bf16 v[148:151], v[76:79], v[196:199], v[148:151]
    ds_read_b128 v[184:187], v24 offset:51200
    v_mul_f32 v222, v254, v251
    v_mfma_f32_16x16x32_bf16 v[164:167], v[132:135], v[196:199], v[164:167]
    ds_read_b128 v[188:191], v24 offset:52224
    v_mul_f32 v223, v255, v251
    v_mfma_f32_16x16x32_bf16 v[152:155], v[76:79], v[200:203], v[152:155]
    v_mul_f32 v236, v28, v251
    v_mul_f32 v237, v29, v251
    v_mfma_f32_16x16x32_bf16 v[168:171], v[132:135], v[200:203], v[168:171]
    v_mul_f32 v238, v30, v251
    v_mul_f32 v239, v31, v251
    v_mfma_f32_16x16x32_bf16 v[156:159], v[76:79], v[204:207], v[156:159]
    v_mfma_f32_16x16x32_bf16 v[172:175], v[132:135], v[204:207], v[172:175]
    s_waitcnt lgkmcnt(0)
    v_mfma_f32_16x16x32_bf16 v[144:147], v[80:83], v[176:179], v[144:147]
    ds_read_b128 v[192:195], v24 offset:53248
    v_mfma_f32_16x16x32_bf16 v[160:163], v[136:139], v[176:179], v[160:163]
    ds_read_b128 v[196:199], v24 offset:54272
    v_mfma_f32_16x16x32_bf16 v[148:151], v[80:83], v[180:183], v[148:151]
    ds_read_b128 v[200:203], v24 offset:55296
    v_mfma_f32_16x16x32_bf16 v[164:167], v[136:139], v[180:183], v[164:167]
    ds_read_b128 v[204:207], v24 offset:56320
    v_mfma_f32_16x16x32_bf16 v[152:155], v[80:83], v[184:187], v[152:155]
    v_mfma_f32_16x16x32_bf16 v[168:171], v[136:139], v[184:187], v[168:171]
    v_mfma_f32_16x16x32_bf16 v[156:159], v[80:83], v[188:191], v[156:159]
    v_mfma_f32_16x16x32_bf16 v[172:175], v[136:139], v[188:191], v[172:175]
    s_waitcnt vmcnt(8) lgkmcnt(0)
    s_barrier
    v_mfma_f32_16x16x32_bf16 v[144:147], v[84:87], v[192:195], v[144:147]
    s_add_u32 m0, s53, 145408
    v_lshl_add_u32 v27, v2, 2, s86
    ds_read_b32 v248, v27 offset:0
    v_mfma_f32_16x16x32_bf16 v[160:163], v[140:143], v[192:195], v[160:163]
    s_add_u32 s72, s75, 45056
    buffer_load_dwordx4 v1, s[8:11], s72 offen sc1 lds
    ds_read_b32 v249, v27 offset:64
    v_mfma_f32_16x16x32_bf16 v[148:151], v[84:87], v[196:199], v[148:151]
    s_add_u32 m0, s53, 149504
    ds_read_b32 v250, v27 offset:128
    ds_read_b32 v251, v27 offset:192
    v_mfma_f32_16x16x32_bf16 v[164:167], v[140:143], v[196:199], v[164:167]
    s_add_u32 s72, s75, 49152
    buffer_load_dwordx4 v1, s[8:11], s72 offen sc1 lds
    s_lshl_b32 s52, s3, 12
    v_mfma_f32_16x16x32_bf16 v[152:155], v[84:87], v[200:203], v[152:155]
    s_add_u32 m0, s53, 153600
    s_add_u32 s52, s52, 129024
    v_add_u32 v26, s52, v1
    v_mfma_f32_16x16x32_bf16 v[168:171], v[140:143], v[200:203], v[168:171]
    s_add_u32 s72, s75, 53248
    buffer_load_dwordx4 v1, s[8:11], s72 offen sc1 lds
    s_add_u32 s52, s53, 129024
    v_mfma_f32_16x16x32_bf16 v[156:159], v[84:87], v[204:207], v[156:159]
    v_add_u32 v27, s52, v1
    s_lshl_b32 s87, s84, 11
    v_mfma_f32_16x16x32_bf16 v[172:175], v[140:143], v[204:207], v[172:175]
    s_add_u32 s87, s87, s83
    v_add_u32 v24, 100352, v1
    v_pk_fma_f32 v[144:145], v[144:145], v[240:241], v[208:209]
    v_pk_fma_f32 v[146:147], v[146:147], v[242:243], v[210:211]
    v_pk_fma_f32 v[160:161], v[160:161], v[244:245], v[224:225]
    v_pk_fma_f32 v[162:163], v[162:163], v[246:247], v[226:227]
    v_pk_mul_f32 v[192:193], v[144:145], s[64:65]
    v_pk_mul_f32 v[194:195], v[146:147], s[64:65]
    v_pk_mul_f32 v[196:197], v[160:161], s[64:65]
    s_add_u32 m0, s53, 0
    s_add_u32 s72, s76, 0
    buffer_load_dwordx4 v1, s[8:11], s72 offen sc1 lds
    v_pk_mul_f32 v[198:199], v[162:163], s[64:65]
    v_exp_f32 v192, v192 clamp
    v_max_f32 v144, s67, v144
    v_exp_f32 v193, v193 clamp
    v_max_f32 v145, s67, v145
    v_exp_f32 v194, v194 clamp
    v_max_f32 v146, s67, v146
    s_add_u32 s93, s77, 0
    buffer_load_dwordx4 a[0:3], v1, s[8:11], s93 offen offset:0 sc1
    v_exp_f32 v195, v195 clamp
    v_max_f32 v147, s67, v147
    v_exp_f32 v196, v196 clamp
    v_max_f32 v160, s67, v160
    v_exp_f32 v197, v197 clamp
    v_max_f32 v161, s67, v161
    v_exp_f32 v198, v198 clamp
    s_add_u32 m0, s53, 4096
    s_add_u32 s72, s76, 4096
    buffer_load_dwordx4 v1, s[8:11], s72 offen sc1 lds
    v_max_f32 v162, s67, v162
    v_exp_f32 v199, v199 clamp
    v_max_f32 v163, s67, v163
    v_pk_add_f32 v[144:145], v[144:145], v[192:193]
    v_pk_add_f32 v[146:147], v[146:147], v[194:195]
    v_pk_add_f32 v[160:161], v[160:161], v[196:197]
    v_pk_add_f32 v[162:163], v[162:163], v[198:199]
    s_add_u32 s93, s77, 0
    buffer_load_dwordx4 a[4:7], v1, s[8:11], s93 offen offset:1024 sc1
    v_cvt_pk_bf16_f32 v176, v144, v145
    v_cvt_pk_bf16_f32 v177, v146, v147
    v_cvt_pk_bf16_f32 v178, v160, v161
    v_cvt_pk_bf16_f32 v179, v162, v163
    v_pk_fma_f32 v[152:153], v[152:153], v[240:241], v[216:217]
    v_pk_fma_f32 v[154:155], v[154:155], v[242:243], v[218:219]
    v_pk_fma_f32 v[168:169], v[168:169], v[244:245], v[232:233]
    s_add_u32 m0, s53, 8192
    s_add_u32 s72, s76, 8192
    buffer_load_dwordx4 v1, s[8:11], s72 offen sc1 lds
    v_pk_fma_f32 v[170:171], v[170:171], v[246:247], v[234:235]
    v_pk_fma_f32 v[156:157], v[156:157], v[240:241], v[220:221]
    v_pk_fma_f32 v[158:159], v[158:159], v[242:243], v[222:223]
    v_pk_fma_f32 v[172:173], v[172:173], v[244:245], v[236:237]
    v_pk_fma_f32 v[174:175], v[174:175], v[246:247], v[238:239]
    v_cvt_pk_bf16_f32 v184, v152, v153
    v_cvt_pk_bf16_f32 v185, v154, v155
    s_add_u32 s93, s77, 0
    buffer_load_dwordx4 a[8:11], v1, s[8:11], s93 offen offset:2048 sc1
    v_cvt_pk_bf16_f32 v186, v168, v169
    v_cvt_pk_bf16_f32 v187, v170, v171
    v_cvt_pk_bf16_f32 v188, v156, v157
    v_cvt_pk_bf16_f32 v189, v158, v159
    v_cvt_pk_bf16_f32 v190, v172, v173
    v_cvt_pk_bf16_f32 v191, v174, v175
    v_mfma_f32_16x16x32_bf16 v[152:155], v[176:179], v[184:187], 0
    s_add_u32 m0, s53, 12288
    s_add_u32 s72, s76, 12288
    buffer_load_dwordx4 v1, s[8:11], s72 offen sc1 lds
    v_mfma_f32_16x16x32_bf16 v[156:159], v[176:179], v[188:191], 0
    v_pk_fma_f32 v[148:149], v[148:149], v[240:241], v[212:213]
    v_pk_fma_f32 v[150:151], v[150:151], v[242:243], v[214:215]
    v_pk_fma_f32 v[164:165], v[164:165], v[244:245], v[228:229]
    v_pk_fma_f32 v[166:167], v[166:167], v[246:247], v[230:231]
    v_pk_mul_f32 v[192:193], v[148:149], s[64:65]
    v_pk_mul_f32 v[194:195], v[150:151], s[64:65]
    s_add_u32 s93, s77, 0
    buffer_load_dwordx4 a[12:15], v1, s[8:11], s93 offen offset:3072 sc1
    v_pk_mul_f32 v[196:197], v[164:165], s[64:65]
    v_pk_mul_f32 v[198:199], v[166:167], s[64:65]
    v_exp_f32 v192, v192 clamp
    v_max_f32 v148, s67, v148
    v_exp_f32 v193, v193 clamp
    v_max_f32 v149, s67, v149
    v_exp_f32 v194, v194 clamp
    s_add_u32 m0, s53, 16384
    s_add_u32 s72, s76, 16384
    buffer_load_dwordx4 v1, s[8:11], s72 offen sc1 lds
    v_max_f32 v150, s67, v150
    v_exp_f32 v195, v195 clamp
    v_max_f32 v151, s67, v151
    v_exp_f32 v196, v196 clamp
    v_max_f32 v164, s67, v164
    v_exp_f32 v197, v197 clamp
    v_max_f32 v165, s67, v165
    s_add_u32 s93, s77, 4096
    buffer_load_dwordx4 a[16:19], v1, s[8:11], s93 offen offset:0 sc1
    v_exp_f32 v198, v198 clamp
    v_max_f32 v166, s67, v166
    v_exp_f32 v199, v199 clamp
    v_max_f32 v167, s67, v167
    v_pk_add_f32 v[148:149], v[148:149], v[192:193]
    v_pk_add_f32 v[150:151], v[150:151], v[194:195]
    v_pk_add_f32 v[164:165], v[164:165], v[196:197]
    s_add_u32 m0, s53, 20480
    s_add_u32 s72, s76, 20480
    buffer_load_dwordx4 v1, s[8:11], s72 offen sc1 lds
    v_pk_add_f32 v[166:167], v[166:167], v[198:199]
    v_cvt_pk_bf16_f32 v180, v148, v149
    v_cvt_pk_bf16_f32 v181, v150, v151
    v_cvt_pk_bf16_f32 v182, v164, v165
    v_cvt_pk_bf16_f32 v183, v166, v167
    s_nop 1
    v_mfma_f32_16x16x32_bf16 v[168:171], v[180:183], v[184:187], 0
    v_mfma_f32_16x16x32_bf16 v[172:175], v[180:183], v[188:191], 0
    s_add_u32 s93, s77, 4096
    buffer_load_dwordx4 a[20:23], v1, s[8:11], s93 offen offset:1024 sc1
    ds_write_b128 v26, v[152:155] offset:0
    ds_write_b128 v26, v[156:159] offset:2048
    s_nop 2
    ds_write_b128 v26, v[168:171] offset:1024
    ds_write_b128 v26, v[172:175] offset:3072
    v_cmp_ne_u32 vcc, 3, v3
    v_lshlrev_b32 v25, 3, v0
    s_waitcnt vmcnt(16)
    s_waitcnt lgkmcnt(0)
    s_barrier
    ds_read_b128 v[160:163], v27 offset:0
    ds_read_b128 v[164:167], v27 offset:4096
    ds_read_b128 v[168:171], v27 offset:8192
    ds_read_b128 v[172:175], v27 offset:12288
    ds_read_b128 v[176:179], v24 offset:0
    ds_read_b128 v[180:183], v24 offset:1024
    s_waitcnt lgkmcnt(4)
    v_pk_add_f32 v[160:161], v[160:161], v[164:165]
    v_pk_add_f32 v[162:163], v[162:163], v[166:167]
    s_waitcnt lgkmcnt(2)
    v_pk_add_f32 v[168:169], v[168:169], v[172:173]
    v_pk_add_f32 v[170:171], v[170:171], v[174:175]
    v_pk_add_f32 v[162:163], v[162:163], v[170:171]
    v_pk_add_f32 v[160:161], v[160:161], v[168:169]
    v_cvt_pk_bf16_f32 v162, v162, v163
    v_cvt_pk_bf16_f32 v160, v160, v161
    v_cndmask_b32 v161, 0, v162, vcc
    buffer_store_dwordx2 v[160:161], v25, s[8:11], s87 offen sc1
    ds_read_b128 v[184:187], v24 offset:2048
    ds_read_b128 v[188:191], v24 offset:3072
    ds_read_b128 v[192:195], v24 offset:4096
    ds_read_b128 v[196:199], v24 offset:5120
    s_waitcnt vmcnt(16)
tab_chk:
    s_mov_b32 s55, 0
    s_mov_b32 s56, 0
    v_bfe_u32 v11, v13, 0, 8
    v_add_u32 v10, 0, v12
    v_cmp_ne_u32 s[58:59], 0, v11
    v_cmp_gt_u32 s[60:61], s2, v10
    s_bcnt1_i32_b64 s57, s[58:59]
    s_add_u32 s56, s56, s57
    s_and_b64 s[58:59], s[58:59], s[60:61]
    s_bcnt1_i32_b64 s57, s[58:59]
    s_add_u32 s55, s55, s57
    v_bfe_u32 v11, v13, 8, 8
    v_add_u32 v10, 1, v12
    v_cmp_ne_u32 s[58:59], 0, v11
    v_cmp_gt_u32 s[60:61], s2, v10
    s_bcnt1_i32_b64 s57, s[58:59]
    s_add_u32 s56, s56, s57
    s_and_b64 s[58:59], s[58:59], s[60:61]
    s_bcnt1_i32_b64 s57, s[58:59]
    s_add_u32 s55, s55, s57
    v_bfe_u32 v11, v13, 16, 8
    v_add_u32 v10, 2, v12
    v_cmp_ne_u32 s[58:59], 0, v11
    v_cmp_gt_u32 s[60:61], s2, v10
    s_bcnt1_i32_b64 s57, s[58:59]
    s_add_u32 s56, s56, s57
    s_and_b64 s[58:59], s[58:59], s[60:61]
    s_bcnt1_i32_b64 s57, s[58:59]
    s_add_u32 s55, s55, s57
    v_bfe_u32 v11, v13, 24, 8
    v_add_u32 v10, 3, v12
    v_cmp_ne_u32 s[58:59], 0, v11
    v_cmp_gt_u32 s[60:61], s2, v10
    s_bcnt1_i32_b64 s57, s[58:59]
    s_add_u32 s56, s56, s57
    s_and_b64 s[58:59], s[58:59], s[60:61]
    s_bcnt1_i32_b64 s57, s[58:59]
    s_add_u32 s55, s55, s57
    s_cmp_lt_u32 s56, 32
    s_cbranch_scc1 tab_again
    s_cmp_lg_u32 s55, s5
    s_cbranch_scc1 role_bad
    s_waitcnt lgkmcnt(5)
    v_mfma_f32_16x16x32_bf16 v[144:147], v[176:179], v[32:35], 0
    ds_read_b128 v[200:203], v24 offset:6144
    buffer_load_dwordx4 v[224:227], v7, s[8:11], s42 offen sc1
    v_mfma_f32_16x16x32_bf16 v[148:151], v[176:179], v[88:91], 0
    s_waitcnt lgkmcnt(5)
    ds_read_b128 v[204:207], v24 offset:7168
    v_and_b32 v25, 31, v0
    v_mfma_f32_16x16x32_bf16 v[152:155], v[180:183], v[32:35], 0
    v_lshlrev_b32 v25, 4, v25
    v_lshrrev_b32 v26, 5, v0
    v_mfma_f32_16x16x32_bf16 v[156:159], v[180:183], v[88:91], 0
    s_waitcnt lgkmcnt(5)
    buffer_load_dwordx4 v[228:231], v6, s[8:11], s42 offen offset:3584 sc1
    v_lshl_add_u32 v25, v26, 11, v25
    v_mfma_f32_16x16x32_bf16 v[144:147], v[184:187], v[36:39], v[144:147]
    s_add_u32 m0, s53, 24576
    ds_read_b128 v[176:179], v24 offset:8192
    v_mul_f32 v248, v248, v250
    v_mfma_f32_16x16x32_bf16 v[148:151], v[184:187], v[92:95], v[148:151]
    s_waitcnt lgkmcnt(5)
    ds_read_b128 v[180:183], v24 offset:9216
    v_mul_f32 v249, v249, v251
    v_mfma_f32_16x16x32_bf16 v[152:155], v[188:191], v[36:39], v[152:155]
    s_add_u32 s72, s76, 24576
    buffer_load_dwordx4 v1, s[8:11], s72 offen sc1 lds
    v_fma_f32 v208, v248, v16, s67
    v_mfma_f32_16x16x32_bf16 v[156:159], v[188:191], v[92:95], v[156:159]
    s_waitcnt lgkmcnt(5)
    v_fma_f32 v209, v248, v17, s67
    v_fma_f32 v210, v248, v18, s67
    v_mfma_f32_16x16x32_bf16 v[144:147], v[192:195], v[40:43], v[144:147]
    s_add_u32 s93, s77, 4096
    ds_read_b128 v[184:187], v24 offset:10240
    v_fma_f32 v211, v248, v19, s67
    v_mfma_f32_16x16x32_bf16 v[148:151], v[192:195], v[96:99], v[148:151]
    s_waitcnt lgkmcnt(5)
    ds_read_b128 v[188:191], v24 offset:11264
    buffer_load_dwordx4 a[24:27], v1, s[8:11], s93 offen offset:2048 sc1
    v_mfma_f32_16x16x32_bf16 v[152:155], v[196:199], v[40:43], v[152:155]
    s_add_u32 m0, s53, 28672
    v_fma_f32 v212, v249, v16, s67
    v_fma_f32 v213, v249, v17, s67
    v_mfma_f32_16x16x32_bf16 v[156:159], v[196:199], v[96:99], v[156:159]
    s_waitcnt lgkmcnt(5)
    v_fma_f32 v214, v249, v18, s67
    v_fma_f32 v215, v249, v19, s67
    v_mfma_f32_16x16x32_bf16 v[144:147], v[200:203], v[44:47], v[144:147]
    s_add_u32 s72, s76, 28672
    ds_read_b128 v[192:195], v24 offset:12288
    buffer_load_dwordx4 v1, s[8:11], s72 offen sc1 lds
    v_mfma_f32_16x16x32_bf16 v[148:151], v[200:203], v[100:103], v[148:151]
    s_waitcnt lgkmcnt(5)
    ds_read_b128 v[196:199], v24 offset:13312
    v_fma_f32 v216, v248, v20, s67
    v_mfma_f32_16x16x32_bf16 v[152:155], v[204:207], v[44:47], v[152:155]
    s_add_u32 s93, s77, 4096
    v_fma_f32 v217, v248, v21, s67
    v_fma_f32 v218, v248, v22, s67
    v_mfma_f32_16x16x32_bf16 v[156:159], v[204:207], v[100:103], v[156:159]
    s_waitcnt lgkmcnt(5)
    buffer_load_dwordx4 a[28:31], v1, s[8:11], s93 offen offset:3072 sc1
    v_fma_f32 v219, v248, v23, s67
    v_mfma_f32_16x16x32_bf16 v[144:147], v[176:179], v[48:51], v[144:147]
    s_add_u32 m0, s69, 98304
    ds_read_b128 v[200:203], v24 offset:14336
    v_fma_f32 v220, v249, v20, s67
    v_mfma_f32_16x16x32_bf16 v[148:151], v[176:179], v[104:107], v[148:151]
    s_waitcnt lgkmcnt(5)
    ds_read_b128 v[204:207], v24 offset:15360
    v_fma_f32 v221, v249, v21, s67
    v_mfma_f32_16x16x32_bf16 v[152:155], v[180:183], v[48:51], v[152:155]
    s_add_u32 s72, s68, 98304
    buffer_load_dwordx4 v1, s[8:11], s72 offen sc1 lds
    v_fma_f32 v222, v249, v22, s67
    v_mfma_f32_16x16x32_bf16 v[156:159], v[180:183], v[104:107], v[156:159]
    s_waitcnt lgkmcnt(5)
    v_fma_f32 v223, v249, v23, s67
    v_and_b32 v28, 1, v3
    v_mfma_f32_16x16x32_bf16 v[144:147], v[184:187], v[52:55], v[144:147]
    s_add_u32 s93, s77, 8192
    ds_read_b128 v[176:179], v24 offset:16384
    v_lshlrev_b32 v28, 2, v28
    v_mfma_f32_16x16x32_bf16 v[148:151], v[184:187], v[108:111], v[148:151]
    s_waitcnt lgkmcnt(5)
    ds_read_b128 v[180:183], v24 offset:17408
    buffer_load_dwordx4 a[32:35], v1, s[8:11], s93 offen offset:0 sc1
    v_mfma_f32_16x16x32_bf16 v[152:155], v[188:191], v[52:55], v[152:155]
    s_add_u32 s93, s77, 8192
    v_lshrrev_b32 v29, 1, v2
    v_xor_b32 v28, v28, v29
    v_mfma_f32_16x16x32_bf16 v[156:159], v[188:191], v[108:111], v[156:159]
    s_waitcnt lgkmcnt(5)
    v_and_b32 v29, 1, v2
    v_lshlrev_b32 v29, 4, v29
    s_barrier
    buffer_load_dwordx4 a[36:39], v1, s[8:11], s93 offen offset:1024 sc1
    v_mfma_f32_16x16x32_bf16 v[144:147], v[192:195], v[56:59], v[144:147]
    s_add_u32 m0, s53, 129024
    ds_read_b128 v[184:187], v24 offset:18432
    s_add_u32 s72, s75, 28672
    v_mfma_f32_16x16x32_bf16 v[148:151], v[192:195], v[112:115], v[148:151]
    s_waitcnt lgkmcnt(5)
    ds_read_b128 v[188:191], v24 offset:19456
    v_mov_b32 v30, 0x3f80
    v_mfma_f32_16x16x32_bf16 v[152:155], v[196:199], v[56:59], v[152:155]
    v_lshlrev_b32 v29, v29, v30
    v_cmp_eq_u32 s[56:57], 0, v28
    v_mfma_f32_16x16x32_bf16 v[156:159], v[196:199], v[112:115], v[156:159]
    s_waitcnt lgkmcnt(5)
    buffer_load_dwordx4 v1, s[8:11], s72 offen sc1 lds
    s_nop 0
    v_mfma_f32_16x16x32_bf16 v[144:147], v[200:203], v[60:63], v[144:147]
    s_add_u32 m0, s53, 133120
    ds_read_b128 v[192:195], v24 offset:20480
    s_nop 0
    v_mfma_f32_16x16x32_bf16 v[148:151], v[200:203], v[116:119], v[148:151]
    s_waitcnt lgkmcnt(5)
    ds_read_b128 v[196:199], v24 offset:21504
    v_cndmask_b32 v252, 0, v29, s[56:57]
    v_mfma_f32_16x16x32_bf16 v[152:155], v[204:207], v[60:63], v[152:155]
    s_add_u32 s72, s75, 32768
    buffer_load_dwordx4 v1, s[8:11], s72 offen sc1 lds
    v_cmp_eq_u32 s[58:59], 1, v28
    v_mfma_f32_16x16x32_bf16 v[156:159], v[204:207], v[116:119], v[156:159]
    s_waitcnt lgkmcnt(5)
    s_nop 0
    s_nop 0
    v_mfma_f32_16x16x32_bf16 v[144:147], v[176:179], v[64:67], v[144:147]
    s_add_u32 m0, s53, 137216
    ds_read_b128 v[200:203], v24 offset:22528
    v_cndmask_b32 v253, 0, v29, s[58:59]
    v_mfma_f32_16x16x32_bf16 v[148:151], v[176:179], v[120:123], v[148:151]
    s_waitcnt lgkmcnt(5)
    ds_read_b128 v[204:207], v24 offset:23552
    s_add_u32 s72, s75, 36864
    v_mfma_f32_16x16x32_bf16 v[152:155], v[180:183], v[64:67], v[152:155]
    v_cmp_eq_u32 s[56:57], 2, v28
    s_nop 0
    v_mfma_f32_16x16x32_bf16 v[156:159], v[180:183], v[120:123], v[156:159]
    s_waitcnt lgkmcnt(5)
    s_nop 0
    v_cndmask_b32 v254, 0, v29, s[56:57]
    v_mfma_f32_16x16x32_bf16 v[144:147], v[184:187], v[68:71], v[144:147]
    ds_read_b128 v[176:179], v24 offset:24576
    buffer_load_dwordx4 v1, s[8:11], s72 offen sc1 lds
    v_mfma_f32_16x16x32_bf16 v[148:151], v[184:187], v[124:127], v[148:151]
    s_waitcnt lgkmcnt(5)
    ds_read_b128 v[180:183], v24 offset:25600
    v_cmp_eq_u32 s[58:59], 3, v28
    v_mfma_f32_16x16x32_bf16 v[152:155], v[188:191], v[68:71], v[152:155]
    s_add_u32 m0, s53, 141312
    s_nop 0
    s_nop 0
    v_mfma_f32_16x16x32_bf16 v[156:159], v[188:191], v[124:127], v[156:159]
    s_waitcnt lgkmcnt(5)
    s_add_u32 s72, s75, 40960
    buffer_load_dwordx4 v1, s[8:11], s72 offen sc1 lds
    v_mfma_f32_16x16x32_bf16 v[144:147], v[192:195], v[72:75], v[144:147]
    s_add_u32 m0, s53, 100352
    ds_read_b128 v[184:187], v24 offset:26624
    v_cndmask_b32 v255, 0, v29, s[58:59]
    v_mfma_f32_16x16x32_bf16 v[148:151], v[192:195], v[128:131], v[148:151]
    s_waitcnt lgkmcnt(5)
    ds_read_b128 v[188:191], v24 offset:27648
    v_mfma_f32_16x16x32_bf16 v[152:155], v[196:199], v[72:75], v[152:155]
    s_add_u32 s72, s75, 0
    buffer_load_dwordx4 v1, s[8:11], s72 offen sc1 lds
    v_mfma_f32_16x16x32_bf16 v[156:159], v[196:199], v[128:131], v[156:159]
    s_waitcnt lgkmcnt(5)
    v_mfma_f32_16x16x32_bf16 v[144:147], v[200:203], v[76:79], v[144:147]
    s_add_u32 m0, s53, 104448
    v_mfma_f32_16x16x32_bf16 v[148:151], v[200:203], v[132:135], v[148:151]
    s_waitcnt lgkmcnt(4)
    s_add_u32 s72, s75, 4096
    buffer_load_dwordx4 v1, s[8:11], s72 offen sc1 lds
    v_mfma_f32_16x16x32_bf16 v[152:155], v[204:207], v[76:79], v[152:155]
    s_add_u32 m0, s53, 108544
    v_mfma_f32_16x16x32_bf16 v[156:159], v[204:207], v[132:135], v[156:159]
    s_waitcnt lgkmcnt(3)
    v_mfma_f32_16x16x32_bf16 v[144:147], v[176:179], v[80:83], v[144:147]
    s_add_u32 s72, s75, 8192
    buffer_load_dwordx4 v1, s[8:11], s72 offen sc1 lds
    v_mfma_f32_16x16x32_bf16 v[148:151], v[176:179], v[136:139], v[148:151]
    s_waitcnt lgkmcnt(2)
    v_mfma_f32_16x16x32_bf16 v[152:155], v[180:183], v[80:83], v[152:155]
    s_add_u32 s93, s77, 8192
    v_mfma_f32_16x16x32_bf16 v[156:159], v[180:183], v[136:139], v[156:159]
    s_waitcnt lgkmcnt(1)
    buffer_load_dwordx4 a[40:43], v1, s[8:11], s93 offen offset:2048 sc1
    v_mfma_f32_16x16x32_bf16 v[144:147], v[184:187], v[84:87], v[144:147]
    s_add_u32 s93, s77, 8192
    v_mfma_f32_16x16x32_bf16 v[148:151], v[184:187], v[140:143], v[148:151]
    s_waitcnt lgkmcnt(0)
    v_mfma_f32_16x16x32_bf16 v[152:155], v[188:191], v[84:87], v[152:155]
    buffer_load_dwordx4 a[44:47], v1, s[8:11], s93 offen offset:3072 sc1
    v_mfma_f32_16x16x32_bf16 v[156:159], v[188:191], v[140:143], v[156:159]
    s_add_u32 s93, s77, 12288
    s_nop 0
    v_fma_f32 v144, v144, v250, v208
    v_fma_f32 v145, v145, v250, v209
    buffer_load_dwordx4 a[48:51], v1, s[8:11], s93 offen offset:0 sc1
    v_fma_f32 v146, v146, v250, v210
    v_fma_f32 v147, v147, v250, v211
    v_fma_f32 v148, v148, v251, v212
    s_add_u32 s93, s77, 12288
    buffer_load_dwordx4 a[52:55], v1, s[8:11], s93 offen offset:1024 sc1
    v_fma_f32 v149, v149, v251, v213
    v_fma_f32 v150, v150, v251, v214
    v_fma_f32 v151, v151, v251, v215
    s_add_u32 s93, s77, 12288
    buffer_load_dwordx4 a[56:59], v1, s[8:11], s93 offen offset:2048 sc1
    v_fma_f32 v152, v152, v250, v216
    v_fma_f32 v153, v153, v250, v217
    v_fma_f32 v154, v154, v250, v218
    s_add_u32 s93, s77, 12288
    buffer_load_dwordx4 a[60:63], v1, s[8:11], s93 offen offset:3072 sc1
    v_fma_f32 v155, v155, v250, v219
    v_fma_f32 v156, v156, v251, v220
    v_fma_f32 v157, v157, v251, v221
    s_add_u32 s93, s77, 16384
    buffer_load_dwordx4 a[64:67], v1, s[8:11], s93 offen offset:0 sc1
    v_fma_f32 v158, v158, v251, v222
    v_fma_f32 v159, v159, v251, v223
    v_pk_mul_f32 v[192:193], v[144:145], s[64:65]
    s_add_u32 s93, s77, 16384
    buffer_load_dwordx4 a[68:71], v1, s[8:11], s93 offen offset:1024 sc1
    v_pk_mul_f32 v[194:195], v[146:147], s[64:65]
    v_pk_mul_f32 v[196:197], v[148:149], s[64:65]
    v_pk_mul_f32 v[198:199], v[150:151], s[64:65]
    s_add_u32 s93, s77, 16384
    buffer_load_dwordx4 a[72:75], v1, s[8:11], s93 offen offset:2048 sc1
    v_pk_mul_f32 v[200:201], v[152:153], s[64:65]
    v_pk_mul_f32 v[202:203], v[154:155], s[64:65]
    v_pk_mul_f32 v[204:205], v[156:157], s[64:65]
    s_add_u32 s93, s77, 16384
    buffer_load_dwordx4 a[76:79], v1, s[8:11], s93 offen offset:3072 sc1
    v_pk_mul_f32 v[206:207], v[158:159], s[64:65]
    v_exp_f32 v192, v192 clamp
    v_max_f32 v144, s67, v144
    s_add_u32 s93, s77, 20480
    buffer_load_dwordx4 a[80:83], v1, s[8:11], s93 offen offset:0 sc1
    v_exp_f32 v193, v193 clamp
    v_max_f32 v145, s67, v145
    v_exp_f32 v194, v194 clamp
    s_add_u32 s93, s77, 20480
    buffer_load_dwordx4 a[84:87], v1, s[8:11], s93 offen offset:1024 sc1
    v_max_f32 v146, s67, v146
    v_exp_f32 v195, v195 clamp
    v_max_f32 v147, s67, v147
    s_add_u32 s93, s77, 20480
    buffer_load_dwordx4 a[88:91], v1, s[8:11], s93 offen offset:2048 sc1
    v_exp_f32 v196, v196 clamp
    v_max_f32 v148, s67, v148
    v_exp_f32 v197, v197 clamp
    s_add_u32 s93, s77, 20480
    buffer_load_dwordx4 a[92:95], v1, s[8:11], s93 offen offset:3072 sc1
    v_max_f32 v149, s67, v149
    v_exp_f32 v198, v198 clamp
    v_max_f32 v150, s67, v150
    v_exp_f32 v199, v199 clamp
    v_max_f32 v151, s67, v151
    v_exp_f32 v200, v200 clamp
    v_max_f32 v152, s67, v152
    v_exp_f32 v201, v201 clamp
    v_max_f32 v153, s67, v153
    v_exp_f32 v202, v202 clamp
    v_max_f32 v154, s67, v154
    v_exp_f32 v203, v203 clamp
    v_max_f32 v155, s67, v155
    v_exp_f32 v204, v204 clamp
    v_max_f32 v156, s67, v156
    v_exp_f32 v205, v205 clamp
    v_max_f32 v157, s67, v157
    v_exp_f32 v206, v206 clamp
    v_max_f32 v158, s67, v158
    v_exp_f32 v207, v207 clamp
    v_max_f32 v159, s67, v159
    v_pk_add_f32 v[144:145], v[144:145], v[192:193]
    v_pk_add_f32 v[146:147], v[146:147], v[194:195]
    v_pk_add_f32 v[148:149], v[148:149], v[196:197]
    v_pk_add_f32 v[150:151], v[150:151], v[198:199]
    v_pk_add_f32 v[152:153], v[152:153], v[200:201]
    v_pk_add_f32 v[154:155], v[154:155], v[202:203]
    v_pk_add_f32 v[156:157], v[156:157], v[204:205]
    v_pk_add_f32 v[158:159], v[158:159], v[206:207]
    v_cvt_pk_bf16_f32 v160, v144, v145
    v_cvt_pk_bf16_f32 v161, v146, v147
    v_cvt_pk_bf16_f32 v164, v148, v149
    v_cvt_pk_bf16_f32 v165, v150, v151
    v_cvt_pk_bf16_f32 v162, v152, v153
    v_cvt_pk_bf16_f32 v163, v154, v155
    v_cvt_pk_bf16_f32 v166, v156, v157
    v_cvt_pk_bf16_f32 v167, v158, v159
    s_lshr_b32 s52, s3, 1
    s_lshl_b32 s52, s52, 10
    s_and_b32 s55, s3, 1
    s_lshl_b32 s55, s55, 3
    s_add_u32 s52, s52, s55
    s_add_u32 s52, s52, 158720
    v_lshlrev_b32 v31, 5, v2
    v_lshrrev_b32 v30, 5, v0
    v_lshl_add_u32 v31, v30, 9, v31
    v_and_b32 v30, 1, v3
    v_lshl_add_u32 v31, v30, 4, v31
    v_add_u32 v31, s52, v31
    s_waitcnt vmcnt(28)
    v_pk_add_f32 v[224:225], v[224:225], v[228:229]
    v_pk_add_f32 v[226:227], v[226:227], v[230:231]
    v_min_u32 v7, 3584, v7
    v_add_u32 v7, 94208, v7
    ds_write_b128 v7, v[224:227]
    s_waitcnt lgkmcnt(0)
    v_add_u32 v28, 158720, v1
    s_mul_i32 s52, s28, 7
    v_lshl_add_u32 v29, v3, 1, s52
    v_lshrrev_b32 v26, 1, v29
    v_lshlrev_b32 v26, 8, v26
    v_and_b32 v30, 1, v29
    v_lshl_add_u32 v26, v30, 3, v26
    v_lshl_add_u32 v26, v2, 4, v26
    v_add_u32 v29, 1, v29
    v_lshrrev_b32 v27, 1, v29
    v_lshlrev_b32 v27, 8, v27
    v_and_b32 v30, 1, v29
    v_lshl_add_u32 v27, v30, 3, v27
    v_lshl_add_u32 v27, v2, 4, v27
    v_mov_b32 v29, 0x7ffffff0
    v_cmp_ne_u32 vcc, 3, v3
    s_nop 1
    v_cndmask_b32 v27, v29, v27, vcc
    s_mul_i32 s86, s30, 28672
    s_add_u32 s86, s86, 8388608
    s_add_u32 s87, s86, 14336
    s_and_b32 s52, s30, 7
    s_lshl_b32 s52, s52, 6
    s_lshl_b32 s55, s28, 2
    s_add_u32 s52, s52, s55
    s_add_u32 s92, s52, s78
    s_add_u32 s85, s83, 0
    buffer_load_dwordx4 v[224:227], v25, s[8:11], s85 offen sc1
    s_add_u32 s85, s83, 4096
    buffer_load_dwordx4 v[228:231], v25, s[8:11], s85 offen sc1
    s_add_u32 s85, s83, 8192
    buffer_load_dwordx4 v[232:235], v25, s[8:11], s85 offen sc1
    s_add_u32 s85, s83, 12288
    buffer_load_dwordx4 v[236:239], v25, s[8:11], s85 offen sc1
    s_add_u32 s85, s83, 16384
    buffer_load_dwordx4 v[240:243], v25, s[8:11], s85 offen sc1
    s_add_u32 s85, s83, 20480
    buffer_load_dwordx4 v[244:247], v25, s[8:11], s85 offen sc1
    s_add_u32 s85, s83, 24576
    buffer_load_dwordx4 v[168:171], v25, s[8:11], s85 offen sc1
    s_add_u32 s85, s83, 28672
    buffer_load_dwordx4 v[172:175], v25, s[8:11], s85 offen sc1
    s_barrier
    s_add_u32 m0, s53, 112640
    s_add_u32 s72, s75, 12288
    buffer_load_dwordx4 v1, s[8:11], s72 offen sc1 lds
    s_add_u32 m0, s53, 116736
    s_add_u32 s72, s75, 16384
    buffer_load_dwordx4 v1, s[8:11], s72 offen sc1 lds
    s_add_u32 m0, s53, 120832
    s_add_u32 s72, s75, 20480
    buffer_load_dwordx4 v1, s[8:11], s72 offen sc1 lds
    s_add_u32 m0, s53, 124928
    s_add_u32 s72, s75, 24576
    buffer_load_dwordx4 v1, s[8:11], s72 offen sc1 lds
    v_add_u32 v7, 94208, v9
    v_add_u32 v8, 160768, v9
    ds_read_b32 v72, v7 offset:0
    ds_read_b32 v73, v7 offset:448
    ds_read_b32 v74, v7 offset:896
    ds_read_b32 v75, v7 offset:1344
    ds_read_b32 v76, v7 offset:1792
    ds_read_b32 v77, v7 offset:2240
    ds_read_b32 v78, v7 offset:2688
    ds_read_b32 v79, v7 offset:3136
    s_waitcnt lgkmcnt(6)
    v_add_f32 v72, v72, v73
    s_waitcnt lgkmcnt(5)
    v_add_f32 v72, v72, v74
    s_waitcnt lgkmcnt(4)
    v_add_f32 v72, v72, v75
    s_waitcnt lgkmcnt(3)
    v_add_f32 v72, v72, v76
    s_waitcnt lgkmcnt(2)
    v_add_f32 v72, v72, v77
    s_waitcnt lgkmcnt(1)
    v_add_f32 v72, v72, v78
    s_waitcnt lgkmcnt(0)
    v_add_f32 v72, v72, v79
    ds_write_b32 v8, v72
g_retry0:
    s_waitcnt vmcnt(11)
    v_mfma_f32_16x16x32_bf16 v[64:67], v[252:255], v[224:227], 0
    s_waitcnt vmcnt(10)
    v_mfma_f32_16x16x32_bf16 v[64:67], v[252:255], v[228:231], v[64:67]
    s_waitcnt vmcnt(9)
    v_mfma_f32_16x16x32_bf16 v[64:67], v[252:255], v[232:235], v[64:67]
    s_waitcnt vmcnt(8)
    v_mfma_f32_16x16x32_bf16 v[64:67], v[252:255], v[236:239], v[64:67]
    s_waitcnt vmcnt(7)
    v_mfma_f32_16x16x32_bf16 v[64:67], v[252:255], v[240:243], v[64:67]
    s_waitcnt vmcnt(6)
    v_mfma_f32_16x16x32_bf16 v[64:67], v[252:255], v[244:247], v[64:67]
    s_waitcnt vmcnt(5)
    v_mfma_f32_16x16x32_bf16 v[64:67], v[252:255], v[168:171], v[64:67]
    s_waitcnt vmcnt(4)
    v_mfma_f32_16x16x32_bf16 v[64:67], v[252:255], v[172:175], v[64:67]
    s_nop 7
    v_cmp_u_f32 vcc, v64, v65
    v_cmp_u_f32 s[56:57], v66, v67
    s_nop 0
    s_or_b64 vcc, vcc, s[56:57]
    s_cbranch_vccnz g_again0
g_ok0:
    v_cvt_pk_bf16_f32 v32, v64, v65
    v_cvt_pk_bf16_f32 v33, v66, v67
    ds_write_b64 v31, v[32:33]
    s_waitcnt lgkmcnt(0)
    s_barrier
    ds_read_b128 v[96:99], v28 offset:0
    ds_read_b128 v[100:103], v28 offset:1024
    s_waitcnt lgkmcnt(1)
    v_mfma_f32_16x16x32_bf16 v[104:107], v[96:99], v[160:163], 0
    v_mfma_f32_16x16x32_bf16 v[112:115], v[96:99], v[164:167], 0
    s_waitcnt lgkmcnt(0)
    v_mfma_f32_16x16x32_bf16 v[108:111], v[100:103], v[160:163], 0
    v_mfma_f32_16x16x32_bf16 v[116:119], v[100:103], v[164:167], 0
    s_nop 3
    v_mov_b32 v120, v106
    v_mov_b32 v121, v106
    v_mov_b32 v124, v114
    v_mov_b32 v125, v114
    v_permlane32_swap_b32 v120, v121
    s_nop 0
    v_permlane32_swap_b32 v124, v125
    v_mov_b32 v120, v121
    v_mov_b32 v124, v125
    s_nop 0
    v_permlane16_swap_b32 v121, v120
    v_permlane16_swap_b32 v125, v124
    v_add_f32 v120, s67, v120
    v_add_f32 v124, s67, v124
    v_rcp_f32 v120, v120
    v_rcp_f32 v124, v124
    v_pk_mul_f32 v[104:105], v[104:105], v[120:121] op_sel_hi:[1,0]
    v_pk_mul_f32 v[106:107], v[106:107], v[120:121] op_sel_hi:[1,0]
    v_pk_mul_f32 v[108:109], v[108:109], v[120:121] op_sel_hi:[1,0]
    v_pk_mul_f32 v[110:111], v[110:111], v[120:121] op_sel_hi:[1,0]
    v_cvt_pk_bf16_f32 v104, v104, v108
    v_cvt_pk_bf16_f32 v105, v105, v109
    v_cvt_pk_bf16_f32 v106, v106, v110
    v_cvt_pk_bf16_f32 v107, v107, v111
    buffer_store_dwordx2 v[104:105], v26, s[8:11], s86 offen
    buffer_store_dwordx2 v[106:107], v27, s[8:11], s86 offen
    v_pk_mul_f32 v[112:113], v[112:113], v[124:125] op_sel_hi:[1,0]
    v_pk_mul_f32 v[114:115], v[114:115], v[124:125] op_sel_hi:[1,0]
    v_pk_mul_f32 v[116:117], v[116:117], v[124:125] op_sel_hi:[1,0]
    v_pk_mul_f32 v[118:119], v[118:119], v[124:125] op_sel_hi:[1,0]
    v_cvt_pk_bf16_f32 v112, v112, v116
    v_cvt_pk_bf16_f32 v113, v113, v117
    v_cvt_pk_bf16_f32 v114, v114, v118
    v_cvt_pk_bf16_f32 v115, v115, v119
    buffer_store_dwordx2 v[112:113], v26, s[8:11], s87 offen
    buffer_store_dwordx2 v[114:115], v27, s[8:11], s87 offen
    v_lshlrev_b32 v28, 9, v3
    v_lshl_add_u32 v28, v2, 4, v28
    s_mul_i32 s52, s31, 14336
    s_min_u32 s55, s7, 6
    s_lshl_b32 s55, s55, 11
    s_add_u32 s52, s52, s55
    s_add_u32 s52, s52, 10223616
    buffer_load_dwordx4 v[6:9], v28, s[8:11], s52 offen offset:0 sc1
    buffer_load_dwordx4 v[10:13], v28, s[8:11], s52 offen offset:256 sc1
    v_add_u32 v29, 100352, v1
    ds_read_b128 v[32:35], v29 offset:28672
    ds_read_b128 v[36:39], v29 offset:29696
    ds_read_b128 v[40:43], v29 offset:30720
    ds_read_b128 v[44:47], v29 offset:31744
    ds_read_b128 v[48:51], v29 offset:32768
    ds_read_b128 v[52:55], v29 offset:33792
    ds_read_b128 v[56:59], v29 offset:34816
    ds_read_b128 v[60:63], v29 offset:35840
    ds_read_b128 v[64:67], v29 offset:36864
    ds_read_b128 v[68:71], v29 offset:37888
    ds_read_b128 v[72:75], v29 offset:38912
    ds_read_b128 v[76:79], v29 offset:39936
    ds_read_b128 v[80:83], v29 offset:40960
    ds_read_b128 v[84:87], v29 offset:41984
    ds_read_b128 v[88:91], v29 offset:43008
    ds_read_b128 v[92:95], v29 offset:44032
    v_lshlrev_b32 v24, 2, v2
    s_bfe_u32 s52, s31, 196609
    s_lshl_b32 s52, s52, 6
    s_add_u32 s79, s52, s78
    s_mul_i32 s80, s31, 14336
    s_add_u32 s32, s80, 8388608
    s_add_u32 s33, s32, 4096
    s_add_u32 s34, s32, 8192
    s_add_u32 s35, s32, 12288
    s_waitcnt vmcnt(2)
    buffer_store_dword v4, v5, s[8:11], s92 offen
    ds_read_b128 v[96:99], v29 offset:45056
    ds_read_b128 v[100:103], v29 offset:46080
    ds_read_b128 v[104:107], v29 offset:47104
    ds_read_b128 v[108:111], v29 offset:48128
    ds_read_b128 v[112:115], v29 offset:49152
    ds_read_b128 v[116:119], v29 offset:50176
    ds_read_b128 v[120:123], v29 offset:51200
    ds_read_b128 v[124:127], v29 offset:52224
    ds_read_b128 v[128:131], v29 offset:53248
    ds_read_b128 v[132:135], v29 offset:54272
    ds_read_b128 v[136:139], v29 offset:55296
    ds_read_b128 v[140:143], v29 offset:56320
    s_barrier
    buffer_load_dword v25, v24, s[8:11], s79 offen sc1
    s_cmp_ge_u32 s5, 28
    s_cbranch_scc1 wo_idle0
    ds_read_b128 v[144:147], v29 offset:0
    ds_read_b128 v[148:151], v29 offset:1024
    ds_read_b128 v[152:155], v29 offset:2048
    ds_read_b128 v[156:159], v29 offset:3072
    ds_read_b128 v[160:163], v29 offset:4096
    ds_read_b128 v[164:167], v29 offset:5120
    ds_read_b128 v[168:171], v29 offset:6144
    ds_read_b128 v[172:175], v29 offset:7168
    v_lshlrev_b32 v30, 9, v3
    v_lshl_add_u32 v30, v2, 4, v30
    s_mul_i32 s47, s31, 14336
    s_lshl_b32 s56, s7, 11
    s_add_u32 s47, s47, s56
    s_add_u32 s47, s47, 10223616
    v_lshrrev_b32 v31, 5, v0
    v_lshlrev_b32 v31, 2, v31
    v_lshl_add_u32 v31, v2, 3, v31
    s_lshl_b32 s48, s7, 14
    s_lshl_b32 s56, s31, 7
    s_add_u32 s48, s48, s56
    s_add_u32 s48, s48, 6029312
    s_lshl_b32 s49, s6, 7
    s_lshl_b32 s56, s7, 4
    s_add_u32 s49, s49, s56
    s_lshl_b32 s56, s3, 2
    s_add_u32 s49, s49, s56
    s_add_u32 s49, s49, 512
    s_add_u32 s49, s49, s78
    s_mov_b32 s70, 0x3f803f80
    s_waitcnt vmcnt(3)
    v_lshlrev_b32 v176, 16, v6
    v_and_b32 v180, 0xffff0000, v6
    v_lshlrev_b32 v184, 16, v7
    v_and_b32 v188, 0xffff0000, v7
    v_lshlrev_b32 v177, 16, v8
    v_and_b32 v181, 0xffff0000, v8
    v_lshlrev_b32 v185, 16, v9
    v_and_b32 v189, 0xffff0000, v9
    s_waitcnt vmcnt(2)
    v_lshlrev_b32 v178, 16, v10
    v_and_b32 v182, 0xffff0000, v10
    v_lshlrev_b32 v186, 16, v11
    v_and_b32 v190, 0xffff0000, v11
    v_lshlrev_b32 v179, 16, v12
    v_and_b32 v183, 0xffff0000, v12
    v_lshlrev_b32 v187, 16, v13
    v_and_b32 v191, 0xffff0000, v13
    s_waitcnt vmcnt(0)
    v_cmp_gt_u32 vcc, 1, v25
    s_nop 0
    s_cbranch_vccz spin1_ok
spin1:
    buffer_load_dword v25, v24, s[8:11], s79 offen sc1
    s_waitcnt vmcnt(0)
    v_cmp_gt_u32 vcc, 1, v25
    s_nop 0
    s_cbranch_vccz spin1_ok
    s_cmp_eq_u32 s98, 0
    s_cbranch_scc1 spin1_ok
    s_sub_u32 s98, s98, 1
    s_branch spin1
spin1_ok:
    buffer_load_dwordx4 v[192:195], v1, s[8:11], s33 offen offset:3072 sc1
    buffer_load_dwordx4 v[196:199], v1, s[8:11], s34 offen offset:0 sc1
    buffer_load_dwordx4 v[200:203], v1, s[8:11], s34 offen offset:1024 sc1
    buffer_load_dwordx4 v[204:207], v1, s[8:11], s34 offen offset:2048 sc1
    buffer_load_dwordx4 v[208:211], v1, s[8:11], s34 offen offset:3072 sc1
    buffer_load_dwordx4 v[212:215], v1, s[8:11], s35 offen offset:0 sc1
    buffer_load_dwordx4 v[216:219], v1, s[8:11], s35 offen offset:1024 sc1
    s_waitcnt vmcnt(6)
    s_waitcnt lgkmcnt(15)
    v_mfma_f32_16x16x32_bf16 v[176:179], v[32:35], v[192:195], v[176:179]
    buffer_load_dwordx4 v[220:223], v1, s[8:11], s32 offen offset:0 sc1
    v_mfma_f32_16x16x32_bf16 v[180:183], v[36:39], v[192:195], v[180:183]
    v_mfma_f32_16x16x32_bf16 v[184:187], v[40:43], v[192:195], v[184:187]
    v_mfma_f32_16x16x32_bf16 v[188:191], v[44:47], v[192:195], v[188:191]
    s_waitcnt vmcnt(6)
    buffer_load_dwordx4 v[224:227], v1, s[8:11], s32 offen offset:1024 sc1
    ds_read_b128 v[32:35], v29 offset:8192
    v_mfma_f32_16x16x32_bf16 v[176:179], v[48:51], v[196:199], v[176:179]
    ds_read_b128 v[36:39], v29 offset:9216
    v_mfma_f32_16x16x32_bf16 v[180:183], v[52:55], v[196:199], v[180:183]
    ds_read_b128 v[40:43], v29 offset:10240
    v_mfma_f32_16x16x32_bf16 v[184:187], v[56:59], v[196:199], v[184:187]
    buffer_load_dwordx4 v[228:231], v1, s[8:11], s32 offen offset:2048 sc1
    ds_read_b128 v[44:47], v29 offset:11264
    v_mfma_f32_16x16x32_bf16 v[188:191], v[60:63], v[196:199], v[188:191]
    s_waitcnt vmcnt(7)
    ds_read_b128 v[48:51], v29 offset:12288
    v_mfma_f32_16x16x32_bf16 v[176:179], v[64:67], v[200:203], v[176:179]
    ds_read_b128 v[52:55], v29 offset:13312
    v_mfma_f32_16x16x32_bf16 v[180:183], v[68:71], v[200:203], v[180:183]
    buffer_load_dwordx4 v[232:235], v1, s[8:11], s32 offen offset:3072 sc1
    ds_read_b128 v[56:59], v29 offset:14336
    v_mfma_f32_16x16x32_bf16 v[184:187], v[72:75], v[200:203], v[184:187]
    ds_read_b128 v[60:63], v29 offset:15360
    v_mfma_f32_16x16x32_bf16 v[188:191], v[76:79], v[200:203], v[188:191]
    s_waitcnt vmcnt(7)
    ds_read_b128 v[64:67], v29 offset:16384
    v_mfma_f32_16x16x32_bf16 v[176:179], v[80:83], v[204:207], v[176:179]
    buffer_load_dwordx4 v[236:239], v1, s[8:11], s33 offen offset:0 sc1
    ds_read_b128 v[68:71], v29 offset:17408
    v_mfma_f32_16x16x32_bf16 v[180:183], v[84:87], v[204:207], v[180:183]
    ds_read_b128 v[72:75], v29 offset:18432
    v_mfma_f32_16x16x32_bf16 v[184:187], v[88:91], v[204:207], v[184:187]
    ds_read_b128 v[76:79], v29 offset:19456
    v_mfma_f32_16x16x32_bf16 v[188:191], v[92:95], v[204:207], v[188:191]
    s_waitcnt vmcnt(7)
    buffer_load_dwordx4 v[240:243], v1, s[8:11], s33 offen offset:1024 sc1
    ds_read_b128 v[80:83], v29 offset:20480
    v_mfma_f32_16x16x32_bf16 v[176:179], v[96:99], v[208:211], v[176:179]
    ds_read_b128 v[84:87], v29 offset:21504
    v_mfma_f32_16x16x32_bf16 v[180:183], v[100:103], v[208:211], v[180:183]
    ds_read_b128 v[88:91], v29 offset:22528
    v_mfma_f32_16x16x32_bf16 v[184:187], v[104:107], v[208:211], v[184:187]
    buffer_load_dwordx4 v[244:247], v1, s[8:11], s33 offen offset:2048 sc1
    ds_read_b128 v[92:95], v29 offset:23552
    v_mfma_f32_16x16x32_bf16 v[188:191], v[108:111], v[208:211], v[188:191]
    s_waitcnt vmcnt(8)
    ds_read_b128 v[96:99], v29 offset:24576
    v_mfma_f32_16x16x32_bf16 v[176:179], v[112:115], v[212:215], v[176:179]
    s_waitcnt lgkmcnt(15)
    ds_read_b128 v[100:103], v29 offset:25600
    v_mfma_f32_16x16x32_bf16 v[180:183], v[116:119], v[212:215], v[180:183]
    ds_read_b128 v[104:107], v29 offset:26624
    v_mfma_f32_16x16x32_bf16 v[184:187], v[120:123], v[212:215], v[184:187]
    ds_read_b128 v[108:111], v29 offset:27648
    v_mfma_f32_16x16x32_bf16 v[188:191], v[124:127], v[212:215], v[188:191]
    s_waitcnt vmcnt(7)
    v_mfma_f32_16x16x32_bf16 v[176:179], v[128:131], v[216:219], v[176:179]
    v_mfma_f32_16x16x32_bf16 v[180:183], v[132:135], v[216:219], v[180:183]
    v_mfma_f32_16x16x32_bf16 v[184:187], v[136:139], v[216:219], v[184:187]
    v_mfma_f32_16x16x32_bf16 v[188:191], v[140:143], v[216:219], v[188:191]
    s_waitcnt vmcnt(6)
    v_mfma_f32_16x16x32_bf16 v[176:179], v[144:147], v[220:223], v[176:179]
    v_mfma_f32_16x16x32_bf16 v[180:183], v[148:151], v[220:223], v[180:183]
    v_mfma_f32_16x16x32_bf16 v[184:187], v[152:155], v[220:223], v[184:187]
    v_mfma_f32_16x16x32_bf16 v[188:191], v[156:159], v[220:223], v[188:191]
    s_waitcnt vmcnt(5)
    v_mfma_f32_16x16x32_bf16 v[176:179], v[160:163], v[224:227], v[176:179]
    v_mfma_f32_16x16x32_bf16 v[180:183], v[164:167], v[224:227], v[180:183]
    v_mfma_f32_16x16x32_bf16 v[184:187], v[168:171], v[224:227], v[184:187]
    v_mfma_f32_16x16x32_bf16 v[188:191], v[172:175], v[224:227], v[188:191]
    s_waitcnt vmcnt(4)
    v_mfma_f32_16x16x32_bf16 v[176:179], v[32:35], v[228:231], v[176:179]
    v_mfma_f32_16x16x32_bf16 v[180:183], v[36:39], v[228:231], v[180:183]
    s_waitcnt lgkmcnt(15)
    v_mfma_f32_16x16x32_bf16 v[184:187], v[40:43], v[228:231], v[184:187]
    v_mfma_f32_16x16x32_bf16 v[188:191], v[44:47], v[228:231], v[188:191]
    s_waitcnt vmcnt(3)
    v_mfma_f32_16x16x32_bf16 v[176:179], v[48:51], v[232:235], v[176:179]
    s_waitcnt lgkmcnt(14)
    v_mfma_f32_16x16x32_bf16 v[180:183], v[52:55], v[232:235], v[180:183]
    s_waitcnt lgkmcnt(13)
    v_mfma_f32_16x16x32_bf16 v[184:187], v[56:59], v[232:235], v[184:187]
    s_waitcnt lgkmcnt(12)
    v_mfma_f32_16x16x32_bf16 v[188:191], v[60:63], v[232:235], v[188:191]
    s_waitcnt vmcnt(2) lgkmcnt(11)
    v_mfma_f32_16x16x32_bf16 v[176:179], v[64:67], v[236:239], v[176:179]
    s_waitcnt lgkmcnt(10)
    v_mfma_f32_16x16x32_bf16 v[180:183], v[68:71], v[236:239], v[180:183]
    s_waitcnt lgkmcnt(9)
    v_mfma_f32_16x16x32_bf16 v[184:187], v[72:75], v[236:239], v[184:187]
    s_waitcnt lgkmcnt(8)
    v_mfma_f32_16x16x32_bf16 v[188:191], v[76:79], v[236:239], v[188:191]
    s_waitcnt vmcnt(1) lgkmcnt(7)
    v_mfma_f32_16x16x32_bf16 v[176:179], v[80:83], v[240:243], v[176:179]
    s_waitcnt lgkmcnt(6)
    v_mfma_f32_16x16x32_bf16 v[180:183], v[84:87], v[240:243], v[180:183]
    s_waitcnt lgkmcnt(5)
    v_mfma_f32_16x16x32_bf16 v[184:187], v[88:91], v[240:243], v[184:187]
    s_waitcnt lgkmcnt(4)
    v_mfma_f32_16x16x32_bf16 v[188:191], v[92:95], v[240:243], v[188:191]
    s_waitcnt vmcnt(0) lgkmcnt(3)
    v_mfma_f32_16x16x32_bf16 v[176:179], v[96:99], v[244:247], v[176:179]
    s_waitcnt lgkmcnt(2)
    v_mfma_f32_16x16x32_bf16 v[180:183], v[100:103], v[244:247], v[180:183]
    s_waitcnt lgkmcnt(1)
    v_mfma_f32_16x16x32_bf16 v[184:187], v[104:107], v[244:247], v[184:187]
    s_waitcnt lgkmcnt(0)
    v_mfma_f32_16x16x32_bf16 v[188:191], v[108:111], v[244:247], v[188:191]
    s_nop 3
    v_cvt_pk_bf16_f32 v6, v176, v180
    s_nop 2
    v_cvt_pk_bf16_f32 v7, v184, v188
    v_cvt_pk_bf16_f32 v8, v177, v181
    v_cvt_pk_bf16_f32 v9, v185, v189
    buffer_store_dwordx4 v[6:9], v30, s[8:11], s47 offen offset:0
    v_cvt_pk_bf16_f32 v10, v178, v182
    v_cvt_pk_bf16_f32 v11, v186, v190
    v_cvt_pk_bf16_f32 v12, v179, v183
    v_cvt_pk_bf16_f32 v13, v187, v191
    buffer_store_dwordx4 v[10:13], v30, s[8:11], s47 offen offset:256
    v_dot2_f32_bf16 v24, v6, s70, 0
    v_dot2_f32_bf16 v25, v6, v6, 0
    v_dot2_f32_bf16 v26, v10, s70, 0
    v_dot2_f32_bf16 v27, v10, v10, 0
    v_dot2_f32_bf16 v24, v7, s70, v24
    v_dot2_f32_bf16 v25, v7, v7, v25
    v_dot2_f32_bf16 v26, v11, s70, v26
    v_dot2_f32_bf16 v27, v11, v11, v27
    v_dot2_f32_bf16 v24, v8, s70, v24
    v_dot2_f32_bf16 v25, v8, v8, v25
    v_dot2_f32_bf16 v26, v12, s70, v26
    v_dot2_f32_bf16 v27, v12, v12, v27
    v_dot2_f32_bf16 v24, v9, s70, v24
    v_dot2_f32_bf16 v25, v9, v9, v25
    v_dot2_f32_bf16 v26, v13, s70, v26
    v_dot2_f32_bf16 v27, v13, v13, v27
    s_nop 2
    v_pk_add_f32 v[24:25], v[24:25], v[26:27]
    s_nop 1
    v_permlane32_swap_b32 v24, v25
    v_add_f32 v24, v24, v25
    v_mov_b32 v25, v24
    s_nop 1
    v_permlane16_swap_b32 v24, v25
    v_add_f32 v24, v24, v25
    buffer_store_dword v24, v31, s[8:11], s48 offen
    s_waitcnt vmcnt(0)
    buffer_store_dword v4, v5, s[8:11], s49 offen
wo_done0:
    s_nop 1
    v_min_u32 v24, 27, v0
    v_lshlrev_b32 v24, 2, v24
    s_lshl_b32 s52, s3, 7
    s_add_u32 s52, s52, s78
    s_add_u32 s79, s52, 512
    buffer_load_dword v31, v24, s[8:11], s79 offen sc1
    v_add_u32 v25, 14336, v1
    v_add_u32 v26, 28672, v1
    v_add_u32 v27, 43008, v1
    s_lshl_b32 s88, s4, 2
    s_add_u32 s88, s88, s3
    s_mul_i32 s80, s88, 57344
    s_add_u32 s32, s80, 10223616
    s_add_u32 s33, s32, 4096
    s_add_u32 s34, s32, 8192
    s_add_u32 s35, s32, 12288
    s_lshl_b32 s81, s88, 9
    s_add_u32 s36, s81, 6029312
    s_add_u32 s37, s36, 16384
    s_add_u32 s38, s36, 32768
    s_add_u32 s39, s36, 49152
    s_add_u32 s40, s36, 65536
    s_add_u32 s41, s36, 81920
    s_add_u32 s42, s36, 98304
    v_lshlrev_b32 v28, 3, v0
    v_add_u32 v29, 50176, v1
    v_lshlrev_b32 v30, 4, v3
    v_add_u32 v30, 160768, v30
    s_waitcnt lgkmcnt(0)
    s_barrier
    ds_read_b128 v[224:227], v1 offset:0
    ds_read_b128 v[228:231], v1 offset:1024
    ds_read_b128 v[232:235], v1 offset:2048
    ds_read_b128 v[236:239], v1 offset:3072
    s_waitcnt vmcnt(0)
    v_cmp_gt_u32 vcc, 1, v31
    s_nop 0
    s_cbranch_vccz spin2_ok
spin2:
    buffer_load_dword v31, v24, s[8:11], s79 offen sc1
    s_waitcnt vmcnt(0)
    v_cmp_gt_u32 vcc, 1, v31
    s_nop 0
    s_cbranch_vccz spin2_ok
    s_cmp_eq_u32 s98, 0
    s_cbranch_scc1 spin2_ok
    s_sub_u32 s98, s98, 1
    s_branch spin2
spin2_ok:
    buffer_load_dwordx4 v[144:147], v1, s[8:11], s32 offen offset:0 sc1
    buffer_load_dwordx4 v[148:151], v25, s[8:11], s32 offen offset:0 sc1
    buffer_load_dwordx4 v[152:155], v26, s[8:11], s32 offen offset:0 sc1
    buffer_load_dwordx4 v[156:159], v27, s[8:11], s32 offen offset:0 sc1
    buffer_load_dwordx4 v[160:163], v1, s[8:11], s32 offen offset:1024 sc1
    buffer_load_dwordx4 v[164:167], v25, s[8:11], s32 offen offset:1024 sc1
    buffer_load_dwordx4 v[168:171], v26, s[8:11], s32 offen offset:1024 sc1
    buffer_load_dwordx4 v[172:175], v27, s[8:11], s32 offen offset:1024 sc1
    s_waitcnt vmcnt(7)
    s_waitcnt lgkmcnt(3)
    v_mfma_f32_16x16x32_bf16 v[32:35], v[224:227], v[144:147], 0
    s_waitcnt vmcnt(6)
    ds_read_b128 v[240:243], v1 offset:4096
    v_mfma_f32_16x16x32_bf16 v[36:39], v[224:227], v[148:151], 0
    s_waitcnt vmcnt(5)
    buffer_load_dwordx4 v[176:179], v1, s[8:11], s32 offen offset:2048 sc1
    v_mfma_f32_16x16x32_bf16 v[40:43], v[224:227], v[152:155], 0
    s_waitcnt vmcnt(5)
    v_mfma_f32_16x16x32_bf16 v[44:47], v[224:227], v[156:159], 0
    s_waitcnt lgkmcnt(3)
    v_mfma_f32_16x16x32_bf16 v[48:51], v[228:231], v[144:147], 0
    s_add_u32 m0, s53, 32768
    ds_read_b128 v[224:227], v1 offset:5120
    v_mfma_f32_16x16x32_bf16 v[52:55], v[228:231], v[148:151], 0
    s_add_u32 s72, s76, 32768
    buffer_load_dwordx4 v[180:183], v25, s[8:11], s32 offen offset:2048 sc1
    v_mfma_f32_16x16x32_bf16 v[56:59], v[228:231], v[152:155], 0
    v_mfma_f32_16x16x32_bf16 v[60:63], v[228:231], v[156:159], 0
    s_waitcnt lgkmcnt(3)
    v_mfma_f32_16x16x32_bf16 v[64:67], v[232:235], v[144:147], 0
    ds_read_b128 v[228:231], v1 offset:6144
    v_mfma_f32_16x16x32_bf16 v[68:71], v[232:235], v[148:151], 0
    buffer_load_dwordx4 v[184:187], v26, s[8:11], s32 offen offset:2048 sc1
    v_mfma_f32_16x16x32_bf16 v[72:75], v[232:235], v[152:155], 0
    v_mfma_f32_16x16x32_bf16 v[76:79], v[232:235], v[156:159], 0
    s_waitcnt lgkmcnt(3)
    v_mfma_f32_16x16x32_bf16 v[80:83], v[236:239], v[144:147], 0
    ds_read_b128 v[232:235], v1 offset:7168
    v_mfma_f32_16x16x32_bf16 v[84:87], v[236:239], v[148:151], 0
    buffer_load_dwordx4 v[188:191], v27, s[8:11], s32 offen offset:2048 sc1
    v_mfma_f32_16x16x32_bf16 v[88:91], v[236:239], v[152:155], 0
    v_mfma_f32_16x16x32_bf16 v[92:95], v[236:239], v[156:159], 0
    s_waitcnt lgkmcnt(3)
    v_mfma_f32_16x16x32_bf16 v[96:99], v[240:243], v[144:147], 0
    ds_read_b128 v[236:239], v1 offset:8192
    v_mfma_f32_16x16x32_bf16 v[100:103], v[240:243], v[148:151], 0
    buffer_load_dwordx2 v[208:209], v28, s[8:11], s36 offen sc1
    v_mfma_f32_16x16x32_bf16 v[104:107], v[240:243], v[152:155], 0
    v_mfma_f32_16x16x32_bf16 v[108:111], v[240:243], v[156:159], 0
    s_waitcnt lgkmcnt(3)
    v_mfma_f32_16x16x32_bf16 v[112:115], v[224:227], v[144:147], 0
    ds_read_b128 v[240:243], v1 offset:9216
    v_mfma_f32_16x16x32_bf16 v[116:119], v[224:227], v[148:151], 0
    buffer_load_dwordx2 v[210:211], v28, s[8:11], s37 offen sc1
    v_mfma_f32_16x16x32_bf16 v[120:123], v[224:227], v[152:155], 0
    v_mfma_f32_16x16x32_bf16 v[124:127], v[224:227], v[156:159], 0
    s_waitcnt lgkmcnt(3)
    v_mfma_f32_16x16x32_bf16 v[128:131], v[228:231], v[144:147], 0
    ds_read_b128 v[224:227], v1 offset:10240
    v_mfma_f32_16x16x32_bf16 v[132:135], v[228:231], v[148:151], 0
    buffer_load_dwordx2 v[212:213], v28, s[8:11], s38 offen sc1
    v_mfma_f32_16x16x32_bf16 v[136:139], v[228:231], v[152:155], 0
    v_mfma_f32_16x16x32_bf16 v[140:143], v[228:231], v[156:159], 0
    s_waitcnt vmcnt(7) lgkmcnt(3)
    v_mfma_f32_16x16x32_bf16 v[32:35], v[232:235], v[160:163], v[32:35]
    ds_read_b128 v[228:231], v1 offset:11264
    v_mfma_f32_16x16x32_bf16 v[36:39], v[232:235], v[164:167], v[36:39]
    buffer_load_dwordx2 v[214:215], v28, s[8:11], s39 offen sc1
    v_mfma_f32_16x16x32_bf16 v[40:43], v[232:235], v[168:171], v[40:43]
    v_mfma_f32_16x16x32_bf16 v[44:47], v[232:235], v[172:175], v[44:47]
    s_waitcnt lgkmcnt(3)
    v_mfma_f32_16x16x32_bf16 v[48:51], v[236:239], v[160:163], v[48:51]
    ds_read_b128 v[232:235], v1 offset:12288
    v_mfma_f32_16x16x32_bf16 v[52:55], v[236:239], v[164:167], v[52:55]
    buffer_load_dwordx2 v[216:217], v28, s[8:11], s40 offen sc1
    v_mfma_f32_16x16x32_bf16 v[56:59], v[236:239], v[168:171], v[56:59]
    v_mfma_f32_16x16x32_bf16 v[60:63], v[236:239], v[172:175], v[60:63]
    s_waitcnt lgkmcnt(3)
    v_mfma_f32_16x16x32_bf16 v[64:67], v[240:243], v[160:163], v[64:67]
    ds_read_b128 v[236:239], v1 offset:13312
    v_mfma_f32_16x16x32_bf16 v[68:71], v[240:243], v[164:167], v[68:71]
    buffer_load_dwordx2 v[218:219], v28, s[8:11], s41 offen sc1
    v_mfma_f32_16x16x32_bf16 v[72:75], v[240:243], v[168:171], v[72:75]
    v_mfma_f32_16x16x32_bf16 v[76:79], v[240:243], v[172:175], v[76:79]
    s_waitcnt lgkmcnt(3)
    buffer_load_dwordx4 v1, s[8:11], s72 offen sc1 lds
    v_mfma_f32_16x16x32_bf16 v[80:83], v[224:227], v[160:163], v[80:83]
    s_add_u32 m0, s53, 36864
    ds_read_b128 v[240:243], v1 offset:14336
    v_mfma_f32_16x16x32_bf16 v[84:87], v[224:227], v[164:167], v[84:87]
    s_add_u32 s72, s76, 36864
    buffer_load_dwordx2 v[220:221], v28, s[8:11], s42 offen sc1
    v_mfma_f32_16x16x32_bf16 v[88:91], v[224:227], v[168:171], v[88:91]
    v_mfma_f32_16x16x32_bf16 v[92:95], v[224:227], v[172:175], v[92:95]
    s_waitcnt lgkmcnt(3)
    v_mfma_f32_16x16x32_bf16 v[96:99], v[228:231], v[160:163], v[96:99]
    ds_read_b128 v[224:227], v1 offset:15360
    v_mfma_f32_16x16x32_bf16 v[100:103], v[228:231], v[164:167], v[100:103]
    buffer_load_dwordx4 v[192:195], v1, s[8:11], s32 offen offset:3072 sc1
    v_mfma_f32_16x16x32_bf16 v[104:107], v[228:231], v[168:171], v[104:107]
    v_mfma_f32_16x16x32_bf16 v[108:111], v[228:231], v[172:175], v[108:111]
    s_waitcnt lgkmcnt(3)
    buffer_load_dwordx4 v1, s[8:11], s72 offen sc1 lds
    v_mfma_f32_16x16x32_bf16 v[112:115], v[232:235], v[160:163], v[112:115]
    s_add_u32 m0, s53, 40960
    ds_read_b128 v[228:231], v1 offset:16384
    v_mfma_f32_16x16x32_bf16 v[116:119], v[232:235], v[164:167], v[116:119]
    s_add_u32 s72, s76, 40960
    buffer_load_dwordx4 v[196:199], v25, s[8:11], s32 offen offset:3072 sc1
    v_mfma_f32_16x16x32_bf16 v[120:123], v[232:235], v[168:171], v[120:123]
    v_mfma_f32_16x16x32_bf16 v[124:127], v[232:235], v[172:175], v[124:127]
    s_waitcnt lgkmcnt(3)
    v_mfma_f32_16x16x32_bf16 v[128:131], v[236:239], v[160:163], v[128:131]
    ds_read_b128 v[232:235], v1 offset:17408
    v_mfma_f32_16x16x32_bf16 v[132:135], v[236:239], v[164:167], v[132:135]
    buffer_load_dwordx4 v[200:203], v26, s[8:11], s32 offen offset:3072 sc1
    v_mfma_f32_16x16x32_bf16 v[136:139], v[236:239], v[168:171], v[136:139]
    v_mfma_f32_16x16x32_bf16 v[140:143], v[236:239], v[172:175], v[140:143]
    s_waitcnt vmcnt(12) lgkmcnt(3)
    buffer_load_dwordx4 v1, s[8:11], s72 offen sc1 lds
    v_mfma_f32_16x16x32_bf16 v[32:35], v[240:243], v[176:179], v[32:35]
    s_add_u32 m0, s53, 45056
    ds_read_b128 v[236:239], v1 offset:18432
    v_mfma_f32_16x16x32_bf16 v[36:39], v[240:243], v[180:183], v[36:39]
    s_add_u32 s72, s76, 45056
    buffer_load_dwordx4 v[204:207], v27, s[8:11], s32 offen offset:3072 sc1
    v_mfma_f32_16x16x32_bf16 v[40:43], v[240:243], v[184:187], v[40:43]
    v_mfma_f32_16x16x32_bf16 v[44:47], v[240:243], v[188:191], v[44:47]
    s_waitcnt lgkmcnt(3)
    v_mfma_f32_16x16x32_bf16 v[48:51], v[224:227], v[176:179], v[48:51]
    ds_read_b128 v[240:243], v1 offset:19456
    v_mfma_f32_16x16x32_bf16 v[52:55], v[224:227], v[180:183], v[52:55]
    buffer_load_dwordx4 a[224:227], v1, s[8:11], s33 offen offset:0 sc1
    v_mfma_f32_16x16x32_bf16 v[56:59], v[224:227], v[184:187], v[56:59]
    v_mfma_f32_16x16x32_bf16 v[60:63], v[224:227], v[188:191], v[60:63]
    s_waitcnt lgkmcnt(3)
    buffer_load_dwordx4 v1, s[8:11], s72 offen sc1 lds
    v_mfma_f32_16x16x32_bf16 v[64:67], v[228:231], v[176:179], v[64:67]
    s_add_u32 m0, s53, 49152
    ds_read_b128 v[224:227], v1 offset:20480
    s_waitcnt vmcnt(14)
    v_add_f32 v208, v208, v210
    v_mfma_f32_16x16x32_bf16 v[68:71], v[228:231], v[180:183], v[68:71]
    s_add_u32 s72, s76, 49152
    buffer_load_dwordx4 a[228:231], v25, s[8:11], s33 offen offset:0 sc1
    v_add_f32 v209, v209, v211
    v_mfma_f32_16x16x32_bf16 v[72:75], v[228:231], v[184:187], v[72:75]
    s_waitcnt vmcnt(14)
    v_add_f32 v208, v208, v212
    v_add_f32 v209, v209, v213
    v_mfma_f32_16x16x32_bf16 v[76:79], v[228:231], v[188:191], v[76:79]
    s_waitcnt lgkmcnt(3)
    s_waitcnt vmcnt(13)
    v_add_f32 v208, v208, v214
    v_add_f32 v209, v209, v215
    v_mfma_f32_16x16x32_bf16 v[80:83], v[232:235], v[176:179], v[80:83]
    ds_read_b128 v[228:231], v1 offset:21504
    s_waitcnt vmcnt(12)
    v_add_f32 v208, v208, v216
    v_mfma_f32_16x16x32_bf16 v[84:87], v[232:235], v[180:183], v[84:87]
    buffer_load_dwordx4 a[232:235], v26, s[8:11], s33 offen offset:0 sc1
    v_add_f32 v209, v209, v217
    v_mfma_f32_16x16x32_bf16 v[88:91], v[232:235], v[184:187], v[88:91]
    s_waitcnt vmcnt(12)
    v_add_f32 v208, v208, v218
    v_add_f32 v209, v209, v219
    v_mfma_f32_16x16x32_bf16 v[92:95], v[232:235], v[188:191], v[92:95]
    s_waitcnt lgkmcnt(3)
    buffer_load_dwordx4 v1, s[8:11], s72 offen sc1 lds
    s_waitcnt vmcnt(11)
    v_add_f32 v208, v208, v220
    v_mfma_f32_16x16x32_bf16 v[96:99], v[236:239], v[176:179], v[96:99]
    s_add_u32 m0, s53, 53248
    ds_read_b128 v[232:235], v1 offset:22528
    v_add_f32 v209, v209, v221
    v_mfma_f32_16x16x32_bf16 v[100:103], v[236:239], v[180:183], v[100:103]
    s_add_u32 s72, s76, 53248
    buffer_load_dwordx4 a[236:239], v27, s[8:11], s33 offen offset:0 sc1
    s_add_u32 s52, s53, 100352
    v_mfma_f32_16x16x32_bf16 v[104:107], v[236:239], v[184:187], v[104:107]
    v_add_u32 v28, s52, v1
    v_lshl_add_u32 v31, v2, 4, s52
    v_mfma_f32_16x16x32_bf16 v[108:111], v[236:239], v[188:191], v[108:111]
    s_waitcnt lgkmcnt(3)
    v_mul_f32 v208, 0xbb124925, v208
    v_mul_f32 v209, 0x3b124925, v209
    v_mfma_f32_16x16x32_bf16 v[112:115], v[240:243], v[176:179], v[112:115]
    ds_read_b128 v[236:239], v1 offset:23552
    v_fma_f32 v209, -v208, v208, v209
    v_mfma_f32_16x16x32_bf16 v[116:119], v[240:243], v[180:183], v[116:119]
    buffer_load_dwordx4 a[240:243], v1, s[8:11], s33 offen offset:1024 sc1
    v_max_f32 v209, 0, v209
    v_mfma_f32_16x16x32_bf16 v[120:123], v[240:243], v[184:187], v[120:123]
    v_add_f32 v211, 0x3727c5ac, v209
    v_mfma_f32_16x16x32_bf16 v[124:127], v[240:243], v[188:191], v[124:127]
    s_waitcnt lgkmcnt(3)
    buffer_load_dwordx4 v1, s[8:11], s72 offen sc1 lds
    v_mfma_f32_16x16x32_bf16 v[128:131], v[224:227], v[176:179], v[128:131]
    s_add_u32 m0, s53, 57344
    ds_read_b128 v[240:243], v1 offset:24576
    v_mfma_f32_16x16x32_bf16 v[132:135], v[224:227], v[180:183], v[132:135]
    s_add_u32 s72, s76, 57344
    buffer_load_dwordx4 a[244:247], v25, s[8:11], s33 offen offset:1024 sc1
    v_mfma_f32_16x16x32_bf16 v[136:139], v[224:227], v[184:187], v[136:139]
    v_rsq_f32 v209, v211
    v_mfma_f32_16x16x32_bf16 v[140:143], v[224:227], v[188:191], v[140:143]
    s_waitcnt vmcnt(9) lgkmcnt(3)
    v_mov_b32 v212, 0
    v_mul_f32 v210, 0xbfb8aa3b, v209
    v_mfma_f32_16x16x32_bf16 v[32:35], v[228:231], v[192:195], v[32:35]
    ds_read_b128 v[224:227], v1 offset:25600
    ds_write_b128 v28, v[208:211]
    v_mfma_f32_16x16x32_bf16 v[36:39], v[228:231], v[196:199], v[36:39]
    buffer_load_dwordx4 a[248:251], v26, s[8:11], s33 offen offset:1024 sc1
    ds_read_b32 v252, v31 offset:0
    v_mfma_f32_16x16x32_bf16 v[40:43], v[228:231], v[200:203], v[40:43]
    ds_read_b32 v253, v31 offset:256
    ds_read_b32 v254, v31 offset:512
    v_mfma_f32_16x16x32_bf16 v[44:47], v[228:231], v[204:207], v[44:47]
    s_waitcnt lgkmcnt(7)
    buffer_load_dwordx4 v1, s[8:11], s72 offen sc1 lds
    ds_read_b32 v255, v31 offset:768
    v_mfma_f32_16x16x32_bf16 v[48:51], v[232:235], v[192:195], v[48:51]
    s_add_u32 m0, s53, 61440
    ds_read_b128 v[228:231], v1 offset:26624
    ds_read_b64 v[16:17], v31 offset:8
    v_mfma_f32_16x16x32_bf16 v[52:55], v[232:235], v[196:199], v[52:55]
    s_add_u32 s72, s76, 61440
    buffer_load_dwordx4 a[252:255], v27, s[8:11], s33 offen offset:1024 sc1
    ds_read_b64 v[18:19], v31 offset:264
    v_mfma_f32_16x16x32_bf16 v[56:59], v[232:235], v[200:203], v[56:59]
    ds_read_b64 v[20:21], v31 offset:520
    ds_read_b64 v[22:23], v31 offset:776
    v_mfma_f32_16x16x32_bf16 v[60:63], v[232:235], v[204:207], v[60:63]
    s_waitcnt lgkmcnt(12)
    v_mul_u32_u24 v28, 57344, v3
    v_lshl_add_u32 v28, v2, 4, v28
    v_mfma_f32_16x16x32_bf16 v[64:67], v[236:239], v[192:195], v[64:67]
    s_mul_i32 s81, s88, 229376
    ds_read_b128 v[232:235], v1 offset:27648
    s_lshl_b32 s52, s5, 8
    v_mfma_f32_16x16x32_bf16 v[68:71], v[236:239], v[196:199], v[68:71]
    s_add_u32 s81, s81, s52
    buffer_load_dwordx4 v[144:147], v1, s[8:11], s33 offen offset:3072 sc1
    s_add_u32 s81, s81, 12058624
    v_mfma_f32_16x16x32_bf16 v[72:75], v[236:239], v[200:203], v[72:75]
    s_lshl_b32 s52, s3, 7
    s_lshl_b32 s55, s5, 2
    s_add_u32 s52, s52, s55
    v_mfma_f32_16x16x32_bf16 v[76:79], v[236:239], v[204:207], v[76:79]
    s_waitcnt lgkmcnt(12)
    buffer_load_dwordx4 v1, s[8:11], s72 offen sc1 lds
    s_add_u32 s52, s52, s78
    v_mfma_f32_16x16x32_bf16 v[80:83], v[240:243], v[192:195], v[80:83]
    s_add_u32 m0, s53, 65536
    ds_read_b128 v[236:239], v1 offset:28672
    s_add_u32 s82, s52, 1024
    v_mfma_f32_16x16x32_bf16 v[84:87], v[240:243], v[196:199], v[84:87]
    s_add_u32 s72, s76, 65536
    buffer_load_dwordx4 v[208:211], v1, s[8:11], s33 offen offset:2048 sc1
    s_lshl_b32 s52, s6, 7
    v_mfma_f32_16x16x32_bf16 v[88:91], v[240:243], v[200:203], v[88:91]
    s_lshl_b32 s55, s3, 5
    s_add_u32 s52, s52, s55
    s_add_u32 s52, s52, s78
    v_mfma_f32_16x16x32_bf16 v[92:95], v[240:243], v[204:207], v[92:95]
    s_waitcnt lgkmcnt(12)
    s_add_u32 s79, s52, 1024
    s_lshl_b32 s52, s4, 2
    v_mfma_f32_16x16x32_bf16 v[96:99], v[224:227], v[192:195], v[96:99]
    s_add_u32 s52, s52, s6
    ds_read_b128 v[240:243], v1 offset:29696
    s_mul_i32 s89, s52, 229376
    v_mfma_f32_16x16x32_bf16 v[100:103], v[224:227], v[196:199], v[100:103]
    s_lshl_b32 s52, s3, 11
    buffer_load_dwordx4 v[212:215], v25, s[8:11], s33 offen offset:2048 sc1
    s_add_u32 s89, s89, s52
    v_mfma_f32_16x16x32_bf16 v[104:107], v[224:227], v[200:203], v[104:107]
    s_add_u32 s36, s89, 12058624
    s_add_u32 s37, s36, 8192
    s_add_u32 s38, s36, 16384
    v_mfma_f32_16x16x32_bf16 v[108:111], v[224:227], v[204:207], v[108:111]
    s_waitcnt lgkmcnt(7)
    buffer_load_dwordx4 v1, s[8:11], s72 offen sc1 lds
    s_add_u32 s39, s36, 24576
    v_mfma_f32_16x16x32_bf16 v[112:115], v[228:231], v[192:195], v[112:115]
    s_add_u32 m0, s53, 69632
    ds_read_b128 v[224:227], v1 offset:30720
    s_add_u32 s40, s36, 32768
    v_mfma_f32_16x16x32_bf16 v[116:119], v[228:231], v[196:199], v[116:119]
    s_add_u32 s72, s76, 69632
    buffer_load_dwordx4 v[216:219], v26, s[8:11], s33 offen offset:2048 sc1
    s_add_u32 s41, s36, 40960
    v_mfma_f32_16x16x32_bf16 v[120:123], v[228:231], v[200:203], v[120:123]
    s_add_u32 s42, s36, 49152
    v_and_b32 v24, 7, v0
    v_lshlrev_b32 v24, 2, v24
    v_mfma_f32_16x16x32_bf16 v[124:127], v[228:231], v[204:207], v[124:127]
    s_waitcnt lgkmcnt(3)
    v_mfma_f32_16x16x32_bf16 v[128:131], v[232:235], v[192:195], v[128:131]
    ds_read_b128 v[228:231], v1 offset:31744
    v_mfma_f32_16x16x32_bf16 v[132:135], v[232:235], v[196:199], v[132:135]
    buffer_load_dwordx4 v[220:223], v27, s[8:11], s33 offen offset:2048 sc1
    v_mfma_f32_16x16x32_bf16 v[136:139], v[232:235], v[200:203], v[136:139]
    v_mfma_f32_16x16x32_bf16 v[140:143], v[232:235], v[204:207], v[140:143]
    s_waitcnt vmcnt(13) lgkmcnt(3)
    buffer_load_dwordx4 v1, s[8:11], s72 offen sc1 lds
    s_waitcnt vmcnt(12)
    s_barrier
    ds_read_b128 v[248:251], v30 offset:256
    v_mfma_f32_16x16x32_bf16 v[32:35], v[236:239], a[224:227], v[32:35]
    s_add_u32 m0, s53, 73728
    ds_read_b128 v[232:235], v1 offset:32768
    ds_read_b128 v[244:247], v30 offset:320
    v_mfma_f32_16x16x32_bf16 v[36:39], v[236:239], a[228:231], v[36:39]
    s_add_u32 s72, s76, 73728
    buffer_load_dwordx4 v[148:151], v25, s[8:11], s33 offen offset:3072 sc1
    s_waitcnt lgkmcnt(2)
    v_fmac_f32 v96, v252, v248
    v_mfma_f32_16x16x32_bf16 v[40:43], v[236:239], a[232:235], v[40:43]
    v_fmac_f32 v97, v252, v249
    v_fmac_f32 v98, v252, v250
    v_mfma_f32_16x16x32_bf16 v[44:47], v[236:239], a[236:239], v[44:47]
    v_fmac_f32 v99, v252, v251
    v_mfma_f32_16x16x32_bf16 v[48:51], v[240:243], a[224:227], v[48:51]
    ds_read_b128 v[236:239], v1 offset:33792
    ds_read_b128 v[248:251], v30 offset:384
    v_mfma_f32_16x16x32_bf16 v[52:55], v[240:243], a[228:231], v[52:55]
    buffer_load_dwordx4 v[152:155], v26, s[8:11], s33 offen offset:3072 sc1
    s_waitcnt lgkmcnt(2)
    v_fmac_f32 v112, v252, v244
    v_mfma_f32_16x16x32_bf16 v[56:59], v[240:243], a[232:235], v[56:59]
    v_fmac_f32 v113, v252, v245
    v_fmac_f32 v114, v252, v246
    v_mfma_f32_16x16x32_bf16 v[60:63], v[240:243], a[236:239], v[60:63]
    buffer_load_dwordx4 v1, s[8:11], s72 offen sc1 lds
    v_fmac_f32 v115, v252, v247
    v_mfma_f32_16x16x32_bf16 v[64:67], v[224:227], a[224:227], v[64:67]
    s_add_u32 m0, s53, 77824
    ds_read_b128 v[240:243], v1 offset:34816
    ds_read_b128 v[244:247], v30 offset:0
    v_mfma_f32_16x16x32_bf16 v[68:71], v[224:227], a[228:231], v[68:71]
    s_add_u32 s72, s76, 77824
    buffer_load_dwordx4 v[156:159], v27, s[8:11], s33 offen offset:3072 sc1
    s_waitcnt lgkmcnt(2)
    v_fmac_f32 v128, v252, v248
    v_mfma_f32_16x16x32_bf16 v[72:75], v[224:227], a[232:235], v[72:75]
    v_fmac_f32 v129, v252, v249
    v_fmac_f32 v130, v252, v250
    v_mfma_f32_16x16x32_bf16 v[76:79], v[224:227], a[236:239], v[76:79]
    v_fmac_f32 v131, v252, v251
    v_mfma_f32_16x16x32_bf16 v[80:83], v[228:231], a[224:227], v[80:83]
    ds_read_b128 v[224:227], v1 offset:35840
    ds_read_b128 v[248:251], v30 offset:64
    v_mfma_f32_16x16x32_bf16 v[84:87], v[228:231], a[228:231], v[84:87]
    buffer_load_dwordx4 v[160:163], v1, s[8:11], s34 offen offset:0 sc1
    s_waitcnt lgkmcnt(2)
    v_fmac_f32 v32, v252, v244
    v_mfma_f32_16x16x32_bf16 v[88:91], v[228:231], a[232:235], v[88:91]
    v_fmac_f32 v33, v252, v245
    v_fmac_f32 v34, v252, v246
    v_mfma_f32_16x16x32_bf16 v[92:95], v[228:231], a[236:239], v[92:95]
    buffer_load_dwordx4 v1, s[8:11], s72 offen sc1 lds
    v_fmac_f32 v35, v252, v247
    v_mfma_f32_16x16x32_bf16 v[96:99], v[232:235], a[224:227], v[96:99]
    s_add_u32 m0, s53, 81920
    ds_read_b128 v[228:231], v1 offset:36864
    ds_read_b128 v[244:247], v30 offset:128
    v_mfma_f32_16x16x32_bf16 v[100:103], v[232:235], a[228:231], v[100:103]
    s_add_u32 s72, s76, 81920
    buffer_load_dwordx4 v[164:167], v25, s[8:11], s34 offen offset:0 sc1
    s_waitcnt lgkmcnt(2)
    v_fmac_f32 v48, v252, v248
    v_mfma_f32_16x16x32_bf16 v[104:107], v[232:235], a[232:235], v[104:107]
    v_fmac_f32 v49, v252, v249
    v_fmac_f32 v50, v252, v250
    v_mfma_f32_16x16x32_bf16 v[108:111], v[232:235], a[236:239], v[108:111]
    v_fmac_f32 v51, v252, v251
    v_mfma_f32_16x16x32_bf16 v[112:115], v[236:239], a[224:227], v[112:115]
    ds_read_b128 v[232:235], v1 offset:37888
    ds_read_b128 v[248:251], v30 offset:192
    v_mfma_f32_16x16x32_bf16 v[116:119], v[236:239], a[228:231], v[116:119]
    buffer_load_dwordx4 v[168:171], v26, s[8:11], s34 offen offset:0 sc1
    s_waitcnt lgkmcnt(2)
    v_fmac_f32 v64, v252, v244
    v_mfma_f32_16x16x32_bf16 v[120:123], v[236:239], a[232:235], v[120:123]
    v_fmac_f32 v65, v252, v245
    v_fmac_f32 v66, v252, v246
    v_mfma_f32_16x16x32_bf16 v[124:127], v[236:239], a[236:239], v[124:127]
    buffer_load_dwordx4 v1, s[8:11], s72 offen sc1 lds
    v_fmac_f32 v67, v252, v247
    v_mfma_f32_16x16x32_bf16 v[128:131], v[240:243], a[224:227], v[128:131]
    s_add_u32 m0, s53, 86016
    ds_read_b128 v[236:239], v1 offset:38912
    ds_read_b128 v[244:247], v30 offset:256
    v_mfma_f32_16x16x32_bf16 v[132:135], v[240:243], a[228:231], v[132:135]
    s_add_u32 s72, s76, 86016
    buffer_load_dwordx4 v[172:175], v27, s[8:11], s34 offen offset:0 sc1
    s_waitcnt lgkmcnt(2)
    v_fmac_f32 v80, v252, v248
    v_mfma_f32_16x16x32_bf16 v[136:139], v[240:243], a[232:235], v[136:139]
    v_fmac_f32 v81, v252, v249
    v_fmac_f32 v82, v252, v250
    v_mfma_f32_16x16x32_bf16 v[140:143], v[240:243], a[236:239], v[140:143]
    s_waitcnt vmcnt(18)
    v_fmac_f32 v83, v252, v251
    v_mfma_f32_16x16x32_bf16 v[32:35], v[224:227], a[240:243], v[32:35]
    ds_read_b128 v[240:243], v1 offset:39936
    ds_read_b128 v[248:251], v30 offset:320
    v_mfma_f32_16x16x32_bf16 v[36:39], v[224:227], a[244:247], v[36:39]
    buffer_load_dwordx4 v[176:179], v1, s[8:11], s34 offen offset:1024 sc1
    s_waitcnt lgkmcnt(2)
    v_fmac_f32 v100, v253, v244
    v_mfma_f32_16x16x32_bf16 v[40:43], v[224:227], a[248:251], v[40:43]
    v_fmac_f32 v101, v253, v245
    v_fmac_f32 v102, v253, v246
    v_mfma_f32_16x16x32_bf16 v[44:47], v[224:227], a[252:255], v[44:47]
    buffer_load_dwordx4 v1, s[8:11], s72 offen sc1 lds
    v_fmac_f32 v103, v253, v247
    v_mfma_f32_16x16x32_bf16 v[48:51], v[228:231], a[240:243], v[48:51]
    s_add_u32 m0, s53, 90112
    ds_read_b128 v[224:227], v1 offset:40960
    ds_read_b128 v[244:247], v30 offset:384
    v_mfma_f32_16x16x32_bf16 v[52:55], v[228:231], a[244:247], v[52:55]
    s_add_u32 s72, s76, 90112
    buffer_load_dwordx4 v[180:183], v25, s[8:11], s34 offen offset:1024 sc1
    s_waitcnt lgkmcnt(2)
    v_fmac_f32 v116, v253, v248
    v_mfma_f32_16x16x32_bf16 v[56:59], v[228:231], a[248:251], v[56:59]
    v_fmac_f32 v117, v253, v249
    v_fmac_f32 v118, v253, v250
    v_mfma_f32_16x16x32_bf16 v[60:63], v[228:231], a[252:255], v[60:63]
    v_fmac_f32 v119, v253, v251
    v_mfma_f32_16x16x32_bf16 v[64:67], v[232:235], a[240:243], v[64:67]
    ds_read_b128 v[228:231], v1 offset:41984
    ds_read_b128 v[248:251], v30 offset:0
    v_mfma_f32_16x16x32_bf16 v[68:71], v[232:235], a[244:247], v[68:71]
    buffer_load_dwordx4 v[184:187], v26, s[8:11], s34 offen offset:1024 sc1
    s_waitcnt lgkmcnt(2)
    v_fmac_f32 v132, v253, v244
    v_mfma_f32_16x16x32_bf16 v[72:75], v[232:235], a[248:251], v[72:75]
    v_fmac_f32 v133, v253, v245
    v_fmac_f32 v134, v253, v246
    v_mfma_f32_16x16x32_bf16 v[76:79], v[232:235], a[252:255], v[76:79]
    buffer_load_dwordx4 v1, s[8:11], s72 offen sc1 lds
    v_fmac_f32 v135, v253, v247
    v_mfma_f32_16x16x32_bf16 v[80:83], v[236:239], a[240:243], v[80:83]
    s_add_u32 m0, s53, 94208
    ds_read_b128 v[232:235], v1 offset:43008
    ds_read_b128 v[244:247], v30 offset:64
    v_mfma_f32_16x16x32_bf16 v[84:87], v[236:239], a[244:247], v[84:87]
    s_add_u32 s72, s76, 94208
    buffer_load_dwordx4 v[188:191], v27, s[8:11], s34 offen offset:1024 sc1
    s_waitcnt lgkmcnt(2)
    v_fmac_f32 v36, v253, v248
    v_mfma_f32_16x16x32_bf16 v[88:91], v[236:239], a[248:251], v[88:91]
    v_fmac_f32 v37, v253, v249
    v_fmac_f32 v38, v253, v250
    v_mfma_f32_16x16x32_bf16 v[92:95], v[236:239], a[252:255], v[92:95]
    v_fmac_f32 v39, v253, v251
    v_mfma_f32_16x16x32_bf16 v[96:99], v[240:243], a[240:243], v[96:99]
    ds_read_b128 v[236:239], v1 offset:44032
    ds_read_b128 v[248:251], v30 offset:128
    v_mfma_f32_16x16x32_bf16 v[100:103], v[240:243], a[244:247], v[100:103]
    buffer_load_dwordx4 v[192:195], v1, s[8:11], s34 offen offset:2048 sc1
    s_waitcnt lgkmcnt(2)
    v_fmac_f32 v52, v253, v244
    v_mfma_f32_16x16x32_bf16 v[104:107], v[240:243], a[248:251], v[104:107]
    v_fmac_f32 v53, v253, v245
    v_fmac_f32 v54, v253, v246
    v_mfma_f32_16x16x32_bf16 v[108:111], v[240:243], a[252:255], v[108:111]
    buffer_load_dwordx4 v1, s[8:11], s72 offen sc1 lds
    v_fmac_f32 v55, v253, v247
    v_mfma_f32_16x16x32_bf16 v[112:115], v[224:227], a[240:243], v[112:115]
    s_add_u32 s93, s77, 24576
    ds_read_b128 v[240:243], v1 offset:45056
    ds_read_b128 v[244:247], v30 offset:192
    v_mfma_f32_16x16x32_bf16 v[116:119], v[224:227], a[244:247], v[116:119]
    buffer_load_dwordx4 v[196:199], v25, s[8:11], s34 offen offset:2048 sc1
    s_waitcnt lgkmcnt(2)
    v_fmac_f32 v68, v253, v248
    v_mfma_f32_16x16x32_bf16 v[120:123], v[224:227], a[248:251], v[120:123]
    v_fmac_f32 v69, v253, v249
    v_fmac_f32 v70, v253, v250
    v_mfma_f32_16x16x32_bf16 v[124:127], v[224:227], a[252:255], v[124:127]
    v_fmac_f32 v71, v253, v251
    v_mfma_f32_16x16x32_bf16 v[128:131], v[228:231], a[240:243], v[128:131]
    ds_read_b128 v[224:227], v1 offset:46080
    ds_read_b128 v[248:251], v30 offset:256
    v_mfma_f32_16x16x32_bf16 v[132:135], v[228:231], a[244:247], v[132:135]
    buffer_load_dwordx4 v[200:203], v26, s[8:11], s34 offen offset:2048 sc1
    s_waitcnt lgkmcnt(2)
    v_fmac_f32 v84, v253, v244
    v_mfma_f32_16x16x32_bf16 v[136:139], v[228:231], a[248:251], v[136:139]
    v_fmac_f32 v85, v253, v245
    v_fmac_f32 v86, v253, v246
    v_mfma_f32_16x16x32_bf16 v[140:143], v[228:231], a[252:255], v[140:143]
    s_waitcnt vmcnt(21)
    v_fmac_f32 v87, v253, v247
    v_mfma_f32_16x16x32_bf16 v[32:35], v[232:235], v[208:211], v[32:35]
    ds_read_b128 v[228:231], v1 offset:47104
    ds_read_b128 v[244:247], v30 offset:320
    v_mfma_f32_16x16x32_bf16 v[36:39], v[232:235], v[212:215], v[36:39]
    buffer_load_dwordx4 v[204:207], v27, s[8:11], s34 offen offset:2048 sc1
    s_waitcnt lgkmcnt(2)
    v_fmac_f32 v104, v254, v248
    v_mfma_f32_16x16x32_bf16 v[40:43], v[232:235], v[216:219], v[40:43]
    v_fmac_f32 v105, v254, v249
    v_fmac_f32 v106, v254, v250
    v_mfma_f32_16x16x32_bf16 v[44:47], v[232:235], v[220:223], v[44:47]
    v_fmac_f32 v107, v254, v251
    v_mfma_f32_16x16x32_bf16 v[48:51], v[236:239], v[208:211], v[48:51]
    ds_read_b128 v[232:235], v1 offset:48128
    ds_read_b128 v[248:251], v30 offset:384
    v_mfma_f32_16x16x32_bf16 v[52:55], v[236:239], v[212:215], v[52:55]
    buffer_load_dwordx4 a[224:227], v1, s[8:11], s34 offen offset:3072 sc1
    s_waitcnt lgkmcnt(2)
    v_fmac_f32 v120, v254, v244
    v_mfma_f32_16x16x32_bf16 v[56:59], v[236:239], v[216:219], v[56:59]
    v_fmac_f32 v121, v254, v245
    v_fmac_f32 v122, v254, v246
    v_mfma_f32_16x16x32_bf16 v[60:63], v[236:239], v[220:223], v[60:63]
    v_fmac_f32 v123, v254, v247
    v_mfma_f32_16x16x32_bf16 v[64:67], v[240:243], v[208:211], v[64:67]
    ds_read_b128 v[236:239], v1 offset:49152
    ds_read_b128 v[244:247], v30 offset:0
    v_mfma_f32_16x16x32_bf16 v[68:71], v[240:243], v[212:215], v[68:71]
    buffer_load_dwordx4 a[228:231], v25, s[8:11], s34 offen offset:3072 sc1
    s_waitcnt lgkmcnt(2)
    v_fmac_f32 v136, v254, v248
    v_mfma_f32_16x16x32_bf16 v[72:75], v[240:243], v[216:219], v[72:75]
    v_fmac_f32 v137, v254, v249
    v_fmac_f32 v138, v254, v250
    v_mfma_f32_16x16x32_bf16 v[76:79], v[240:243], v[220:223], v[76:79]
    v_fmac_f32 v139, v254, v251
    v_mfma_f32_16x16x32_bf16 v[80:83], v[224:227], v[208:211], v[80:83]
    ds_read_b128 v[240:243], v29 offset:0
    ds_read_b128 v[248:251], v30 offset:64
    v_mfma_f32_16x16x32_bf16 v[84:87], v[224:227], v[212:215], v[84:87]
    buffer_load_dwordx4 a[232:235], v26, s[8:11], s34 offen offset:3072 sc1
    s_waitcnt lgkmcnt(2)
    v_fmac_f32 v40, v254, v244
    v_mfma_f32_16x16x32_bf16 v[88:91], v[224:227], v[216:219], v[88:91]
    v_fmac_f32 v41, v254, v245
    v_fmac_f32 v42, v254, v246
    v_mfma_f32_16x16x32_bf16 v[92:95], v[224:227], v[220:223], v[92:95]
    v_fmac_f32 v43, v254, v247
    v_mfma_f32_16x16x32_bf16 v[96:99], v[228:231], v[208:211], v[96:99]
    ds_read_b128 v[224:227], v29 offset:1024
    ds_read_b128 v[244:247], v30 offset:128
    v_mfma_f32_16x16x32_bf16 v[100:103], v[228:231], v[212:215], v[100:103]
    buffer_load_dwordx4 a[236:239], v27, s[8:11], s34 offen offset:3072 sc1
    s_waitcnt lgkmcnt(2)
    v_fmac_f32 v56, v254, v248
    v_mfma_f32_16x16x32_bf16 v[104:107], v[228:231], v[216:219], v[104:107]
    v_fmac_f32 v57, v254, v249
    v_fmac_f32 v58, v254, v250
    v_mfma_f32_16x16x32_bf16 v[108:111], v[228:231], v[220:223], v[108:111]
    v_fmac_f32 v59, v254, v251
    v_mfma_f32_16x16x32_bf16 v[112:115], v[232:235], v[208:211], v[112:115]
    ds_read_b128 v[228:231], v29 offset:2048
    ds_read_b128 v[248:251], v30 offset:192
    v_mfma_f32_16x16x32_bf16 v[116:119], v[232:235], v[212:215], v[116:119]
    buffer_load_dwordx4 a[240:243], v1, s[8:11], s35 offen offset:0 sc1
    s_waitcnt lgkmcnt(2)
    v_fmac_f32 v72, v254, v244
    v_mfma_f32_16x16x32_bf16 v[120:123], v[232:235], v[216:219], v[120:123]
    v_fmac_f32 v73, v254, v245
    v_fmac_f32 v74, v254, v246
    v_mfma_f32_16x16x32_bf16 v[124:127], v[232:235], v[220:223], v[124:127]
    v_fmac_f32 v75, v254, v247
    v_mfma_f32_16x16x32_bf16 v[128:131], v[236:239], v[208:211], v[128:131]
    ds_read_b128 v[232:235], v29 offset:3072
    ds_read_b128 v[244:247], v30 offset:256
    v_mfma_f32_16x16x32_bf16 v[132:135], v[236:239], v[212:215], v[132:135]
    buffer_load_dwordx4 a[244:247], v25, s[8:11], s35 offen offset:0 sc1
    s_waitcnt lgkmcnt(2)
    v_fmac_f32 v88, v254, v248
    v_mfma_f32_16x16x32_bf16 v[136:139], v[236:239], v[216:219], v[136:139]
    v_fmac_f32 v89, v254, v249
    v_fmac_f32 v90, v254, v250
    v_mfma_f32_16x16x32_bf16 v[140:143], v[236:239], v[220:223], v[140:143]
    s_waitcnt vmcnt(23)
    v_fmac_f32 v91, v254, v251
    v_mfma_f32_16x16x32_bf16 v[32:35], v[240:243], v[144:147], v[32:35]
    ds_read_b128 v[236:239], v29 offset:4096
    ds_read_b128 v[248:251], v30 offset:320
    v_mfma_f32_16x16x32_bf16 v[36:39], v[240:243], v[148:151], v[36:39]
    buffer_load_dwordx4 a[248:251], v26, s[8:11], s35 offen offset:0 sc1
    s_waitcnt lgkmcnt(2)
    v_fmac_f32 v108, v255, v244
    v_mfma_f32_16x16x32_bf16 v[40:43], v[240:243], v[152:155], v[40:43]
    v_fmac_f32 v109, v255, v245
    v_fmac_f32 v110, v255, v246
    v_mfma_f32_16x16x32_bf16 v[44:47], v[240:243], v[156:159], v[44:47]
    v_fmac_f32 v111, v255, v247
    v_mfma_f32_16x16x32_bf16 v[48:51], v[224:227], v[144:147], v[48:51]
    ds_read_b128 v[240:243], v29 offset:5120
    ds_read_b128 v[244:247], v30 offset:384
    v_mfma_f32_16x16x32_bf16 v[52:55], v[224:227], v[148:151], v[52:55]
    buffer_load_dwordx4 a[252:255], v27, s[8:11], s35 offen offset:0 sc1
    s_waitcnt lgkmcnt(2)
    v_fmac_f32 v124, v255, v248
    v_mfma_f32_16x16x32_bf16 v[56:59], v[224:227], v[152:155], v[56:59]
    v_fmac_f32 v125, v255, v249
    v_fmac_f32 v126, v255, v250
    v_mfma_f32_16x16x32_bf16 v[60:63], v[224:227], v[156:159], v[60:63]
    v_fmac_f32 v127, v255, v251
    v_mfma_f32_16x16x32_bf16 v[64:67], v[228:231], v[144:147], v[64:67]
    ds_read_b128 v[224:227], v29 offset:6144
    ds_read_b128 v[248:251], v30 offset:0
    v_mfma_f32_16x16x32_bf16 v[68:71], v[228:231], v[148:151], v[68:71]
    buffer_load_dwordx4 v[208:211], v1, s[8:11], s35 offen offset:1024 sc1
    s_waitcnt lgkmcnt(2)
    v_fmac_f32 v140, v255, v244
    v_mfma_f32_16x16x32_bf16 v[72:75], v[228:231], v[152:155], v[72:75]
    v_fmac_f32 v141, v255, v245
    v_fmac_f32 v142, v255, v246
    v_mfma_f32_16x16x32_bf16 v[76:79], v[228:231], v[156:159], v[76:79]
    v_fmac_f32 v143, v255, v247
    s_barrier
    v_mfma_f32_16x16x32_bf16 v[80:83], v[232:235], v[144:147], v[80:83]
    ds_read_b128 v[228:231], v29 offset:7168
    ds_read_b128 v[244:247], v30 offset:64
    v_mfma_f32_16x16x32_bf16 v[84:87], v[232:235], v[148:151], v[84:87]
    buffer_load_dwordx4 v[212:215], v25, s[8:11], s35 offen offset:1024 sc1
    s_waitcnt lgkmcnt(2)
    v_fmac_f32 v44, v255, v248
    v_mfma_f32_16x16x32_bf16 v[88:91], v[232:235], v[152:155], v[88:91]
    v_fmac_f32 v45, v255, v249
    v_fmac_f32 v46, v255, v250
    v_mfma_f32_16x16x32_bf16 v[92:95], v[232:235], v[156:159], v[92:95]
    v_fmac_f32 v47, v255, v251
    v_mfma_f32_16x16x32_bf16 v[96:99], v[236:239], v[144:147], v[96:99]
    ds_read_b128 v[232:235], v29 offset:8192
    ds_read_b128 v[248:251], v30 offset:128
    v_mfma_f32_16x16x32_bf16 v[100:103], v[236:239], v[148:151], v[100:103]
    buffer_load_dwordx4 v[216:219], v26, s[8:11], s35 offen offset:1024 sc1
    s_waitcnt lgkmcnt(2)
    v_fmac_f32 v60, v255, v244
    v_mfma_f32_16x16x32_bf16 v[104:107], v[236:239], v[152:155], v[104:107]
    v_fmac_f32 v61, v255, v245
    v_fmac_f32 v62, v255, v246
    v_mfma_f32_16x16x32_bf16 v[108:111], v[236:239], v[156:159], v[108:111]
    v_fmac_f32 v63, v255, v247
    v_mfma_f32_16x16x32_bf16 v[112:115], v[240:243], v[144:147], v[112:115]
    ds_read_b128 v[236:239], v29 offset:9216
    ds_read_b128 v[244:247], v30 offset:192
    v_mfma_f32_16x16x32_bf16 v[116:119], v[240:243], v[148:151], v[116:119]
    buffer_load_dwordx4 v[220:223], v27, s[8:11], s35 offen offset:1024 sc1
    s_waitcnt lgkmcnt(2)
    v_fmac_f32 v76, v255, v248
    v_mfma_f32_16x16x32_bf16 v[120:123], v[240:243], v[152:155], v[120:123]
    v_fmac_f32 v77, v255, v249
    v_fmac_f32 v78, v255, v250
    v_mfma_f32_16x16x32_bf16 v[124:127], v[240:243], v[156:159], v[124:127]
    v_fmac_f32 v79, v255, v251
    v_mfma_f32_16x16x32_bf16 v[128:131], v[224:227], v[144:147], v[128:131]
    ds_read_b128 v[240:243], v29 offset:10240
    ds_read_b128 v[248:251], v30 offset:256
    v_mfma_f32_16x16x32_bf16 v[132:135], v[224:227], v[148:151], v[132:135]
    buffer_load_dwordx4 a[96:99], v1, s[8:11], s93 offen offset:0 sc1
    s_waitcnt lgkmcnt(2)
    v_fmac_f32 v92, v255, v244
    v_mfma_f32_16x16x32_bf16 v[136:139], v[224:227], v[152:155], v[136:139]
    s_add_u32 s93, s77, 24576
    v_fmac_f32 v93, v255, v245
    v_fmac_f32 v94, v255, v246
    v_mfma_f32_16x16x32_bf16 v[140:143], v[224:227], v[156:159], v[140:143]
    s_waitcnt vmcnt(24)
    v_fmac_f32 v95, v255, v247
    v_mfma_f32_16x16x32_bf16 v[32:35], v[228:231], v[160:163], v[32:35]
    s_add_u32 s52, s3, 1
    ds_read_b128 v[224:227], v29 offset:11264
    s_and_b32 s52, s52, 3
    s_mul_i32 s55, s52, 57344
    v_mfma_f32_16x16x32_bf16 v[36:39], v[228:231], v[164:167], v[36:39]
    buffer_load_dwordx4 a[100:103], v1, s[8:11], s93 offen offset:1024 sc1
    v_add_u32 v25, s55, v1
    s_mul_i32 s55, s52, 12288
    v_mfma_f32_16x16x32_bf16 v[40:43], v[228:231], v[168:171], v[40:43]
    s_add_u32 s93, s77, 24576
    s_add_u32 s44, s55, 116736
    s_add_u32 s52, s3, 2
    s_and_b32 s52, s52, 3
    v_mfma_f32_16x16x32_bf16 v[44:47], v[228:231], v[172:175], v[44:47]
    s_waitcnt vmcnt(19)
    s_mul_i32 s55, s52, 57344
    v_add_u32 v26, s55, v1
    s_mul_i32 s55, s52, 12288
    v_mfma_f32_16x16x32_bf16 v[32:35], v[232:235], v[176:179], v[32:35]
    s_add_u32 s45, s55, 112640
    ds_read_b128 v[228:231], v29 offset:12288
    s_add_u32 s52, s3, 3
    s_and_b32 s52, s52, 3
    v_mfma_f32_16x16x32_bf16 v[36:39], v[232:235], v[180:183], v[36:39]
    s_mul_i32 s55, s52, 57344
    buffer_load_dwordx4 a[104:107], v1, s[8:11], s93 offen offset:2048 sc1
    v_add_u32 v27, s55, v1
    s_mul_i32 s55, s52, 12288
    v_mfma_f32_16x16x32_bf16 v[40:43], v[232:235], v[184:187], v[40:43]
    s_add_u32 s93, s77, 24576
    s_add_u32 s46, s55, 108544
    s_add_u32 s52, s3, 4
    s_and_b32 s52, s52, 3
    v_mfma_f32_16x16x32_bf16 v[44:47], v[232:235], v[188:191], v[44:47]
    s_waitcnt vmcnt(15)
    s_mul_i32 s55, s52, 57344
    v_add_u32 v244, s55, v1
    v_mfma_f32_16x16x32_bf16 v[32:35], v[236:239], v[192:195], v[32:35]
    ds_read_b128 v[232:235], v29 offset:13312
    v_mfma_f32_16x16x32_bf16 v[36:39], v[236:239], v[196:199], v[36:39]
    buffer_load_dwordx4 a[108:111], v1, s[8:11], s93 offen offset:3072 sc1
    v_mfma_f32_16x16x32_bf16 v[40:43], v[236:239], v[200:203], v[40:43]
    s_add_u32 s93, s77, 28672
    v_mfma_f32_16x16x32_bf16 v[44:47], v[236:239], v[204:207], v[44:47]
    s_waitcnt vmcnt(12) lgkmcnt(4)
    v_mfma_f32_16x16x32_bf16 v[32:35], v[240:243], a[224:227], v[32:35]
    ds_read_b128 v[236:239], v29 offset:14336
    v_mfma_f32_16x16x32_bf16 v[36:39], v[240:243], a[228:231], v[36:39]
    buffer_load_dwordx4 a[112:115], v1, s[8:11], s93 offen offset:0 sc1
    v_mfma_f32_16x16x32_bf16 v[40:43], v[240:243], a[232:235], v[40:43]
    s_add_u32 s93, s77, 28672
    v_mfma_f32_16x16x32_bf16 v[44:47], v[240:243], a[236:239], v[44:47]
    s_waitcnt vmcnt(9) lgkmcnt(3)
    v_mfma_f32_16x16x32_bf16 v[32:35], v[224:227], a[240:243], v[32:35]
    ds_read_b128 v[240:243], v29 offset:15360
    v_mfma_f32_16x16x32_bf16 v[36:39], v[224:227], a[244:247], v[36:39]
    buffer_load_dwordx4 a[116:119], v1, s[8:11], s93 offen offset:1024 sc1
    v_mfma_f32_16x16x32_bf16 v[40:43], v[224:227], a[248:251], v[40:43]
    s_add_u32 s93, s77, 28672
    v_mfma_f32_16x16x32_bf16 v[44:47], v[224:227], a[252:255], v[44:47]
    s_waitcnt vmcnt(6) lgkmcnt(3)
    v_mfma_f32_16x16x32_bf16 v[32:35], v[228:231], v[208:211], v[32:35]
    ds_read_b128 v[224:227], v29 offset:16384
    v_mfma_f32_16x16x32_bf16 v[36:39], v[228:231], v[212:215], v[36:39]
    buffer_load_dwordx4 a[120:123], v1, s[8:11], s93 offen offset:2048 sc1
    v_mfma_f32_16x16x32_bf16 v[40:43], v[228:231], v[216:219], v[40:43]
    s_add_u32 s93, s77, 28672
    v_mfma_f32_16x16x32_bf16 v[44:47], v[228:231], v[220:223], v[44:47]
    s_waitcnt lgkmcnt(3)
    s_nop 0
    v_mul_f32 v144, v32, v16
    v_mul_f32 v145, v33, v16
    v_mul_f32 v146, v36, v18
    v_mfma_f32_16x16x32_bf16 v[48:51], v[232:235], v[160:163], v[48:51]
    ds_read_b128 v[228:231], v29 offset:17408
    v_mul_f32 v147, v37, v18
    v_mul_f32 v148, v40, v20
    v_mfma_f32_16x16x32_bf16 v[52:55], v[232:235], v[164:167], v[52:55]
    buffer_load_dwordx4 a[124:127], v1, s[8:11], s93 offen offset:3072 sc1
    v_mul_f32 v149, v41, v20
    v_mul_f32 v150, v44, v22
    v_mfma_f32_16x16x32_bf16 v[56:59], v[232:235], v[168:171], v[56:59]
    s_add_u32 s93, s77, 32768
    v_mul_f32 v151, v45, v22
    v_exp_f32 v144, v144
    v_mfma_f32_16x16x32_bf16 v[60:63], v[232:235], v[172:175], v[60:63]
    s_waitcnt lgkmcnt(3)
    v_mul_f32 v32, v32, v34
    v_exp_f32 v145, v145
    v_mfma_f32_16x16x32_bf16 v[48:51], v[236:239], v[176:179], v[48:51]
    ds_read_b128 v[232:235], v29 offset:18432
    v_mul_f32 v33, v33, v35
    v_mfma_f32_16x16x32_bf16 v[52:55], v[236:239], v[180:183], v[52:55]
    buffer_load_dwordx4 a[128:131], v1, s[8:11], s93 offen offset:0 sc1
    v_exp_f32 v146, v146
    v_mfma_f32_16x16x32_bf16 v[56:59], v[236:239], v[184:187], v[56:59]
    s_add_u32 s93, s77, 32768
    v_mul_f32 v36, v36, v38
    v_exp_f32 v147, v147
    v_mfma_f32_16x16x32_bf16 v[60:63], v[236:239], v[188:191], v[60:63]
    s_waitcnt lgkmcnt(3)
    v_mul_f32 v37, v37, v39
    v_exp_f32 v148, v148
    v_mfma_f32_16x16x32_bf16 v[48:51], v[240:243], v[192:195], v[48:51]
    ds_read_b128 v[236:239], v29 offset:19456
    v_mul_f32 v40, v40, v42
    v_mfma_f32_16x16x32_bf16 v[52:55], v[240:243], v[196:199], v[52:55]
    buffer_load_dwordx4 a[132:135], v1, s[8:11], s93 offen offset:1024 sc1
    v_exp_f32 v149, v149
    v_mfma_f32_16x16x32_bf16 v[56:59], v[240:243], v[200:203], v[56:59]
    s_add_u32 s93, s77, 32768
    v_mul_f32 v41, v41, v43
    v_exp_f32 v150, v150
    v_mfma_f32_16x16x32_bf16 v[60:63], v[240:243], v[204:207], v[60:63]
    s_waitcnt lgkmcnt(3)
    v_mul_f32 v44, v44, v46
    v_exp_f32 v151, v151
    v_mfma_f32_16x16x32_bf16 v[48:51], v[224:227], a[224:227], v[48:51]
    ds_read_b128 v[240:243], v29 offset:20480
    v_mul_f32 v45, v45, v47
    v_fma_f32 v144, v144, v17, v17
    v_mfma_f32_16x16x32_bf16 v[52:55], v[224:227], a[228:231], v[52:55]
    buffer_load_dwordx4 a[136:139], v1, s[8:11], s93 offen offset:2048 sc1
    v_fma_f32 v145, v145, v17, v17
    v_fma_f32 v146, v146, v19, v19
    v_mfma_f32_16x16x32_bf16 v[56:59], v[224:227], a[232:235], v[56:59]
    s_add_u32 s93, s77, 32768
    v_fma_f32 v147, v147, v19, v19
    v_fma_f32 v148, v148, v21, v21
    v_fma_f32 v149, v149, v21, v21
    v_mfma_f32_16x16x32_bf16 v[60:63], v[224:227], a[236:239], v[60:63]
    s_waitcnt lgkmcnt(3)
    v_fma_f32 v150, v150, v23, v23
    v_fma_f32 v151, v151, v23, v23
    v_mfma_f32_16x16x32_bf16 v[48:51], v[228:231], a[240:243], v[48:51]
    ds_read_b128 v[224:227], v29 offset:21504
    v_rcp_f32 v144, v144
    v_mfma_f32_16x16x32_bf16 v[52:55], v[228:231], a[244:247], v[52:55]
    buffer_load_dwordx4 a[140:143], v1, s[8:11], s93 offen offset:3072 sc1
    v_rcp_f32 v145, v145
    v_mfma_f32_16x16x32_bf16 v[56:59], v[228:231], a[248:251], v[56:59]
    s_add_u32 s93, s77, 36864
    v_mul_f32 v32, v32, v144
    v_rcp_f32 v146, v146
    v_mfma_f32_16x16x32_bf16 v[60:63], v[228:231], a[252:255], v[60:63]
    s_waitcnt lgkmcnt(3)
    v_mul_f32 v33, v33, v145
    v_rcp_f32 v147, v147
    v_mfma_f32_16x16x32_bf16 v[48:51], v[232:235], v[208:211], v[48:51]
    ds_read_b128 v[228:231], v29 offset:22528
    v_mul_f32 v36, v36, v146
    v_mfma_f32_16x16x32_bf16 v[52:55], v[232:235], v[212:215], v[52:55]
    buffer_load_dwordx4 a[144:147], v1, s[8:11], s93 offen offset:0 sc1
    v_rcp_f32 v148, v148
    v_mfma_f32_16x16x32_bf16 v[56:59], v[232:235], v[216:219], v[56:59]
    s_add_u32 s93, s77, 36864
    v_mul_f32 v37, v37, v147
    v_rcp_f32 v149, v149
    v_mfma_f32_16x16x32_bf16 v[60:63], v[232:235], v[220:223], v[60:63]
    s_waitcnt lgkmcnt(3)
    v_mul_f32 v40, v40, v148
    v_rcp_f32 v150, v150
    s_barrier
    v_mfma_f32_16x16x32_bf16 v[64:67], v[236:239], v[160:163], v[64:67]
    ds_read_b128 v[232:235], v29 offset:23552
    v_mul_f32 v41, v41, v149
    v_mfma_f32_16x16x32_bf16 v[68:71], v[236:239], v[164:167], v[68:71]
    buffer_load_dwordx4 a[148:151], v1, s[8:11], s93 offen offset:1024 sc1
    v_rcp_f32 v151, v151
    v_mfma_f32_16x16x32_bf16 v[72:75], v[236:239], v[168:171], v[72:75]
    s_add_u32 s93, s77, 36864
    v_mul_f32 v44, v44, v150
    v_cvt_pk_bf16_f32 v152, v32, v33
    v_cvt_pk_bf16_f32 v154, v40, v41
    v_mfma_f32_16x16x32_bf16 v[76:79], v[236:239], v[172:175], v[76:79]
    s_waitcnt lgkmcnt(3)
    v_mul_f32 v45, v45, v151
    v_cvt_pk_bf16_f32 v153, v36, v37
    v_cvt_pk_bf16_f32 v155, v44, v45
    v_mfma_f32_16x16x32_bf16 v[64:67], v[240:243], v[176:179], v[64:67]
    ds_read_b128 v[236:239], v29 offset:24576
    v_permlane32_swap_b32 v152, v154
    v_mfma_f32_16x16x32_bf16 v[68:71], v[240:243], v[180:183], v[68:71]
    buffer_load_dwordx4 a[152:155], v1, s[8:11], s93 offen offset:2048 sc1
    v_permlane32_swap_b32 v153, v155
    v_mfma_f32_16x16x32_bf16 v[72:75], v[240:243], v[184:187], v[72:75]
    s_add_u32 s93, s77, 36864
    s_add_u32 s91, s81, 0
    v_permlane16_swap_b32 v152, v153
    v_mfma_f32_16x16x32_bf16 v[76:79], v[240:243], v[188:191], v[76:79]
    s_waitcnt lgkmcnt(3)
    v_permlane16_swap_b32 v154, v155
    buffer_store_dwordx4 v[152:155], v28, s[8:11], s91 offen sc1
    v_mfma_f32_16x16x32_bf16 v[64:67], v[224:227], v[192:195], v[64:67]
    ds_read_b128 v[240:243], v29 offset:25600
    v_mul_f32 v144, v48, v16
    v_mul_f32 v145, v49, v16
    v_mfma_f32_16x16x32_bf16 v[68:71], v[224:227], v[196:199], v[68:71]
    buffer_load_dwordx4 a[156:159], v1, s[8:11], s93 offen offset:3072 sc1
    v_mul_f32 v146, v52, v18
    v_mul_f32 v147, v53, v18
    v_mfma_f32_16x16x32_bf16 v[72:75], v[224:227], v[200:203], v[72:75]
    s_add_u32 s93, s77, 40960
    v_mul_f32 v148, v56, v20
    v_mul_f32 v149, v57, v20
    v_mul_f32 v150, v60, v22
    v_mfma_f32_16x16x32_bf16 v[76:79], v[224:227], v[204:207], v[76:79]
    s_waitcnt lgkmcnt(3)
    v_mul_f32 v151, v61, v22
    v_exp_f32 v144, v144
    v_mfma_f32_16x16x32_bf16 v[64:67], v[228:231], a[224:227], v[64:67]
    ds_read_b128 v[224:227], v29 offset:26624
    v_mul_f32 v48, v48, v50
    v_mfma_f32_16x16x32_bf16 v[68:71], v[228:231], a[228:231], v[68:71]
    buffer_load_dwordx4 a[160:163], v1, s[8:11], s93 offen offset:0 sc1
    v_exp_f32 v145, v145
    v_mfma_f32_16x16x32_bf16 v[72:75], v[228:231], a[232:235], v[72:75]
    s_add_u32 s93, s77, 40960
    v_mul_f32 v49, v49, v51
    v_exp_f32 v146, v146
    v_mfma_f32_16x16x32_bf16 v[76:79], v[228:231], a[236:239], v[76:79]
    s_waitcnt lgkmcnt(3)
    v_mul_f32 v52, v52, v54
    v_exp_f32 v147, v147
    v_mfma_f32_16x16x32_bf16 v[64:67], v[232:235], a[240:243], v[64:67]
    ds_read_b128 v[228:231], v29 offset:27648
    v_mul_f32 v53, v53, v55
    v_mfma_f32_16x16x32_bf16 v[68:71], v[232:235], a[244:247], v[68:71]
    buffer_load_dwordx4 a[164:167], v1, s[8:11], s93 offen offset:1024 sc1
    v_exp_f32 v148, v148
    v_mfma_f32_16x16x32_bf16 v[72:75], v[232:235], a[248:251], v[72:75]
    s_add_u32 s93, s77, 40960
    v_mul_f32 v56, v56, v58
    v_exp_f32 v149, v149
    v_mfma_f32_16x16x32_bf16 v[76:79], v[232:235], a[252:255], v[76:79]
    s_waitcnt lgkmcnt(3)
    v_mul_f32 v57, v57, v59
    v_exp_f32 v150, v150
    v_mfma_f32_16x16x32_bf16 v[64:67], v[236:239], v[208:211], v[64:67]
    ds_read_b128 v[232:235], v29 offset:28672
    v_mul_f32 v60, v60, v62
    v_mfma_f32_16x16x32_bf16 v[68:71], v[236:239], v[212:215], v[68:71]
    buffer_load_dwordx4 a[168:171], v1, s[8:11], s93 offen offset:2048 sc1
    v_exp_f32 v151, v151
    v_mfma_f32_16x16x32_bf16 v[72:75], v[236:239], v[216:219], v[72:75]
    s_add_u32 s93, s77, 40960
    v_mul_f32 v61, v61, v63
    v_fma_f32 v144, v144, v17, v17
    v_fma_f32 v145, v145, v17, v17
    v_mfma_f32_16x16x32_bf16 v[76:79], v[236:239], v[220:223], v[76:79]
    s_waitcnt lgkmcnt(3)
    v_fma_f32 v146, v146, v19, v19
    v_fma_f32 v147, v147, v19, v19
    v_fma_f32 v148, v148, v21, v21
    v_mfma_f32_16x16x32_bf16 v[80:83], v[240:243], v[160:163], v[80:83]
    ds_read_b128 v[236:239], v29 offset:29696
    v_fma_f32 v149, v149, v21, v21
    v_fma_f32 v150, v150, v23, v23
    v_mfma_f32_16x16x32_bf16 v[84:87], v[240:243], v[164:167], v[84:87]
    buffer_load_dwordx4 a[172:175], v1, s[8:11], s93 offen offset:3072 sc1
    v_fma_f32 v151, v151, v23, v23
    v_mfma_f32_16x16x32_bf16 v[88:91], v[240:243], v[168:171], v[88:91]
    s_add_u32 s93, s77, 45056
    v_rcp_f32 v144, v144
    v_mfma_f32_16x16x32_bf16 v[92:95], v[240:243], v[172:175], v[92:95]
    s_waitcnt lgkmcnt(3)
    v_rcp_f32 v145, v145
    v_mul_f32 v48, v48, v144
    v_mfma_f32_16x16x32_bf16 v[80:83], v[224:227], v[176:179], v[80:83]
    ds_read_b128 v[240:243], v29 offset:30720
    v_rcp_f32 v146, v146
    v_mfma_f32_16x16x32_bf16 v[84:87], v[224:227], v[180:183], v[84:87]
    buffer_load_dwordx4 a[176:179], v1, s[8:11], s93 offen offset:0 sc1
    v_mul_f32 v49, v49, v145
    v_mfma_f32_16x16x32_bf16 v[88:91], v[224:227], v[184:187], v[88:91]
    s_add_u32 s93, s77, 45056
    v_rcp_f32 v147, v147
    v_mul_f32 v52, v52, v146
    v_mfma_f32_16x16x32_bf16 v[92:95], v[224:227], v[188:191], v[92:95]
    s_waitcnt lgkmcnt(3)
    v_rcp_f32 v148, v148
    v_mul_f32 v53, v53, v147
    v_mfma_f32_16x16x32_bf16 v[80:83], v[228:231], v[192:195], v[80:83]
    ds_read_b128 v[224:227], v29 offset:31744
    v_rcp_f32 v149, v149
    v_mfma_f32_16x16x32_bf16 v[84:87], v[228:231], v[196:199], v[84:87]
    buffer_load_dwordx4 a[180:183], v1, s[8:11], s93 offen offset:1024 sc1
    v_mul_f32 v56, v56, v148
    v_mfma_f32_16x16x32_bf16 v[88:91], v[228:231], v[200:203], v[88:91]
    s_add_u32 s93, s77, 45056
    v_rcp_f32 v150, v150
    v_mul_f32 v57, v57, v149
    v_mfma_f32_16x16x32_bf16 v[92:95], v[228:231], v[204:207], v[92:95]
    s_waitcnt lgkmcnt(3)
    v_rcp_f32 v151, v151
    v_mul_f32 v60, v60, v150
    v_mfma_f32_16x16x32_bf16 v[80:83], v[232:235], a[224:227], v[80:83]
    ds_read_b128 v[228:231], v29 offset:32768
    v_mov_b32 v31, 1
    s_waitcnt vmcnt(7)
    v_mfma_f32_16x16x32_bf16 v[84:87], v[232:235], a[228:231], v[84:87]
    buffer_load_dwordx4 a[184:187], v1, s[8:11], s93 offen offset:2048 sc1
    buffer_store_dword v31, v5, s[8:11], s82 offen
    v_cvt_pk_bf16_f32 v156, v48, v49
    v_mfma_f32_16x16x32_bf16 v[88:91], v[232:235], a[232:235], v[88:91]
    s_add_u32 s93, s77, 45056
    v_cvt_pk_bf16_f32 v158, v56, v57
    v_mul_f32 v61, v61, v151
    v_cvt_pk_bf16_f32 v157, v52, v53
    v_mfma_f32_16x16x32_bf16 v[92:95], v[232:235], a[236:239], v[92:95]
    s_waitcnt lgkmcnt(3)
    v_cvt_pk_bf16_f32 v159, v60, v61
    v_permlane32_swap_b32 v156, v158
    v_mfma_f32_16x16x32_bf16 v[80:83], v[236:239], a[240:243], v[80:83]
    ds_read_b128 v[232:235], v29 offset:33792
    v_permlane32_swap_b32 v157, v159
    v_mfma_f32_16x16x32_bf16 v[84:87], v[236:239], a[244:247], v[84:87]
    s_add_u32 s91, s81, 8192
    buffer_load_dwordx4 a[188:191], v1, s[8:11], s93 offen offset:3072 sc1
    v_permlane16_swap_b32 v156, v157
    v_mfma_f32_16x16x32_bf16 v[88:91], v[236:239], a[248:251], v[88:91]
    s_add_u32 s93, s77, 49152
    v_permlane16_swap_b32 v158, v159
    buffer_store_dwordx4 v[156:159], v28, s[8:11], s91 offen sc1
    v_mfma_f32_16x16x32_bf16 v[92:95], v[236:239], a[252:255], v[92:95]
    s_waitcnt lgkmcnt(3)
    v_mul_f32 v144, v64, v16
    v_mul_f32 v145, v65, v16
    v_mul_f32 v146, v68, v18
    v_mfma_f32_16x16x32_bf16 v[80:83], v[240:243], v[208:211], v[80:83]
    ds_read_b128 v[236:239], v29 offset:34816
    v_mul_f32 v147, v69, v18
    v_mul_f32 v148, v72, v20
    v_mfma_f32_16x16x32_bf16 v[84:87], v[240:243], v[212:215], v[84:87]
    buffer_load_dwordx4 a[192:195], v1, s[8:11], s93 offen offset:0 sc1
    v_mul_f32 v149, v73, v20
    v_mul_f32 v150, v76, v22
    v_mfma_f32_16x16x32_bf16 v[88:91], v[240:243], v[216:219], v[88:91]
    s_add_u32 s93, s77, 49152
    v_mul_f32 v151, v77, v22
    v_exp_f32 v144, v144
    v_mfma_f32_16x16x32_bf16 v[92:95], v[240:243], v[220:223], v[92:95]
    s_waitcnt lgkmcnt(3)
    v_mul_f32 v64, v64, v66
    v_exp_f32 v145, v145
    s_barrier
    v_mfma_f32_16x16x32_bf16 v[96:99], v[224:227], v[160:163], v[96:99]
    ds_read_b128 v[240:243], v29 offset:35840
    v_mul_f32 v65, v65, v67
    v_mfma_f32_16x16x32_bf16 v[100:103], v[224:227], v[164:167], v[100:103]
    buffer_load_dwordx4 a[196:199], v1, s[8:11], s93 offen offset:1024 sc1
    v_exp_f32 v146, v146
    v_mfma_f32_16x16x32_bf16 v[104:107], v[224:227], v[168:171], v[104:107]
    s_add_u32 s93, s77, 49152
    v_mul_f32 v68, v68, v70
    v_exp_f32 v147, v147
    v_mfma_f32_16x16x32_bf16 v[108:111], v[224:227], v[172:175], v[108:111]
    s_waitcnt lgkmcnt(3)
    v_mul_f32 v69, v69, v71
    v_exp_f32 v148, v148
    v_mfma_f32_16x16x32_bf16 v[96:99], v[228:231], v[176:179], v[96:99]
    ds_read_b128 v[224:227], v29 offset:36864
    v_mul_f32 v72, v72, v74
    v_mfma_f32_16x16x32_bf16 v[100:103], v[228:231], v[180:183], v[100:103]
    buffer_load_dwordx4 a[200:203], v1, s[8:11], s93 offen offset:2048 sc1
    v_exp_f32 v149, v149
    v_mfma_f32_16x16x32_bf16 v[104:107], v[228:231], v[184:187], v[104:107]
    s_add_u32 s93, s77, 49152
    v_mul_f32 v73, v73, v75
    v_exp_f32 v150, v150
    v_mfma_f32_16x16x32_bf16 v[108:111], v[228:231], v[188:191], v[108:111]
    s_waitcnt lgkmcnt(3)
    v_mul_f32 v76, v76, v78
    v_exp_f32 v151, v151
    v_mfma_f32_16x16x32_bf16 v[96:99], v[232:235], v[192:195], v[96:99]
    ds_read_b128 v[228:231], v29 offset:37888
    v_mul_f32 v77, v77, v79
    v_fma_f32 v144, v144, v17, v17
    v_mfma_f32_16x16x32_bf16 v[100:103], v[232:235], v[196:199], v[100:103]
    buffer_load_dwordx4 a[204:207], v1, s[8:11], s93 offen offset:3072 sc1
    v_fma_f32 v145, v145, v17, v17
    v_fma_f32 v146, v146, v19, v19
    v_mfma_f32_16x16x32_bf16 v[104:107], v[232:235], v[200:203], v[104:107]
    s_add_u32 s93, s77, 53248
    v_fma_f32 v147, v147, v19, v19
    v_fma_f32 v148, v148, v21, v21
    v_fma_f32 v149, v149, v21, v21
    v_mfma_f32_16x16x32_bf16 v[108:111], v[232:235], v[204:207], v[108:111]
    s_waitcnt lgkmcnt(3)
    v_fma_f32 v150, v150, v23, v23
    v_fma_f32 v151, v151, v23, v23
    v_mfma_f32_16x16x32_bf16 v[96:99], v[236:239], a[224:227], v[96:99]
    ds_read_b128 v[232:235], v29 offset:38912
    buffer_load_dword v30, v24, s[8:11], s79 offen sc1
    v_mfma_f32_16x16x32_bf16 v[100:103], v[236:239], a[228:231], v[100:103]
    buffer_load_dwordx4 a[208:211], v1, s[8:11], s93 offen offset:0 sc1
    v_rcp_f32 v144, v144
    v_mfma_f32_16x16x32_bf16 v[104:107], v[236:239], a[232:235], v[104:107]
    s_add_u32 s93, s77, 53248
    v_rcp_f32 v145, v145
    v_mul_f32 v64, v64, v144
    v_mfma_f32_16x16x32_bf16 v[108:111], v[236:239], a[236:239], v[108:111]
    s_waitcnt lgkmcnt(3)
    v_rcp_f32 v146, v146
    v_mul_f32 v65, v65, v145
    v_mfma_f32_16x16x32_bf16 v[96:99], v[240:243], a[240:243], v[96:99]
    ds_read_b128 v[236:239], v29 offset:39936
    v_rcp_f32 v147, v147
    v_mfma_f32_16x16x32_bf16 v[100:103], v[240:243], a[244:247], v[100:103]
    buffer_load_dwordx4 a[212:215], v1, s[8:11], s93 offen offset:1024 sc1
    v_mul_f32 v68, v68, v146
    v_mfma_f32_16x16x32_bf16 v[104:107], v[240:243], a[248:251], v[104:107]
    s_add_u32 s93, s77, 53248
    v_rcp_f32 v148, v148
    v_mul_f32 v69, v69, v147
    v_mfma_f32_16x16x32_bf16 v[108:111], v[240:243], a[252:255], v[108:111]
    s_waitcnt lgkmcnt(3)
    v_rcp_f32 v149, v149
    v_mul_f32 v72, v72, v148
    v_mfma_f32_16x16x32_bf16 v[96:99], v[224:227], v[208:211], v[96:99]
    ds_read_b128 v[240:243], v29 offset:40960
    v_rcp_f32 v150, v150
    v_mfma_f32_16x16x32_bf16 v[100:103], v[224:227], v[212:215], v[100:103]
    buffer_load_dwordx4 a[216:219], v1, s[8:11], s93 offen offset:2048 sc1
    v_mul_f32 v73, v73, v149
    v_mfma_f32_16x16x32_bf16 v[104:107], v[224:227], v[216:219], v[104:107]
    s_add_u32 s93, s77, 53248
    v_rcp_f32 v151, v151
    v_mul_f32 v76, v76, v150
    v_mfma_f32_16x16x32_bf16 v[108:111], v[224:227], v[220:223], v[108:111]
    s_waitcnt lgkmcnt(3)
    v_mov_b32 v31, 2
    s_waitcnt vmcnt(8)
    buffer_store_dword v31, v5, s[8:11], s82 offen
    v_mfma_f32_16x16x32_bf16 v[112:115], v[228:231], v[160:163], v[112:115]
    ds_read_b128 v[224:227], v29 offset:41984
    v_cvt_pk_bf16_f32 v152, v64, v65
    v_cvt_pk_bf16_f32 v154, v72, v73
    v_mfma_f32_16x16x32_bf16 v[116:119], v[228:231], v[164:167], v[116:119]
    buffer_load_dwordx4 a[220:223], v1, s[8:11], s93 offen offset:3072 sc1
    v_mul_f32 v77, v77, v151
    v_cvt_pk_bf16_f32 v153, v68, v69
    v_mfma_f32_16x16x32_bf16 v[120:123], v[228:231], v[168:171], v[120:123]
    v_cvt_pk_bf16_f32 v155, v76, v77
    v_permlane32_swap_b32 v152, v154
    v_mfma_f32_16x16x32_bf16 v[124:127], v[228:231], v[172:175], v[124:127]
    s_waitcnt lgkmcnt(3)
    v_permlane32_swap_b32 v153, v155
    s_add_u32 s91, s81, 16384
    v_mfma_f32_16x16x32_bf16 v[112:115], v[232:235], v[176:179], v[112:115]
    ds_read_b128 v[228:231], v29 offset:43008
    v_permlane16_swap_b32 v152, v153
    v_mfma_f32_16x16x32_bf16 v[116:119], v[232:235], v[180:183], v[116:119]
    v_permlane16_swap_b32 v154, v155
    buffer_store_dwordx4 v[152:155], v28, s[8:11], s91 offen sc1
    v_mfma_f32_16x16x32_bf16 v[120:123], v[232:235], v[184:187], v[120:123]
    v_mul_f32 v144, v80, v16
    v_mul_f32 v145, v81, v16
    v_mul_f32 v146, v84, v18
    v_mfma_f32_16x16x32_bf16 v[124:127], v[232:235], v[188:191], v[124:127]
    s_waitcnt lgkmcnt(3)
    v_mul_f32 v147, v85, v18
    v_mul_f32 v148, v88, v20
    v_mul_f32 v149, v89, v20
    v_mfma_f32_16x16x32_bf16 v[112:115], v[236:239], v[192:195], v[112:115]
    ds_read_b128 v[232:235], v29 offset:44032
    v_mul_f32 v150, v92, v22
    v_mul_f32 v151, v93, v22
    v_mfma_f32_16x16x32_bf16 v[116:119], v[236:239], v[196:199], v[116:119]
    v_exp_f32 v144, v144
    v_mul_f32 v80, v80, v82
    v_mfma_f32_16x16x32_bf16 v[120:123], v[236:239], v[200:203], v[120:123]
    v_exp_f32 v145, v145
    v_mul_f32 v81, v81, v83
    v_mfma_f32_16x16x32_bf16 v[124:127], v[236:239], v[204:207], v[124:127]
    s_waitcnt lgkmcnt(3)
    v_exp_f32 v146, v146
    v_mul_f32 v84, v84, v86
    v_mfma_f32_16x16x32_bf16 v[112:115], v[240:243], a[224:227], v[112:115]
    ds_read_b128 v[236:239], v29 offset:45056
    v_exp_f32 v147, v147
    v_mfma_f32_16x16x32_bf16 v[116:119], v[240:243], a[228:231], v[116:119]
    v_mul_f32 v85, v85, v87
    v_exp_f32 v148, v148
    v_mfma_f32_16x16x32_bf16 v[120:123], v[240:243], a[232:235], v[120:123]
    v_mul_f32 v88, v88, v90
    v_exp_f32 v149, v149
    v_mfma_f32_16x16x32_bf16 v[124:127], v[240:243], a[236:239], v[124:127]
    s_waitcnt lgkmcnt(3)
    v_mul_f32 v89, v89, v91
    v_exp_f32 v150, v150
    s_waitcnt vmcnt(6)
    v_cmp_gt_u32 vcc, 1, v30
    s_nop 0
    s_cbranch_vccnz poll3
poll3_ok:
    v_mfma_f32_16x16x32_bf16 v[112:115], v[224:227], a[240:243], v[112:115]
    ds_read_b128 v[240:243], v29 offset:46080
    v_mul_f32 v92, v92, v94
    v_mfma_f32_16x16x32_bf16 v[116:119], v[224:227], a[244:247], v[116:119]
    buffer_load_dwordx4 v[32:35], v25, s[8:11], s36 offen offset:0 sc1
    v_exp_f32 v151, v151
    v_mfma_f32_16x16x32_bf16 v[120:123], v[224:227], a[248:251], v[120:123]
    v_mul_f32 v93, v93, v95
    v_fma_f32 v144, v144, v17, v17
    v_fma_f32 v145, v145, v17, v17
    v_mfma_f32_16x16x32_bf16 v[124:127], v[224:227], a[252:255], v[124:127]
    s_waitcnt lgkmcnt(3)
    v_fma_f32 v146, v146, v19, v19
    v_fma_f32 v147, v147, v19, v19
    v_fma_f32 v148, v148, v21, v21
    v_mfma_f32_16x16x32_bf16 v[112:115], v[228:231], v[208:211], v[112:115]
    ds_read_b128 v[224:227], v29 offset:47104
    buffer_load_dwordx4 v[36:39], v26, s[8:11], s36 offen offset:0 sc1
    v_fma_f32 v149, v149, v21, v21
    v_mfma_f32_16x16x32_bf16 v[116:119], v[228:231], v[212:215], v[116:119]
    buffer_load_dword v30, v24, s[8:11], s79 offen sc1
    v_fma_f32 v150, v150, v23, v23
    v_fma_f32 v151, v151, v23, v23
    v_mfma_f32_16x16x32_bf16 v[120:123], v[228:231], v[216:219], v[120:123]
    v_rcp_f32 v144, v144
    v_mfma_f32_16x16x32_bf16 v[124:127], v[228:231], v[220:223], v[124:127]
    s_waitcnt lgkmcnt(3)
    buffer_load_dwordx4 v[40:43], v27, s[8:11], s36 offen offset:0 sc1
    v_rcp_f32 v145, v145
    v_mfma_f32_16x16x32_bf16 v[128:131], v[232:235], v[160:163], v[128:131]
    ds_read_b128 v[228:231], v29 offset:48128
    v_mul_f32 v80, v80, v144
    v_mfma_f32_16x16x32_bf16 v[132:135], v[232:235], v[164:167], v[132:135]
    v_rcp_f32 v146, v146
    v_mul_f32 v81, v81, v145
    v_mfma_f32_16x16x32_bf16 v[136:139], v[232:235], v[168:171], v[136:139]
    buffer_load_dwordx4 v[44:47], v244, s[8:11], s36 offen offset:0 sc1
    v_rcp_f32 v147, v147
    v_mfma_f32_16x16x32_bf16 v[140:143], v[232:235], v[172:175], v[140:143]
    s_waitcnt lgkmcnt(3)
    v_mul_f32 v84, v84, v146
    v_rcp_f32 v148, v148
    v_mfma_f32_16x16x32_bf16 v[128:131], v[236:239], v[176:179], v[128:131]
    ds_read_b128 v[232:235], v29 offset:49152
    v_mul_f32 v85, v85, v147
    v_mfma_f32_16x16x32_bf16 v[132:135], v[236:239], v[180:183], v[132:135]
    buffer_load_dwordx4 v[48:51], v25, s[8:11], s36 offen offset:1024 sc1
    v_rcp_f32 v149, v149
    v_mfma_f32_16x16x32_bf16 v[136:139], v[236:239], v[184:187], v[136:139]
    v_mul_f32 v88, v88, v148
    v_rcp_f32 v150, v150
    v_mfma_f32_16x16x32_bf16 v[140:143], v[236:239], v[188:191], v[140:143]
    s_waitcnt lgkmcnt(3)
    v_mul_f32 v89, v89, v149
    v_rcp_f32 v151, v151
    v_mfma_f32_16x16x32_bf16 v[128:131], v[240:243], v[192:195], v[128:131]
    buffer_load_dwordx4 v[52:55], v26, s[8:11], s36 offen offset:1024 sc1
    v_mul_f32 v92, v92, v150
    v_mov_b32 v31, 3
    v_mfma_f32_16x16x32_bf16 v[132:135], v[240:243], v[196:199], v[132:135]
    s_waitcnt vmcnt(7)
    buffer_store_dword v31, v5, s[8:11], s82 offen
    v_cvt_pk_bf16_f32 v156, v80, v81
    v_cvt_pk_bf16_f32 v158, v88, v89
    v_mfma_f32_16x16x32_bf16 v[136:139], v[240:243], v[200:203], v[136:139]
    v_mul_f32 v93, v93, v151
    v_cvt_pk_bf16_f32 v157, v84, v85
    v_cvt_pk_bf16_f32 v159, v92, v93
    v_mfma_f32_16x16x32_bf16 v[140:143], v[240:243], v[204:207], v[140:143]
    s_waitcnt lgkmcnt(2)
    buffer_load_dwordx4 v[56:59], v27, s[8:11], s36 offen offset:1024 sc1
    v_permlane32_swap_b32 v156, v158
    v_mfma_f32_16x16x32_bf16 v[128:131], v[224:227], a[224:227], v[128:131]
    v_permlane32_swap_b32 v157, v159
    s_add_u32 s91, s81, 24576
    v_mfma_f32_16x16x32_bf16 v[132:135], v[224:227], a[228:231], v[132:135]
    v_permlane16_swap_b32 v156, v157
    v_mfma_f32_16x16x32_bf16 v[136:139], v[224:227], a[232:235], v[136:139]
    buffer_load_dwordx4 v[60:63], v244, s[8:11], s36 offen offset:1024 sc1
    v_permlane16_swap_b32 v158, v159
    v_mfma_f32_16x16x32_bf16 v[140:143], v[224:227], a[236:239], v[140:143]
    s_waitcnt lgkmcnt(1)
    buffer_store_dwordx4 v[156:159], v28, s[8:11], s91 offen sc1
    v_mul_f32 v144, v96, v16
    v_mul_f32 v145, v97, v16
    v_mfma_f32_16x16x32_bf16 v[128:131], v[228:231], a[240:243], v[128:131]
    v_mul_f32 v146, v100, v18
    v_mul_f32 v147, v101, v18
    v_mul_f32 v148, v104, v20
    v_mfma_f32_16x16x32_bf16 v[132:135], v[228:231], a[244:247], v[132:135]
    v_mul_f32 v149, v105, v20
    v_mul_f32 v150, v108, v22
    v_mul_f32 v151, v109, v22
    v_mfma_f32_16x16x32_bf16 v[136:139], v[228:231], a[248:251], v[136:139]
    v_exp_f32 v144, v144
    v_mul_f32 v96, v96, v98
    v_mfma_f32_16x16x32_bf16 v[140:143], v[228:231], a[252:255], v[140:143]
    s_waitcnt lgkmcnt(0)
    v_exp_f32 v145, v145
    v_mul_f32 v97, v97, v99
    v_mfma_f32_16x16x32_bf16 v[128:131], v[232:235], v[208:211], v[128:131]
    v_exp_f32 v146, v146
    v_mul_f32 v100, v100, v102
    v_mfma_f32_16x16x32_bf16 v[132:135], v[232:235], v[212:215], v[132:135]
    v_exp_f32 v147, v147
    v_mul_f32 v101, v101, v103
    v_mfma_f32_16x16x32_bf16 v[136:139], v[232:235], v[216:219], v[136:139]
    v_exp_f32 v148, v148
    v_mul_f32 v104, v104, v106
    v_mfma_f32_16x16x32_bf16 v[140:143], v[232:235], v[220:223], v[140:143]
    v_exp_f32 v149, v149
    v_mul_f32 v105, v105, v107
    s_cmp_ge_u32 s5, 28
    s_cbranch_scc1 dn_idle0
    s_waitcnt vmcnt(8)
    v_cmp_gt_u32 vcc, 2, v30
    s_nop 0
    s_cbranch_vccnz poll4
poll4_ok:
    v_mfma_f32_16x16x32_bf16 v[160:163], a[0:3], v[32:35], 0
    v_exp_f32 v150, v150
    v_mul_f32 v108, v108, v110
    v_mfma_f32_16x16x32_bf16 v[164:167], a[4:7], v[32:35], 0
    buffer_load_dwordx4 v[64:67], v25, s[8:11], s37 offen offset:0 sc1
    v_exp_f32 v151, v151
    v_mfma_f32_16x16x32_bf16 v[168:171], a[8:11], v[32:35], 0
    v_mul_f32 v109, v109, v111
    v_fma_f32 v144, v144, v17, v17
    v_fma_f32 v145, v145, v17, v17
    v_mfma_f32_16x16x32_bf16 v[172:175], a[12:15], v[32:35], 0
    v_fma_f32 v146, v146, v19, v19
    v_fma_f32 v147, v147, v19, v19
    v_fma_f32 v148, v148, v21, v21
    v_mfma_f32_16x16x32_bf16 v[176:179], a[0:3], v[36:39], 0
    buffer_load_dwordx4 v[68:71], v26, s[8:11], s37 offen offset:0 sc1
    v_fma_f32 v149, v149, v21, v21
    v_fma_f32 v150, v150, v23, v23
    v_mfma_f32_16x16x32_bf16 v[180:183], a[4:7], v[36:39], 0
    buffer_load_dword v30, v24, s[8:11], s79 offen sc1
    v_fma_f32 v151, v151, v23, v23
    v_mfma_f32_16x16x32_bf16 v[184:187], a[8:11], v[36:39], 0
    v_rcp_f32 v144, v144
    v_mfma_f32_16x16x32_bf16 v[188:191], a[12:15], v[36:39], 0
    s_waitcnt vmcnt(10)
    buffer_load_dwordx4 v[72:75], v27, s[8:11], s37 offen offset:0 sc1
    v_rcp_f32 v145, v145
    v_mfma_f32_16x16x32_bf16 v[192:195], a[0:3], v[40:43], 0
    v_mul_f32 v96, v96, v144
    v_rcp_f32 v146, v146
    v_mfma_f32_16x16x32_bf16 v[196:199], a[4:7], v[40:43], 0
    v_mul_f32 v97, v97, v145
    v_rcp_f32 v147, v147
    v_mfma_f32_16x16x32_bf16 v[200:203], a[8:11], v[40:43], 0
    buffer_load_dwordx4 v[76:79], v244, s[8:11], s37 offen offset:0 sc1
    v_mul_f32 v100, v100, v146
    v_mfma_f32_16x16x32_bf16 v[204:207], a[12:15], v[40:43], 0
    s_waitcnt vmcnt(11)
    v_rcp_f32 v148, v148
    v_mul_f32 v101, v101, v147
    v_mfma_f32_16x16x32_bf16 v[208:211], a[0:3], v[44:47], 0
    v_rcp_f32 v149, v149
    v_mul_f32 v104, v104, v148
    v_mfma_f32_16x16x32_bf16 v[212:215], a[4:7], v[44:47], 0
    buffer_load_dwordx4 v[80:83], v25, s[8:11], s37 offen offset:1024 sc1
    v_rcp_f32 v150, v150
    v_mfma_f32_16x16x32_bf16 v[216:219], a[8:11], v[44:47], 0
    v_mul_f32 v105, v105, v149
    v_rcp_f32 v151, v151
    v_mfma_f32_16x16x32_bf16 v[220:223], a[12:15], v[44:47], 0
    s_waitcnt vmcnt(11)
    v_mul_f32 v108, v108, v150
    v_mov_b32 v31, 4
    s_waitcnt vmcnt(6)
    v_mfma_f32_16x16x32_bf16 v[160:163], a[16:19], v[48:51], v[160:163]
    buffer_load_dwordx4 v[84:87], v26, s[8:11], s37 offen offset:1024 sc1
    buffer_store_dword v31, v5, s[8:11], s82 offen
    v_cvt_pk_bf16_f32 v152, v96, v97
    v_mfma_f32_16x16x32_bf16 v[164:167], a[20:23], v[48:51], v[164:167]
    v_cvt_pk_bf16_f32 v154, v104, v105
    v_mul_f32 v109, v109, v151
    v_cvt_pk_bf16_f32 v153, v100, v101
    v_mfma_f32_16x16x32_bf16 v[168:171], a[24:27], v[48:51], v[168:171]
    v_cvt_pk_bf16_f32 v155, v108, v109
    v_permlane32_swap_b32 v152, v154
    v_mfma_f32_16x16x32_bf16 v[172:175], a[28:31], v[48:51], v[172:175]
    buffer_load_dwordx4 v[88:91], v27, s[8:11], s37 offen offset:1024 sc1
    v_permlane32_swap_b32 v153, v155
    v_mfma_f32_16x16x32_bf16 v[176:179], a[16:19], v[52:55], v[176:179]
    s_add_u32 s91, s81, 32768
    v_permlane16_swap_b32 v152, v153
    v_mfma_f32_16x16x32_bf16 v[180:183], a[20:23], v[52:55], v[180:183]
    v_permlane16_swap_b32 v154, v155
    buffer_store_dwordx4 v[152:155], v28, s[8:11], s91 offen sc1
    v_mfma_f32_16x16x32_bf16 v[184:187], a[24:27], v[52:55], v[184:187]
    buffer_load_dwordx4 v[92:95], v244, s[8:11], s37 offen offset:1024 sc1
    v_mul_f32 v144, v112, v16
    v_mul_f32 v145, v113, v16
    v_mfma_f32_16x16x32_bf16 v[188:191], a[28:31], v[52:55], v[188:191]
    v_mul_f32 v146, v116, v18
    v_mul_f32 v147, v117, v18
    v_mul_f32 v148, v120, v20
    v_mfma_f32_16x16x32_bf16 v[192:195], a[16:19], v[56:59], v[192:195]
    v_mul_f32 v149, v121, v20
    v_mul_f32 v150, v124, v22
    v_mul_f32 v151, v125, v22
    v_mfma_f32_16x16x32_bf16 v[196:199], a[20:23], v[56:59], v[196:199]
    v_exp_f32 v144, v144
    v_mul_f32 v112, v112, v114
    v_mfma_f32_16x16x32_bf16 v[200:203], a[24:27], v[56:59], v[200:203]
    v_exp_f32 v145, v145
    v_mul_f32 v113, v113, v115
    v_mfma_f32_16x16x32_bf16 v[204:207], a[28:31], v[56:59], v[204:207]
    v_exp_f32 v146, v146
    v_mul_f32 v116, v116, v118
    v_mfma_f32_16x16x32_bf16 v[208:211], a[16:19], v[60:63], v[208:211]
    v_exp_f32 v147, v147
    v_mul_f32 v117, v117, v119
    v_mfma_f32_16x16x32_bf16 v[212:215], a[20:23], v[60:63], v[212:215]
    v_exp_f32 v148, v148
    v_mul_f32 v120, v120, v122
    v_mfma_f32_16x16x32_bf16 v[216:219], a[24:27], v[60:63], v[216:219]
    v_exp_f32 v149, v149
    v_mul_f32 v121, v121, v123
    v_mfma_f32_16x16x32_bf16 v[220:223], a[28:31], v[60:63], v[220:223]
    s_waitcnt vmcnt(10)
    v_exp_f32 v150, v150
    v_mul_f32 v124, v124, v126
    s_waitcnt vmcnt(8)
    v_cmp_gt_u32 vcc, 3, v30
    s_nop 0
    s_cbranch_vccnz poll5
poll5_ok:
    v_mfma_f32_16x16x32_bf16 v[160:163], a[32:35], v[64:67], v[160:163]
    v_exp_f32 v151, v151
    v_mul_f32 v125, v125, v127
    v_mfma_f32_16x16x32_bf16 v[164:167], a[36:39], v[64:67], v[164:167]
    v_fma_f32 v144, v144, v17, v17
    v_fma_f32 v145, v145, v17, v17
    v_fma_f32 v146, v146, v19, v19
    v_mfma_f32_16x16x32_bf16 v[168:171], a[40:43], v[64:67], v[168:171]
    buffer_load_dwordx4 a[224:227], v25, s[8:11], s38 offen offset:0 sc1
    v_fma_f32 v147, v147, v19, v19
    v_fma_f32 v148, v148, v21, v21
    v_mfma_f32_16x16x32_bf16 v[172:175], a[44:47], v[64:67], v[172:175]
    v_fma_f32 v149, v149, v21, v21
    v_fma_f32 v150, v150, v23, v23
    v_fma_f32 v151, v151, v23, v23
    v_mfma_f32_16x16x32_bf16 v[176:179], a[32:35], v[68:71], v[176:179]
    buffer_load_dword v30, v24, s[8:11], s79 offen sc1
    v_rcp_f32 v144, v144
    v_mfma_f32_16x16x32_bf16 v[180:183], a[36:39], v[68:71], v[180:183]
    buffer_load_dwordx4 a[228:231], v26, s[8:11], s38 offen offset:0 sc1
    v_rcp_f32 v145, v145
    v_mfma_f32_16x16x32_bf16 v[184:187], a[40:43], v[68:71], v[184:187]
    v_mul_f32 v112, v112, v144
    v_rcp_f32 v146, v146
    v_mfma_f32_16x16x32_bf16 v[188:191], a[44:47], v[68:71], v[188:191]
    s_waitcnt vmcnt(10)
    v_mul_f32 v113, v113, v145
    v_rcp_f32 v147, v147
    v_mfma_f32_16x16x32_bf16 v[192:195], a[32:35], v[72:75], v[192:195]
    buffer_load_dwordx4 a[232:235], v27, s[8:11], s38 offen offset:0 sc1
    v_mul_f32 v116, v116, v146
    v_mfma_f32_16x16x32_bf16 v[196:199], a[36:39], v[72:75], v[196:199]
    v_rcp_f32 v148, v148
    v_mul_f32 v117, v117, v147
    v_mfma_f32_16x16x32_bf16 v[200:203], a[40:43], v[72:75], v[200:203]
    v_rcp_f32 v149, v149
    v_mul_f32 v120, v120, v148
    v_mfma_f32_16x16x32_bf16 v[204:207], a[44:47], v[72:75], v[204:207]
    s_waitcnt vmcnt(10)
    buffer_load_dwordx4 a[236:239], v244, s[8:11], s38 offen offset:0 sc1
    v_rcp_f32 v150, v150
    v_mfma_f32_16x16x32_bf16 v[208:211], a[32:35], v[76:79], v[208:211]
    v_mul_f32 v121, v121, v149
    v_rcp_f32 v151, v151
    v_mfma_f32_16x16x32_bf16 v[212:215], a[36:39], v[76:79], v[212:215]
    v_mul_f32 v124, v124, v150
    v_mov_b32 v31, 5
    s_waitcnt vmcnt(6)
    v_mfma_f32_16x16x32_bf16 v[216:219], a[40:43], v[76:79], v[216:219]
    buffer_load_dwordx4 a[240:243], v25, s[8:11], s38 offen offset:1024 sc1
    buffer_store_dword v31, v5, s[8:11], s82 offen
    v_cvt_pk_bf16_f32 v156, v112, v113
    v_mfma_f32_16x16x32_bf16 v[220:223], a[44:47], v[76:79], v[220:223]
    v_cvt_pk_bf16_f32 v158, v120, v121
    v_mul_f32 v125, v125, v151
    v_cvt_pk_bf16_f32 v157, v116, v117
    v_mfma_f32_16x16x32_bf16 v[160:163], a[48:51], v[80:83], v[160:163]
    v_cvt_pk_bf16_f32 v159, v124, v125
    v_permlane32_swap_b32 v156, v158
    v_mfma_f32_16x16x32_bf16 v[164:167], a[52:55], v[80:83], v[164:167]
    buffer_load_dwordx4 a[244:247], v26, s[8:11], s38 offen offset:1024 sc1
    v_permlane32_swap_b32 v157, v159
    v_mfma_f32_16x16x32_bf16 v[168:171], a[56:59], v[80:83], v[168:171]
    s_add_u32 s91, s81, 40960
    v_permlane16_swap_b32 v156, v157
    v_mfma_f32_16x16x32_bf16 v[172:175], a[60:63], v[80:83], v[172:175]
    v_permlane16_swap_b32 v158, v159
    buffer_store_dwordx4 v[156:159], v28, s[8:11], s91 offen sc1
    v_mfma_f32_16x16x32_bf16 v[176:179], a[48:51], v[84:87], v[176:179]
    buffer_load_dwordx4 a[248:251], v27, s[8:11], s38 offen offset:1024 sc1
    v_mul_f32 v144, v128, v16
    v_mul_f32 v145, v129, v16
    v_mfma_f32_16x16x32_bf16 v[180:183], a[52:55], v[84:87], v[180:183]
    v_mul_f32 v146, v132, v18
    v_mul_f32 v147, v133, v18
    v_mul_f32 v148, v136, v20
    v_mfma_f32_16x16x32_bf16 v[184:187], a[56:59], v[84:87], v[184:187]
    v_mul_f32 v149, v137, v20
    v_mul_f32 v150, v140, v22
    v_mul_f32 v151, v141, v22
    v_mfma_f32_16x16x32_bf16 v[188:191], a[60:63], v[84:87], v[188:191]
    buffer_load_dwordx4 a[252:255], v244, s[8:11], s38 offen offset:1024 sc1
    v_exp_f32 v144, v144
    v_mfma_f32_16x16x32_bf16 v[192:195], a[48:51], v[88:91], v[192:195]
    v_mul_f32 v128, v128, v130
    v_exp_f32 v145, v145
    v_mfma_f32_16x16x32_bf16 v[196:199], a[52:55], v[88:91], v[196:199]
    v_mul_f32 v129, v129, v131
    v_exp_f32 v146, v146
    v_mfma_f32_16x16x32_bf16 v[200:203], a[56:59], v[88:91], v[200:203]
    v_mul_f32 v132, v132, v134
    v_exp_f32 v147, v147
    v_mfma_f32_16x16x32_bf16 v[204:207], a[60:63], v[88:91], v[204:207]
    s_waitcnt vmcnt(11)
    v_mul_f32 v133, v133, v135
    v_exp_f32 v148, v148
    v_mfma_f32_16x16x32_bf16 v[208:211], a[48:51], v[92:95], v[208:211]
    v_mul_f32 v136, v136, v138
    v_exp_f32 v149, v149
    v_mfma_f32_16x16x32_bf16 v[212:215], a[52:55], v[92:95], v[212:215]
    v_mul_f32 v137, v137, v139
    v_exp_f32 v150, v150
    v_mfma_f32_16x16x32_bf16 v[216:219], a[56:59], v[92:95], v[216:219]
    v_mul_f32 v140, v140, v142
    v_exp_f32 v151, v151
    v_mfma_f32_16x16x32_bf16 v[220:223], a[60:63], v[92:95], v[220:223]
    s_waitcnt vmcnt(10)
    v_mul_f32 v141, v141, v143
    v_fma_f32 v144, v144, v17, v17
    v_fma_f32 v145, v145, v17, v17
    s_waitcnt vmcnt(9)
    v_cmp_gt_u32 vcc, 4, v30
    s_nop 0
    s_cbranch_vccnz poll6
poll6_ok:
    v_mfma_f32_16x16x32_bf16 v[160:163], a[64:67], a[224:227], v[160:163]
    buffer_load_dwordx4 v[96:99], v25, s[8:11], s39 offen offset:0 sc1
    v_fma_f32 v146, v146, v19, v19
    v_fma_f32 v147, v147, v19, v19
    v_mfma_f32_16x16x32_bf16 v[164:167], a[68:71], a[224:227], v[164:167]
    v_fma_f32 v148, v148, v21, v21
    v_fma_f32 v149, v149, v21, v21
    v_fma_f32 v150, v150, v23, v23
    v_mfma_f32_16x16x32_bf16 v[168:171], a[72:75], a[224:227], v[168:171]
    v_fma_f32 v151, v151, v23, v23
    v_rcp_f32 v144, v144
    v_mfma_f32_16x16x32_bf16 v[172:175], a[76:79], a[224:227], v[172:175]
    s_waitcnt vmcnt(9)
    buffer_load_dwordx4 v[100:103], v26, s[8:11], s39 offen offset:0 sc1
    v_rcp_f32 v145, v145
    v_mfma_f32_16x16x32_bf16 v[176:179], a[64:67], a[228:231], v[176:179]
    buffer_load_dword v30, v24, s[8:11], s79 offen sc1
    v_mul_f32 v128, v128, v144
    v_mfma_f32_16x16x32_bf16 v[180:183], a[68:71], a[228:231], v[180:183]
    v_rcp_f32 v146, v146
    v_mul_f32 v129, v129, v145
    v_mfma_f32_16x16x32_bf16 v[184:187], a[72:75], a[228:231], v[184:187]
    buffer_load_dwordx4 v[104:107], v27, s[8:11], s39 offen offset:0 sc1
    v_rcp_f32 v147, v147
    v_mfma_f32_16x16x32_bf16 v[188:191], a[76:79], a[228:231], v[188:191]
    s_waitcnt vmcnt(11)
    v_mul_f32 v132, v132, v146
    v_rcp_f32 v148, v148
    v_mfma_f32_16x16x32_bf16 v[192:195], a[64:67], a[232:235], v[192:195]
    v_mul_f32 v133, v133, v147
    v_rcp_f32 v149, v149
    v_mfma_f32_16x16x32_bf16 v[196:199], a[68:71], a[232:235], v[196:199]
    buffer_load_dwordx4 v[108:111], v244, s[8:11], s39 offen offset:0 sc1
    v_mul_f32 v136, v136, v148
    v_mfma_f32_16x16x32_bf16 v[200:203], a[72:75], a[232:235], v[200:203]
    v_rcp_f32 v150, v150
    v_mul_f32 v137, v137, v149
    v_mfma_f32_16x16x32_bf16 v[204:207], a[76:79], a[232:235], v[204:207]
    s_waitcnt vmcnt(11)
    v_rcp_f32 v151, v151
    v_mul_f32 v140, v140, v150
    v_mfma_f32_16x16x32_bf16 v[208:211], a[64:67], a[236:239], v[208:211]
    buffer_load_dwordx4 v[112:115], v25, s[8:11], s39 offen offset:1024 sc1
    v_mov_b32 v31, 6
    s_waitcnt vmcnt(8)
    v_mfma_f32_16x16x32_bf16 v[212:215], a[68:71], a[236:239], v[212:215]
    buffer_store_dword v31, v5, s[8:11], s82 offen
    v_cvt_pk_bf16_f32 v152, v128, v129
    v_cvt_pk_bf16_f32 v154, v136, v137
    v_mfma_f32_16x16x32_bf16 v[216:219], a[72:75], a[236:239], v[216:219]
    v_mul_f32 v141, v141, v151
    v_cvt_pk_bf16_f32 v153, v132, v133
    v_cvt_pk_bf16_f32 v155, v140, v141
    v_mfma_f32_16x16x32_bf16 v[220:223], a[76:79], a[236:239], v[220:223]
    buffer_load_dwordx4 v[116:119], v26, s[8:11], s39 offen offset:1024 sc1
    v_permlane32_swap_b32 v152, v154
    v_mfma_f32_16x16x32_bf16 v[160:163], a[80:83], a[240:243], v[160:163]
    v_permlane32_swap_b32 v153, v155
    s_add_u32 s91, s81, 49152
    v_mfma_f32_16x16x32_bf16 v[164:167], a[84:87], a[240:243], v[164:167]
    v_permlane16_swap_b32 v152, v153
    v_mfma_f32_16x16x32_bf16 v[168:171], a[88:91], a[240:243], v[168:171]
    buffer_load_dwordx4 v[120:123], v27, s[8:11], s39 offen offset:1024 sc1
    v_permlane16_swap_b32 v154, v155
    v_mfma_f32_16x16x32_bf16 v[172:175], a[92:95], a[240:243], v[172:175]
    buffer_store_dwordx4 v[152:155], v28, s[8:11], s91 offen sc1
    v_mfma_f32_16x16x32_bf16 v[176:179], a[80:83], a[244:247], v[176:179]
    v_mfma_f32_16x16x32_bf16 v[180:183], a[84:87], a[244:247], v[180:183]
    buffer_load_dwordx4 v[124:127], v244, s[8:11], s39 offen offset:1024 sc1
    v_mfma_f32_16x16x32_bf16 v[184:187], a[88:91], a[244:247], v[184:187]
    v_mfma_f32_16x16x32_bf16 v[188:191], a[92:95], a[244:247], v[188:191]
    s_waitcnt vmcnt(12)
    v_mfma_f32_16x16x32_bf16 v[192:195], a[80:83], a[248:251], v[192:195]
    v_mfma_f32_16x16x32_bf16 v[196:199], a[84:87], a[248:251], v[196:199]
    v_mfma_f32_16x16x32_bf16 v[200:203], a[88:91], a[248:251], v[200:203]
    v_mfma_f32_16x16x32_bf16 v[204:207], a[92:95], a[248:251], v[204:207]
    s_waitcnt vmcnt(11)
    v_mfma_f32_16x16x32_bf16 v[208:211], a[80:83], a[252:255], v[208:211]
    v_mfma_f32_16x16x32_bf16 v[212:215], a[84:87], a[252:255], v[212:215]
    v_mfma_f32_16x16x32_bf16 v[216:219], a[88:91], a[252:255], v[216:219]
    v_mfma_f32_16x16x32_bf16 v[220:223], a[92:95], a[252:255], v[220:223]
    s_waitcnt vmcnt(10)
    s_waitcnt vmcnt(8)
    v_cmp_gt_u32 vcc, 5, v30
    s_nop 0
    s_cbranch_vccnz poll7
poll7_ok:
    v_mfma_f32_16x16x32_bf16 v[160:163], a[96:99], v[96:99], v[160:163]
    v_mfma_f32_16x16x32_bf16 v[164:167], a[100:103], v[96:99], v[164:167]
    buffer_load_dwordx4 v[32:35], v25, s[8:11], s40 offen offset:0 sc1
    v_mfma_f32_16x16x32_bf16 v[168:171], a[104:107], v[96:99], v[168:171]
    v_mfma_f32_16x16x32_bf16 v[172:175], a[108:111], v[96:99], v[172:175]
    v_mfma_f32_16x16x32_bf16 v[176:179], a[96:99], v[100:103], v[176:179]
    buffer_load_dwordx4 v[36:39], v26, s[8:11], s40 offen offset:0 sc1
    v_mfma_f32_16x16x32_bf16 v[180:183], a[100:103], v[100:103], v[180:183]
    buffer_load_dword v30, v24, s[8:11], s79 offen sc1
    v_mfma_f32_16x16x32_bf16 v[184:187], a[104:107], v[100:103], v[184:187]
    v_mfma_f32_16x16x32_bf16 v[188:191], a[108:111], v[100:103], v[188:191]
    s_waitcnt vmcnt(10)
    buffer_load_dwordx4 v[40:43], v27, s[8:11], s40 offen offset:0 sc1
    v_mfma_f32_16x16x32_bf16 v[192:195], a[96:99], v[104:107], v[192:195]
    v_mfma_f32_16x16x32_bf16 v[196:199], a[100:103], v[104:107], v[196:199]
    v_mfma_f32_16x16x32_bf16 v[200:203], a[104:107], v[104:107], v[200:203]
    buffer_load_dwordx4 v[44:47], v244, s[8:11], s40 offen offset:0 sc1
    v_mfma_f32_16x16x32_bf16 v[204:207], a[108:111], v[104:107], v[204:207]
    s_waitcnt vmcnt(11)
    v_mfma_f32_16x16x32_bf16 v[208:211], a[96:99], v[108:111], v[208:211]
    v_mfma_f32_16x16x32_bf16 v[212:215], a[100:103], v[108:111], v[212:215]
    buffer_load_dwordx4 v[48:51], v25, s[8:11], s40 offen offset:1024 sc1
    v_mfma_f32_16x16x32_bf16 v[216:219], a[104:107], v[108:111], v[216:219]
    v_mfma_f32_16x16x32_bf16 v[220:223], a[108:111], v[108:111], v[220:223]
    s_waitcnt vmcnt(11)
    v_mfma_f32_16x16x32_bf16 v[160:163], a[112:115], v[112:115], v[160:163]
    buffer_load_dwordx4 v[52:55], v26, s[8:11], s40 offen offset:1024 sc1
    v_mov_b32 v31, 7
    s_waitcnt vmcnt(8)
    v_mfma_f32_16x16x32_bf16 v[164:167], a[116:119], v[112:115], v[164:167]
    buffer_store_dword v31, v5, s[8:11], s82 offen
    v_mfma_f32_16x16x32_bf16 v[168:171], a[120:123], v[112:115], v[168:171]
    v_mfma_f32_16x16x32_bf16 v[172:175], a[124:127], v[112:115], v[172:175]
    buffer_load_dwordx4 v[56:59], v27, s[8:11], s40 offen offset:1024 sc1
    v_mfma_f32_16x16x32_bf16 v[176:179], a[112:115], v[116:119], v[176:179]
    v_mfma_f32_16x16x32_bf16 v[180:183], a[116:119], v[116:119], v[180:183]
    v_mfma_f32_16x16x32_bf16 v[184:187], a[120:123], v[116:119], v[184:187]
    buffer_load_dwordx4 v[60:63], v244, s[8:11], s40 offen offset:1024 sc1
    v_mfma_f32_16x16x32_bf16 v[188:191], a[124:127], v[116:119], v[188:191]
    v_mfma_f32_16x16x32_bf16 v[192:195], a[112:115], v[120:123], v[192:195]
    v_mfma_f32_16x16x32_bf16 v[196:199], a[116:119], v[120:123], v[196:199]
    v_mfma_f32_16x16x32_bf16 v[200:203], a[120:123], v[120:123], v[200:203]
    v_mfma_f32_16x16x32_bf16 v[204:207], a[124:127], v[120:123], v[204:207]
    s_waitcnt vmcnt(10)
    v_mfma_f32_16x16x32_bf16 v[208:211], a[112:115], v[124:127], v[208:211]
    v_mfma_f32_16x16x32_bf16 v[212:215], a[116:119], v[124:127], v[212:215]
    v_mfma_f32_16x16x32_bf16 v[216:219], a[120:123], v[124:127], v[216:219]
    v_mfma_f32_16x16x32_bf16 v[220:223], a[124:127], v[124:127], v[220:223]
    s_waitcnt vmcnt(9)
    s_waitcnt vmcnt(7)
    v_cmp_gt_u32 vcc, 6, v30
    s_nop 0
    s_cbranch_vccnz poll8
poll8_ok:
    v_mfma_f32_16x16x32_bf16 v[160:163], a[128:131], v[32:35], v[160:163]
    v_mfma_f32_16x16x32_bf16 v[164:167], a[132:135], v[32:35], v[164:167]
    v_mfma_f32_16x16x32_bf16 v[168:171], a[136:139], v[32:35], v[168:171]
    buffer_load_dwordx4 v[64:67], v25, s[8:11], s41 offen offset:0 sc1
    v_mfma_f32_16x16x32_bf16 v[172:175], a[140:143], v[32:35], v[172:175]
    v_mfma_f32_16x16x32_bf16 v[176:179], a[128:131], v[36:39], v[176:179]
    buffer_load_dword v30, v24, s[8:11], s79 offen sc1
    v_mfma_f32_16x16x32_bf16 v[180:183], a[132:135], v[36:39], v[180:183]
    buffer_load_dwordx4 v[68:71], v26, s[8:11], s41 offen offset:0 sc1
    v_mfma_f32_16x16x32_bf16 v[184:187], a[136:139], v[36:39], v[184:187]
    v_mfma_f32_16x16x32_bf16 v[188:191], a[140:143], v[36:39], v[188:191]
    s_waitcnt vmcnt(9)
    v_mfma_f32_16x16x32_bf16 v[192:195], a[128:131], v[40:43], v[192:195]
    buffer_load_dwordx4 v[72:75], v27, s[8:11], s41 offen offset:0 sc1
    v_mfma_f32_16x16x32_bf16 v[196:199], a[132:135], v[40:43], v[196:199]
    v_mfma_f32_16x16x32_bf16 v[200:203], a[136:139], v[40:43], v[200:203]
    v_mfma_f32_16x16x32_bf16 v[204:207], a[140:143], v[40:43], v[204:207]
    s_waitcnt vmcnt(9)
    buffer_load_dwordx4 v[76:79], v244, s[8:11], s41 offen offset:0 sc1
    v_mfma_f32_16x16x32_bf16 v[208:211], a[128:131], v[44:47], v[208:211]
    v_mfma_f32_16x16x32_bf16 v[212:215], a[132:135], v[44:47], v[212:215]
    v_mfma_f32_16x16x32_bf16 v[216:219], a[136:139], v[44:47], v[216:219]
    buffer_load_dwordx4 v[80:83], v25, s[8:11], s41 offen offset:1024 sc1
    v_mfma_f32_16x16x32_bf16 v[220:223], a[140:143], v[44:47], v[220:223]
    s_waitcnt vmcnt(10)
    v_mfma_f32_16x16x32_bf16 v[160:163], a[144:147], v[48:51], v[160:163]
    v_lshlrev_b32 v29, 9, v3
    v_lshl_add_u32 v29, v2, 4, v29
    v_mfma_f32_16x16x32_bf16 v[164:167], a[148:151], v[48:51], v[164:167]
    s_mul_i32 s47, s31, 14336
    buffer_load_dwordx4 v[84:87], v26, s[8:11], s41 offen offset:1024 sc1
    s_lshl_b32 s56, s7, 11
    v_mfma_f32_16x16x32_bf16 v[168:171], a[152:155], v[48:51], v[168:171]
    s_add_u32 s47, s47, s56
    s_add_u32 s47, s47, 10223616
    v_lshrrev_b32 v248, 5, v0
    v_mfma_f32_16x16x32_bf16 v[172:175], a[156:159], v[48:51], v[172:175]
    s_waitcnt vmcnt(10)
    v_lshlrev_b32 v248, 2, v248
    v_lshl_add_u32 v248, v2, 3, v248
    v_mfma_f32_16x16x32_bf16 v[176:179], a[144:147], v[52:55], v[176:179]
    s_lshl_b32 s48, s7, 14
    buffer_load_dwordx4 v[88:91], v27, s[8:11], s41 offen offset:1024 sc1
    s_lshl_b32 s56, s31, 7
    v_mfma_f32_16x16x32_bf16 v[180:183], a[148:151], v[52:55], v[180:183]
    s_add_u32 s48, s48, s56
    s_add_u32 s48, s48, 6029312
    s_bfe_u32 s49, s31, 196609
    v_mfma_f32_16x16x32_bf16 v[184:187], a[152:155], v[52:55], v[184:187]
    s_lshl_b32 s49, s49, 6
    s_lshl_b32 s56, s7, 3
    s_add_u32 s49, s49, s56
    v_mfma_f32_16x16x32_bf16 v[188:191], a[156:159], v[52:55], v[188:191]
    s_waitcnt vmcnt(9)
    buffer_load_dwordx4 v[92:95], v244, s[8:11], s41 offen offset:1024 sc1
    s_and_b32 s56, s3, 1
    v_mfma_f32_16x16x32_bf16 v[192:195], a[144:147], v[56:59], v[192:195]
    s_lshl_b32 s56, s56, 2
    s_add_u32 s49, s49, s56
    s_add_u32 s49, s49, 1536
    v_mfma_f32_16x16x32_bf16 v[196:199], a[148:151], v[56:59], v[196:199]
    s_add_u32 s49, s49, s78
    s_mov_b32 s70, 0x3f803f80
    v_lshlrev_b32 v144, 16, v6
    v_mfma_f32_16x16x32_bf16 v[200:203], a[152:155], v[56:59], v[200:203]
    v_and_b32 v148, 0xffff0000, v6
    v_lshlrev_b32 v152, 16, v7
    v_mfma_f32_16x16x32_bf16 v[204:207], a[156:159], v[56:59], v[204:207]
    s_waitcnt vmcnt(9)
    v_and_b32 v156, 0xffff0000, v7
    v_lshlrev_b32 v145, 16, v8
    v_mfma_f32_16x16x32_bf16 v[208:211], a[144:147], v[60:63], v[208:211]
    v_and_b32 v149, 0xffff0000, v8
    v_lshlrev_b32 v153, 16, v9
    v_mfma_f32_16x16x32_bf16 v[212:215], a[148:151], v[60:63], v[212:215]
    v_and_b32 v157, 0xffff0000, v9
    v_lshlrev_b32 v146, 16, v10
    v_mfma_f32_16x16x32_bf16 v[216:219], a[152:155], v[60:63], v[216:219]
    v_and_b32 v150, 0xffff0000, v10
    v_lshlrev_b32 v154, 16, v11
    v_mfma_f32_16x16x32_bf16 v[220:223], a[156:159], v[60:63], v[220:223]
    s_waitcnt vmcnt(8)
    v_and_b32 v158, 0xffff0000, v11
    v_lshlrev_b32 v147, 16, v12
    s_waitcnt vmcnt(7)
    v_cmp_gt_u32 vcc, 7, v30
    s_nop 0
    s_cbranch_vccnz poll9
poll9_ok:
    v_mfma_f32_16x16x32_bf16 v[160:163], a[160:163], v[64:67], v[160:163]
    buffer_load_dwordx4 a[224:227], v25, s[8:11], s42 offen offset:0 sc1
    v_and_b32 v151, 0xffff0000, v12
    v_mfma_f32_16x16x32_bf16 v[164:167], a[164:167], v[64:67], v[164:167]
    v_lshlrev_b32 v155, 16, v13
    v_and_b32 v159, 0xffff0000, v13
    v_mfma_f32_16x16x32_bf16 v[168:171], a[168:171], v[64:67], v[168:171]
    v_mfma_f32_16x16x32_bf16 v[172:175], a[172:175], v[64:67], v[172:175]
    s_waitcnt vmcnt(7)
    buffer_load_dwordx4 a[228:231], v26, s[8:11], s42 offen offset:0 sc1
    v_mfma_f32_16x16x32_bf16 v[176:179], a[160:163], v[68:71], v[176:179]
    v_mfma_f32_16x16x32_bf16 v[180:183], a[164:167], v[68:71], v[180:183]
    v_mfma_f32_16x16x32_bf16 v[184:187], a[168:171], v[68:71], v[184:187]
    buffer_load_dwordx4 a[232:235], v27, s[8:11], s42 offen offset:0 sc1
    v_mfma_f32_16x16x32_bf16 v[188:191], a[172:175], v[68:71], v[188:191]
    s_waitcnt vmcnt(8)
    v_mfma_f32_16x16x32_bf16 v[192:195], a[160:163], v[72:75], v[192:195]
    v_mfma_f32_16x16x32_bf16 v[196:199], a[164:167], v[72:75], v[196:199]
    buffer_load_dwordx4 a[236:239], v244, s[8:11], s42 offen offset:0 sc1
    v_mfma_f32_16x16x32_bf16 v[200:203], a[168:171], v[72:75], v[200:203]
    v_mfma_f32_16x16x32_bf16 v[204:207], a[172:175], v[72:75], v[204:207]
    s_waitcnt vmcnt(8)
    v_mfma_f32_16x16x32_bf16 v[208:211], a[160:163], v[76:79], v[208:211]
    buffer_load_dwordx4 a[240:243], v25, s[8:11], s42 offen offset:1024 sc1
    v_mfma_f32_16x16x32_bf16 v[212:215], a[164:167], v[76:79], v[212:215]
    v_mfma_f32_16x16x32_bf16 v[216:219], a[168:171], v[76:79], v[216:219]
    v_mfma_f32_16x16x32_bf16 v[220:223], a[172:175], v[76:79], v[220:223]
    s_waitcnt vmcnt(8)
    buffer_load_dwordx4 a[244:247], v26, s[8:11], s42 offen offset:1024 sc1
    v_mfma_f32_16x16x32_bf16 v[160:163], a[176:179], v[80:83], v[160:163]
    v_mfma_f32_16x16x32_bf16 v[164:167], a[180:183], v[80:83], v[164:167]
    v_mfma_f32_16x16x32_bf16 v[168:171], a[184:187], v[80:83], v[168:171]
    buffer_load_dwordx4 a[248:251], v27, s[8:11], s42 offen offset:1024 sc1
    v_mfma_f32_16x16x32_bf16 v[172:175], a[188:191], v[80:83], v[172:175]
    s_waitcnt vmcnt(9)
    v_mfma_f32_16x16x32_bf16 v[176:179], a[176:179], v[84:87], v[176:179]
    v_mfma_f32_16x16x32_bf16 v[180:183], a[180:183], v[84:87], v[180:183]
    buffer_load_dwordx4 a[252:255], v244, s[8:11], s42 offen offset:1024 sc1
    v_mfma_f32_16x16x32_bf16 v[184:187], a[184:187], v[84:87], v[184:187]
    v_mfma_f32_16x16x32_bf16 v[188:191], a[188:191], v[84:87], v[188:191]
    s_waitcnt vmcnt(9)
    v_mfma_f32_16x16x32_bf16 v[192:195], a[176:179], v[88:91], v[192:195]
    v_mfma_f32_16x16x32_bf16 v[196:199], a[180:183], v[88:91], v[196:199]
    v_mfma_f32_16x16x32_bf16 v[200:203], a[184:187], v[88:91], v[200:203]
    v_mfma_f32_16x16x32_bf16 v[204:207], a[188:191], v[88:91], v[204:207]
    s_waitcnt vmcnt(8)
    v_mfma_f32_16x16x32_bf16 v[208:211], a[176:179], v[92:95], v[208:211]
    v_mfma_f32_16x16x32_bf16 v[212:215], a[180:183], v[92:95], v[212:215]
    v_mfma_f32_16x16x32_bf16 v[216:219], a[184:187], v[92:95], v[216:219]
    v_mfma_f32_16x16x32_bf16 v[220:223], a[188:191], v[92:95], v[220:223]
    s_waitcnt vmcnt(7)
    v_mfma_f32_16x16x32_bf16 v[160:163], a[192:195], a[224:227], v[160:163]
    s_add_u32 m0, s53, 100352
    v_add_u32 v245, s44, v1
    v_add_u32 v246, s45, v1
    v_mfma_f32_16x16x32_bf16 v[164:167], a[196:199], a[224:227], v[164:167]
    s_add_u32 s72, s71, 0
    buffer_load_dwordx4 v1, s[8:11], s72 offen sc1 lds
    v_add_u32 v247, s46, v1
    v_mfma_f32_16x16x32_bf16 v[168:171], a[200:203], a[224:227], v[168:171]
    s_add_u32 m0, s53, 104448
    s_mul_i32 s52, s3, 12288
    s_add_u32 s52, s52, 108544
    v_mfma_f32_16x16x32_bf16 v[172:175], a[204:207], a[224:227], v[172:175]
    s_waitcnt vmcnt(4)
    v_add_u32 v28, s52, v1
    v_mfma_f32_16x16x32_bf16 v[160:163], a[208:211], a[240:243], v[160:163]
    s_add_u32 s72, s71, 4096
    buffer_load_dwordx4 v1, s[8:11], s72 offen sc1 lds
    v_mfma_f32_16x16x32_bf16 v[164:167], a[212:215], a[240:243], v[164:167]
    v_mfma_f32_16x16x32_bf16 v[168:171], a[216:219], a[240:243], v[168:171]
    v_mfma_f32_16x16x32_bf16 v[172:175], a[220:223], a[240:243], v[172:175]
    v_mfma_f32_16x16x32_bf16 v[176:179], a[192:195], a[228:231], v[176:179]
    v_mfma_f32_16x16x32_bf16 v[180:183], a[196:199], a[228:231], v[180:183]
    v_mfma_f32_16x16x32_bf16 v[184:187], a[200:203], a[228:231], v[184:187]
    ds_write_b128 v245, v[160:163] offset:0
    v_mfma_f32_16x16x32_bf16 v[188:191], a[204:207], a[228:231], v[188:191]
    s_waitcnt vmcnt(4)
    ds_write_b128 v245, v[164:167] offset:1024
    v_mfma_f32_16x16x32_bf16 v[176:179], a[208:211], a[244:247], v[176:179]
    ds_write_b128 v245, v[168:171] offset:2048
    v_mfma_f32_16x16x32_bf16 v[180:183], a[212:215], a[244:247], v[180:183]
    ds_write_b128 v245, v[172:175] offset:3072
    v_mfma_f32_16x16x32_bf16 v[184:187], a[216:219], a[244:247], v[184:187]
    v_mfma_f32_16x16x32_bf16 v[188:191], a[220:223], a[244:247], v[188:191]
    v_mfma_f32_16x16x32_bf16 v[192:195], a[192:195], a[232:235], v[192:195]
    v_mfma_f32_16x16x32_bf16 v[196:199], a[196:199], a[232:235], v[196:199]
    v_mfma_f32_16x16x32_bf16 v[200:203], a[200:203], a[232:235], v[200:203]
    ds_write_b128 v246, v[176:179] offset:0
    v_mfma_f32_16x16x32_bf16 v[204:207], a[204:207], a[232:235], v[204:207]
    s_waitcnt vmcnt(3)
    ds_write_b128 v246, v[180:183] offset:1024
    v_mfma_f32_16x16x32_bf16 v[192:195], a[208:211], a[248:251], v[192:195]
    ds_write_b128 v246, v[184:187] offset:2048
    v_mfma_f32_16x16x32_bf16 v[196:199], a[212:215], a[248:251], v[196:199]
    ds_write_b128 v246, v[188:191] offset:3072
    v_mfma_f32_16x16x32_bf16 v[200:203], a[216:219], a[248:251], v[200:203]
    v_mfma_f32_16x16x32_bf16 v[204:207], a[220:223], a[248:251], v[204:207]
    v_mfma_f32_16x16x32_bf16 v[208:211], a[192:195], a[236:239], v[208:211]
    v_mfma_f32_16x16x32_bf16 v[212:215], a[196:199], a[236:239], v[212:215]
    v_mfma_f32_16x16x32_bf16 v[216:219], a[200:203], a[236:239], v[216:219]
    ds_write_b128 v247, v[192:195] offset:0
    v_mfma_f32_16x16x32_bf16 v[220:223], a[204:207], a[236:239], v[220:223]
    s_waitcnt vmcnt(2)
    ds_write_b128 v247, v[196:199] offset:1024
    v_mfma_f32_16x16x32_bf16 v[208:211], a[208:211], a[252:255], v[208:211]
    ds_write_b128 v247, v[200:203] offset:2048
    v_mfma_f32_16x16x32_bf16 v[212:215], a[212:215], a[252:255], v[212:215]
    ds_write_b128 v247, v[204:207] offset:3072
    v_mfma_f32_16x16x32_bf16 v[216:219], a[216:219], a[252:255], v[216:219]
    v_mfma_f32_16x16x32_bf16 v[220:223], a[220:223], a[252:255], v[220:223]
    s_nop 2
    v_pk_add_f32 v[208:209], v[208:209], v[144:145]
    v_pk_add_f32 v[210:211], v[210:211], v[146:147]
    v_pk_add_f32 v[212:213], v[212:213], v[148:149]
    v_pk_add_f32 v[214:215], v[214:215], v[150:151]
    v_pk_add_f32 v[216:217], v[216:217], v[152:153]
    v_pk_add_f32 v[218:219], v[218:219], v[154:155]
    v_pk_add_f32 v[220:221], v[220:221], v[156:157]
    v_pk_add_f32 v[222:223], v[222:223], v[158:159]
    s_waitcnt lgkmcnt(0)
    s_barrier
    ds_read_b128 v[48:51], v28 offset:0
    ds_read_b128 v[52:55], v28 offset:1024
    ds_read_b128 v[56:59], v28 offset:2048
    ds_read_b128 v[60:63], v28 offset:3072
    ds_read_b128 v[64:67], v28 offset:4096
    ds_read_b128 v[68:71], v28 offset:5120
    ds_read_b128 v[72:75], v28 offset:6144
    ds_read_b128 v[76:79], v28 offset:7168
    ds_read_b128 v[80:83], v28 offset:8192
    ds_read_b128 v[84:87], v28 offset:9216
    ds_read_b128 v[88:91], v28 offset:10240
    ds_read_b128 v[92:95], v28 offset:11264
    s_waitcnt lgkmcnt(11)
    v_pk_add_f32 v[208:209], v[208:209], v[48:49]
    v_pk_add_f32 v[210:211], v[210:211], v[50:51]
    s_waitcnt lgkmcnt(10)
    v_pk_add_f32 v[212:213], v[212:213], v[52:53]
    v_pk_add_f32 v[214:215], v[214:215], v[54:55]
    s_waitcnt lgkmcnt(9)
    v_pk_add_f32 v[216:217], v[216:217], v[56:57]
    v_pk_add_f32 v[218:219], v[218:219], v[58:59]
    s_waitcnt lgkmcnt(8)
    v_pk_add_f32 v[220:221], v[220:221], v[60:61]
    v_pk_add_f32 v[222:223], v[222:223], v[62:63]
    s_waitcnt lgkmcnt(7)
    v_pk_add_f32 v[208:209], v[208:209], v[64:65]
    v_pk_add_f32 v[210:211], v[210:211], v[66:67]
    s_waitcnt lgkmcnt(6)
    v_pk_add_f32 v[212:213], v[212:213], v[68:69]
    v_pk_add_f32 v[214:215], v[214:215], v[70:71]
    s_waitcnt lgkmcnt(5)
    v_pk_add_f32 v[216:217], v[216:217], v[72:73]
    v_pk_add_f32 v[218:219], v[218:219], v[74:75]
    s_waitcnt lgkmcnt(4)
    v_pk_add_f32 v[220:221], v[220:221], v[76:77]
    v_pk_add_f32 v[222:223], v[222:223], v[78:79]
    s_waitcnt lgkmcnt(3)
    v_pk_add_f32 v[208:209], v[208:209], v[80:81]
    v_pk_add_f32 v[210:211], v[210:211], v[82:83]
    s_waitcnt lgkmcnt(2)
    v_pk_add_f32 v[212:213], v[212:213], v[84:85]
    v_pk_add_f32 v[214:215], v[214:215], v[86:87]
    s_waitcnt lgkmcnt(1)
    v_pk_add_f32 v[216:217], v[216:217], v[88:89]
    v_pk_add_f32 v[218:219], v[218:219], v[90:91]
    s_waitcnt lgkmcnt(0)
    v_pk_add_f32 v[220:221], v[220:221], v[92:93]
    v_pk_add_f32 v[222:223], v[222:223], v[94:95]
    v_cvt_pk_bf16_f32 v6, v208, v212
    v_cvt_pk_bf16_f32 v7, v216, v220
    v_cvt_pk_bf16_f32 v8, v209, v213
    v_cvt_pk_bf16_f32 v9, v217, v221
    buffer_store_dwordx4 v[6:9], v29, s[8:11], s47 offen offset:0
    v_cvt_pk_bf16_f32 v10, v210, v214
    v_cvt_pk_bf16_f32 v11, v218, v222
    v_cvt_pk_bf16_f32 v12, v211, v215
    v_cvt_pk_bf16_f32 v13, v219, v223
    buffer_store_dwordx4 v[10:13], v29, s[8:11], s47 offen offset:256
    v_dot2_f32_bf16 v24, v6, s70, 0
    v_dot2_f32_bf16 v25, v6, v6, 0
    v_dot2_f32_bf16 v26, v10, s70, 0
    v_dot2_f32_bf16 v27, v10, v10, 0
    v_dot2_f32_bf16 v24, v7, s70, v24
    v_dot2_f32_bf16 v25, v7, v7, v25
    v_dot2_f32_bf16 v26, v11, s70, v26
    v_dot2_f32_bf16 v27, v11, v11, v27
    v_dot2_f32_bf16 v24, v8, s70, v24
    v_dot2_f32_bf16 v25, v8, v8, v25
    v_dot2_f32_bf16 v26, v12, s70, v26
    v_dot2_f32_bf16 v27, v12, v12, v27
    v_dot2_f32_bf16 v24, v9, s70, v24
    v_dot2_f32_bf16 v25, v9, v9, v25
    v_dot2_f32_bf16 v26, v13, s70, v26
    v_dot2_f32_bf16 v27, v13, v13, v27
    s_nop 2
    v_pk_add_f32 v[24:25], v[24:25], v[26:27]
    s_nop 1
    v_permlane32_swap_b32 v24, v25
    v_add_f32 v24, v24, v25
    v_mov_b32 v25, v24
    s_nop 1
    v_permlane16_swap_b32 v24, v25
    v_add_f32 v24, v24, v25
    buffer_store_dword v24, v248, s[8:11], s48 offen
    s_waitcnt vmcnt(0)
    buffer_store_dword v4, v5, s[8:11], s49 offen
    s_branch dn_done0
dn_idle0:
    v_exp_f32 v150, v150
    v_mul_f32 v108, v108, v110
    v_exp_f32 v151, v151
    v_mul_f32 v109, v109, v111
    v_fma_f32 v144, v144, v17, v17
    v_fma_f32 v145, v145, v17, v17
    v_fma_f32 v146, v146, v19, v19
    v_fma_f32 v147, v147, v19, v19
    v_fma_f32 v148, v148, v21, v21
    v_fma_f32 v149, v149, v21, v21
    v_fma_f32 v150, v150, v23, v23
    v_fma_f32 v151, v151, v23, v23
    v_rcp_f32 v144, v144
    v_rcp_f32 v145, v145
    v_mul_f32 v96, v96, v144
    v_rcp_f32 v146, v146
    v_mul_f32 v97, v97, v145
    v_rcp_f32 v147, v147
    v_mul_f32 v100, v100, v146
    v_rcp_f32 v148, v148
    v_mul_f32 v101, v101, v147
    v_rcp_f32 v149, v149
    v_mul_f32 v104, v104, v148
    v_rcp_f32 v150, v150
    v_mul_f32 v105, v105, v149
    v_rcp_f32 v151, v151
    v_mul_f32 v108, v108, v150
    v_mov_b32 v31, 4
    s_waitcnt vmcnt(0)
    buffer_store_dword v31, v5, s[8:11], s82 offen
    v_cvt_pk_bf16_f32 v152, v96, v97
    v_cvt_pk_bf16_f32 v154, v104, v105
    v_mul_f32 v109, v109, v151
    v_cvt_pk_bf16_f32 v153, v100, v101
    v_cvt_pk_bf16_f32 v155, v108, v109
    v_permlane32_swap_b32 v152, v154
    s_nop 0
    v_permlane32_swap_b32 v153, v155
    s_add_u32 s91, s81, 32768
    s_nop 0
    v_permlane16_swap_b32 v152, v153
    v_permlane16_swap_b32 v154, v155
    buffer_store_dwordx4 v[152:155], v28, s[8:11], s91 offen sc1
    v_mul_f32 v144, v112, v16
    v_mul_f32 v145, v113, v16
    v_mul_f32 v146, v116, v18
    v_mul_f32 v147, v117, v18
    v_mul_f32 v148, v120, v20
    v_mul_f32 v149, v121, v20
    v_mul_f32 v150, v124, v22
    v_mul_f32 v151, v125, v22
    v_exp_f32 v144, v144
    v_mul_f32 v112, v112, v114
    v_exp_f32 v145, v145
    v_mul_f32 v113, v113, v115
    v_exp_f32 v146, v146
    v_mul_f32 v116, v116, v118
    v_exp_f32 v147, v147
    v_mul_f32 v117, v117, v119
    v_exp_f32 v148, v148
    v_mul_f32 v120, v120, v122
    v_exp_f32 v149, v149
    v_mul_f32 v121, v121, v123
    v_exp_f32 v150, v150
    v_mul_f32 v124, v124, v126
    v_exp_f32 v151, v151
    v_mul_f32 v125, v125, v127
    v_fma_f32 v144, v144, v17, v17
    v_fma_f32 v145, v145, v17, v17
    v_fma_f32 v146, v146, v19, v19
    v_fma_f32 v147, v147, v19, v19
    v_fma_f32 v148, v148, v21, v21
    v_fma_f32 v149, v149, v21, v21
    v_fma_f32 v150, v150, v23, v23
    v_fma_f32 v151, v151, v23, v23
    v_rcp_f32 v144, v144
    v_rcp_f32 v145, v145
    v_mul_f32 v112, v112, v144
    v_rcp_f32 v146, v146
    v_mul_f32 v113, v113, v145
    v_rcp_f32 v147, v147
    v_mul_f32 v116, v116, v146
    v_rcp_f32 v148, v148
    v_mul_f32 v117, v117, v147
    v_rcp_f32 v149, v149
    v_mul_f32 v120, v120, v148
    v_rcp_f32 v150, v150
    v_mul_f32 v121, v121, v149
    v_rcp_f32 v151, v151
    v_mul_f32 v124, v124, v150
    v_mov_b32 v31, 5
    s_waitcnt vmcnt(0)
    buffer_store_dword v31, v5, s[8:11], s82 offen
    v_cvt_pk_bf16_f32 v156, v112, v113
    v_cvt_pk_bf16_f32 v158, v120, v121
    v_mul_f32 v125, v125, v151
    v_cvt_pk_bf16_f32 v157, v116, v117
    v_cvt_pk_bf16_f32 v159, v124, v125
    v_permlane32_swap_b32 v156, v158
    s_nop 0
    v_permlane32_swap_b32 v157, v159
    s_add_u32 s91, s81, 40960
    s_nop 0
    v_permlane16_swap_b32 v156, v157
    v_permlane16_swap_b32 v158, v159
    buffer_store_dwordx4 v[156:159], v28, s[8:11], s91 offen sc1
    v_mul_f32 v144, v128, v16
    v_mul_f32 v145, v129, v16
    v_mul_f32 v146, v132, v18
    v_mul_f32 v147, v133, v18
    v_mul_f32 v148, v136, v20
    v_mul_f32 v149, v137, v20
    v_mul_f32 v150, v140, v22
    v_mul_f32 v151, v141, v22
    v_exp_f32 v144, v144
    v_mul_f32 v128, v128, v130
    v_exp_f32 v145, v145
    v_mul_f32 v129, v129, v131
    v_exp_f32 v146, v146
    v_mul_f32 v132, v132, v134
    v_exp_f32 v147, v147
    v_mul_f32 v133, v133, v135
    v_exp_f32 v148, v148
    v_mul_f32 v136, v136, v138
    v_exp_f32 v149, v149
    v_mul_f32 v137, v137, v139
    v_exp_f32 v150, v150
    v_mul_f32 v140, v140, v142
    v_exp_f32 v151, v151
    v_mul_f32 v141, v141, v143
    v_fma_f32 v144, v144, v17, v17
    v_fma_f32 v145, v145, v17, v17
    v_fma_f32 v146, v146, v19, v19
    v_fma_f32 v147, v147, v19, v19
    v_fma_f32 v148, v148, v21, v21
    v_fma_f32 v149, v149, v21, v21
    v_fma_f32 v150, v150, v23, v23
    v_fma_f32 v151, v151, v23, v23
    v_rcp_f32 v144, v144
    v_rcp_f32 v145, v145
    v_mul_f32 v128, v128, v144
    v_rcp_f32 v146, v146
    v_mul_f32 v129, v129, v145
    v_rcp_f32 v147, v147
    v_mul_f32 v132, v132, v146
    v_rcp_f32 v148, v148
    v_mul_f32 v133, v133, v147
    v_rcp_f32 v149, v149
    v_mul_f32 v136, v136, v148
    v_rcp_f32 v150, v150
    v_mul_f32 v137, v137, v149
    v_rcp_f32 v151, v151
    v_mul_f32 v140, v140, v150
    v_mov_b32 v31, 6
    s_waitcnt vmcnt(0)
    buffer_store_dword v31, v5, s[8:11], s82 offen
    v_cvt_pk_bf16_f32 v152, v128, v129
    v_cvt_pk_bf16_f32 v154, v136, v137
    v_mul_f32 v141, v141, v151
    v_cvt_pk_bf16_f32 v153, v132, v133
    v_cvt_pk_bf16_f32 v155, v140, v141
    v_permlane32_swap_b32 v152, v154
    s_nop 0
    v_permlane32_swap_b32 v153, v155
    s_add_u32 s91, s81, 49152
    s_nop 0
    v_permlane16_swap_b32 v152, v153
    v_permlane16_swap_b32 v154, v155
    buffer_store_dwordx4 v[152:155], v28, s[8:11], s91 offen sc1
    v_mov_b32 v31, 7
    s_waitcnt vmcnt(0)
    buffer_store_dword v31, v5, s[8:11], s82 offen
    s_add_u32 m0, s53, 100352
    s_add_u32 s72, s71, 0
    buffer_load_dwordx4 v1, s[8:11], s72 offen sc1 lds
    s_add_u32 m0, s53, 104448
    s_add_u32 s72, s71, 4096
    buffer_load_dwordx4 v1, s[8:11], s72 offen sc1 lds
    s_waitcnt vmcnt(0)
    s_barrier
dn_done0:
    s_nop 1
    v_min_u32 v24, 13, v0
    v_lshlrev_b32 v24, 2, v24
    s_and_b32 s52, s30, 7
    s_lshl_b32 s52, s52, 6
    s_add_u32 s52, s52, s78
    s_add_u32 s79, s52, 1536
    buffer_load_dword v240, v24, s[8:11], s79 offen sc1
    s_add_u32 s78, s78, 16384
    s_add_u32 s83, s83, 524288
    v_add_u32 v25, 14336, v1
    s_mul_i32 s80, s30, 28672
    s_add_u32 s32, s80, 10223616
    s_add_u32 s33, s32, 4096
    s_add_u32 s34, s32, 8192
    s_add_u32 s35, s32, 12288
    v_lshrrev_b32 v26, 5, v0
    v_lshlrev_b32 v26, 14, v26
    v_and_b32 v27, 31, v0
    v_lshl_add_u32 v26, v27, 3, v26
    s_lshl_b32 s81, s30, 8
    s_add_u32 s36, s81, 6029312
    s_add_u32 s37, s36, 32768
    s_add_u32 s38, s36, 65536
    s_add_u32 s39, s36, 98304
    s_mov_b32 s64, 0x3fb8aa3b
    s_mov_b32 s65, 0x3fb8aa3b
    s_mov_b32 s66, 0x3fb8aa3b
    s_mov_b32 s67, 0x358637bd
    s_lshl_b32 s86, s3, 8
    s_add_u32 s86, s86, 157696
    v_add_u32 v241, 100352, v1
    s_barrier
    ds_read_b128 v[176:179], v241 offset:0
    ds_read_b128 v[180:183], v241 offset:1024
    ds_read_b128 v[184:187], v241 offset:2048
    ds_read_b128 v[188:191], v241 offset:3072
    s_add_u32 m0, s53, 108544
    s_add_u32 s72, s71, 8192
    buffer_load_dwordx4 v1, s[8:11], s72 offen sc1 lds
    s_add_u32 m0, s53, 112640
    s_add_u32 s72, s71, 12288
    buffer_load_dwordx4 v1, s[8:11], s72 offen sc1 lds
    s_add_u32 m0, s53, 116736
    s_add_u32 s72, s71, 16384
    buffer_load_dwordx4 v1, s[8:11], s72 offen sc1 lds
    s_add_u32 m0, s53, 120832
    s_add_u32 s72, s71, 20480
    buffer_load_dwordx4 v1, s[8:11], s72 offen sc1 lds
    s_add_u32 m0, s53, 124928
    s_add_u32 s72, s71, 24576
    buffer_load_dwordx4 v1, s[8:11], s72 offen sc1 lds
    s_add_u32 m0, s53, 129024
    s_add_u32 s72, s71, 28672
    buffer_load_dwordx4 v1, s[8:11], s72 offen sc1 lds
    s_waitcnt vmcnt(6)
    v_cmp_gt_u32 vcc, 1, v240
    s_nop 0
    s_cbranch_vccz spin10_ok
spin10:
    buffer_load_dword v240, v24, s[8:11], s79 offen sc1
    s_waitcnt vmcnt(0)
    v_cmp_gt_u32 vcc, 1, v240
    s_nop 0
    s_cbranch_vccz spin10_ok
    s_cmp_eq_u32 s98, 0
    s_cbranch_scc1 spin10_ok
    s_sub_u32 s98, s98, 1
    s_branch spin10
spin10_ok:
    v_add_u32 v24, 100352, v1
    buffer_load_dwordx4 v[32:35], v1, s[8:11], s32 offen offset:0 sc1
    buffer_load_dwordx4 v[88:91], v25, s[8:11], s32 offen offset:0 sc1
    buffer_load_dwordx4 v[36:39], v1, s[8:11], s32 offen offset:1024 sc1
    buffer_load_dwordx4 v[92:95], v25, s[8:11], s32 offen offset:1024 sc1
    buffer_load_dwordx2 v[208:209], v26, s[8:11], s36 offen sc1
    buffer_load_dwordx2 v[210:211], v26, s[8:11], s37 offen sc1
    buffer_load_dwordx2 v[212:213], v26, s[8:11], s38 offen sc1
    buffer_load_dwordx2 v[214:215], v26, s[8:11], s39 offen sc1
    buffer_load_dwordx4 v[40:43], v1, s[8:11], s32 offen offset:2048 sc1
    buffer_load_dwordx4 v[96:99], v25, s[8:11], s32 offen offset:2048 sc1
    buffer_load_dwordx4 v[44:47], v1, s[8:11], s32 offen offset:3072 sc1
    buffer_load_dwordx4 v[100:103], v25, s[8:11], s32 offen offset:3072 sc1
    s_waitcnt vmcnt(11)
    s_waitcnt lgkmcnt(3)
    v_mfma_f32_16x16x32_bf16 v[144:147], v[32:35], v[176:179], 0
    s_waitcnt vmcnt(10)
    ds_read_b128 v[192:195], v24 offset:4096
    v_mfma_f32_16x16x32_bf16 v[160:163], v[88:91], v[176:179], 0
    s_waitcnt lgkmcnt(3)
    ds_read_b128 v[196:199], v24 offset:5120
    buffer_load_dwordx4 v[48:51], v1, s[8:11], s33 offen offset:0 sc1
    v_mfma_f32_16x16x32_bf16 v[148:151], v[32:35], v[180:183], 0
    ds_read_b128 v[200:203], v24 offset:6144
    v_mfma_f32_16x16x32_bf16 v[164:167], v[88:91], v[180:183], 0
    s_waitcnt lgkmcnt(4)
    ds_read_b128 v[204:207], v24 offset:7168
    buffer_load_dwordx4 v[104:107], v25, s[8:11], s33 offen offset:0 sc1
    v_mfma_f32_16x16x32_bf16 v[152:155], v[32:35], v[184:187], 0
    s_add_u32 m0, s53, 133120
    v_mfma_f32_16x16x32_bf16 v[168:171], v[88:91], v[184:187], 0
    s_waitcnt lgkmcnt(4)
    v_mfma_f32_16x16x32_bf16 v[156:159], v[32:35], v[188:191], 0
    s_add_u32 s72, s71, 32768
    buffer_load_dwordx4 v1, s[8:11], s72 offen sc1 lds
    v_mfma_f32_16x16x32_bf16 v[172:175], v[88:91], v[188:191], 0
    s_waitcnt vmcnt(11) lgkmcnt(0)
    s_barrier
    v_mfma_f32_16x16x32_bf16 v[144:147], v[36:39], v[192:195], v[144:147]
    ds_read_b128 v[176:179], v24 offset:8192
    v_mfma_f32_16x16x32_bf16 v[160:163], v[92:95], v[192:195], v[160:163]
    ds_read_b128 v[180:183], v24 offset:9216
    buffer_load_dwordx4 v[52:55], v1, s[8:11], s33 offen offset:1024 sc1
    v_mfma_f32_16x16x32_bf16 v[148:151], v[36:39], v[196:199], v[148:151]
    ds_read_b128 v[184:187], v24 offset:10240
    v_mfma_f32_16x16x32_bf16 v[164:167], v[92:95], v[196:199], v[164:167]
    ds_read_b128 v[188:191], v24 offset:11264
    buffer_load_dwordx4 v[108:111], v25, s[8:11], s33 offen offset:1024 sc1
    v_mfma_f32_16x16x32_bf16 v[152:155], v[36:39], v[200:203], v[152:155]
    s_add_u32 m0, s53, 137216
    v_mfma_f32_16x16x32_bf16 v[168:171], v[92:95], v[200:203], v[168:171]
    s_add_u32 s72, s71, 36864
    v_mfma_f32_16x16x32_bf16 v[156:159], v[36:39], v[204:207], v[156:159]
    buffer_load_dwordx4 v1, s[8:11], s72 offen sc1 lds
    v_mfma_f32_16x16x32_bf16 v[172:175], v[92:95], v[204:207], v[172:175]
    s_waitcnt vmcnt(8) lgkmcnt(0)
    v_mfma_f32_16x16x32_bf16 v[144:147], v[40:43], v[176:179], v[144:147]
    ds_read_b128 v[192:195], v24 offset:12288
    v_cmp_gt_u32 vcc, 32, v0
    v_mfma_f32_16x16x32_bf16 v[160:163], v[96:99], v[176:179], v[160:163]
    ds_read_b128 v[196:199], v24 offset:13312
    buffer_load_dwordx4 v[56:59], v1, s[8:11], s33 offen offset:2048 sc1
    v_mfma_f32_16x16x32_bf16 v[148:151], v[40:43], v[180:183], v[148:151]
    ds_read_b128 v[200:203], v24 offset:14336
    v_add_f32 v208, v208, v210
    v_mfma_f32_16x16x32_bf16 v[164:167], v[96:99], v[180:183], v[164:167]
    ds_read_b128 v[204:207], v24 offset:15360
    buffer_load_dwordx4 v[112:115], v25, s[8:11], s33 offen offset:2048 sc1
    v_mfma_f32_16x16x32_bf16 v[152:155], v[40:43], v[184:187], v[152:155]
    s_add_u32 m0, s53, 141312
    v_add_f32 v209, v209, v211
    v_cndmask_b32 v214, 0, v214, vcc
    v_mfma_f32_16x16x32_bf16 v[168:171], v[96:99], v[184:187], v[168:171]
    s_add_u32 s72, s71, 40960
    v_cndmask_b32 v215, 0, v215, vcc
    v_add_f32 v212, v212, v214
    v_mfma_f32_16x16x32_bf16 v[156:159], v[40:43], v[188:191], v[156:159]
    buffer_load_dwordx4 v1, s[8:11], s72 offen sc1 lds
    v_add_f32 v213, v213, v215
    v_mfma_f32_16x16x32_bf16 v[172:175], v[96:99], v[188:191], v[172:175]
    s_waitcnt vmcnt(9) lgkmcnt(0)
    v_add_f32 v208, v208, v212
    v_add_f32 v209, v209, v213
    v_mfma_f32_16x16x32_bf16 v[144:147], v[44:47], v[192:195], v[144:147]
    ds_read_b128 v[176:179], v24 offset:16384
    v_mov_b32 v210, v208
    v_mfma_f32_16x16x32_bf16 v[160:163], v[100:103], v[192:195], v[160:163]
    ds_read_b128 v[180:183], v24 offset:17408
    buffer_load_dwordx4 v[60:63], v1, s[8:11], s33 offen offset:3072 sc1
    v_mfma_f32_16x16x32_bf16 v[148:151], v[44:47], v[196:199], v[148:151]
    ds_read_b128 v[184:187], v24 offset:18432
    v_mov_b32 v211, v209
    v_mfma_f32_16x16x32_bf16 v[164:167], v[100:103], v[196:199], v[164:167]
    ds_read_b128 v[188:191], v24 offset:19456
    buffer_load_dwordx4 v[116:119], v25, s[8:11], s33 offen offset:3072 sc1
    v_mfma_f32_16x16x32_bf16 v[152:155], v[44:47], v[200:203], v[152:155]
    s_add_u32 m0, s53, 145408
    v_lshl_add_u32 v27, v0, 2, s86
    v_mfma_f32_16x16x32_bf16 v[168:171], v[100:103], v[200:203], v[168:171]
    s_add_u32 s72, s71, 45056
    v_permlane32_swap_b32 v208, v210
    v_mfma_f32_16x16x32_bf16 v[156:159], v[44:47], v[204:207], v[156:159]
    buffer_load_dwordx4 v1, s[8:11], s72 offen sc1 lds
    v_mfma_f32_16x16x32_bf16 v[172:175], v[100:103], v[204:207], v[172:175]
    s_waitcnt vmcnt(10) lgkmcnt(0)
    v_permlane32_swap_b32 v209, v211
    v_mfma_f32_16x16x32_bf16 v[144:147], v[48:51], v[176:179], v[144:147]
    ds_read_b128 v[192:195], v24 offset:20480
    v_add_f32 v208, v208, v210
    v_mfma_f32_16x16x32_bf16 v[160:163], v[104:107], v[176:179], v[160:163]
    ds_read_b128 v[196:199], v24 offset:21504
    buffer_load_dwordx4 v[64:67], v1, s[8:11], s34 offen offset:0 sc1
    v_mfma_f32_16x16x32_bf16 v[148:151], v[48:51], v[180:183], v[148:151]
    ds_read_b128 v[200:203], v24 offset:22528
    v_add_f32 v209, v209, v211
    v_mfma_f32_16x16x32_bf16 v[164:167], v[104:107], v[180:183], v[164:167]
    ds_read_b128 v[204:207], v24 offset:23552
    buffer_load_dwordx4 v[120:123], v25, s[8:11], s34 offen offset:0 sc1
    v_mfma_f32_16x16x32_bf16 v[152:155], v[48:51], v[184:187], v[152:155]
    s_add_u32 m0, s53, 149504
    v_mul_f32 v208, 0xbb124925, v208
    v_mul_f32 v209, 0x3b124925, v209
    v_mfma_f32_16x16x32_bf16 v[168:171], v[104:107], v[184:187], v[168:171]
    s_add_u32 s72, s71, 49152
    v_fma_f32 v209, -v208, v208, v209
    v_max_f32 v209, 0, v209
    v_mfma_f32_16x16x32_bf16 v[156:159], v[48:51], v[188:191], v[156:159]
    buffer_load_dwordx4 v1, s[8:11], s72 offen sc1 lds
    v_add_f32 v209, 0x3727c5ac, v209
    v_mfma_f32_16x16x32_bf16 v[172:175], v[104:107], v[188:191], v[172:175]
    s_waitcnt vmcnt(10) lgkmcnt(0)
    v_rsq_f32 v209, v209
    v_mfma_f32_16x16x32_bf16 v[144:147], v[52:55], v[192:195], v[144:147]
    ds_read_b128 v[176:179], v24 offset:24576
    v_lshlrev_b32 v210, 2, v2
    v_mfma_f32_16x16x32_bf16 v[160:163], v[108:111], v[192:195], v[160:163]
    ds_read_b128 v[180:183], v24 offset:25600
    buffer_load_dwordx4 v[68:71], v1, s[8:11], s34 offen offset:1024 sc1
    v_mfma_f32_16x16x32_bf16 v[148:151], v[52:55], v[196:199], v[148:151]
    ds_read_b128 v[184:187], v24 offset:26624
    v_cndmask_b32 v208, v209, v208, vcc
    v_mfma_f32_16x16x32_bf16 v[164:167], v[108:111], v[196:199], v[164:167]
    ds_read_b128 v[188:191], v24 offset:27648
    buffer_load_dwordx4 v[124:127], v25, s[8:11], s34 offen offset:1024 sc1
    v_mfma_f32_16x16x32_bf16 v[152:155], v[52:55], v[200:203], v[152:155]
    s_add_u32 m0, s53, 153600
    ds_write_b32 v27, v208
    v_lshl_add_u32 v27, v3, 4, s86
    v_mfma_f32_16x16x32_bf16 v[168:171], v[108:111], v[200:203], v[168:171]
    s_add_u32 s72, s71, 53248
    ds_read_b128 v[252:255], v27
    ds_read_b128 v[28:31], v27 offset:64
    v_mfma_f32_16x16x32_bf16 v[156:159], v[52:55], v[204:207], v[156:159]
    buffer_load_dwordx4 v1, s[8:11], s72 offen sc1 lds
    ds_read_b128 v[240:243], v27 offset:128
    v_mfma_f32_16x16x32_bf16 v[172:175], v[108:111], v[204:207], v[172:175]
    s_waitcnt vmcnt(10) lgkmcnt(4)
    ds_read_b128 v[244:247], v27 offset:192
    v_add_u32 v210, 162816, v210
    v_mfma_f32_16x16x32_bf16 v[144:147], v[56:59], v[176:179], v[144:147]
    ds_read_b128 v[192:195], v24 offset:28672
    v_lshlrev_b32 v211, 4, v3
    v_mfma_f32_16x16x32_bf16 v[160:163], v[112:115], v[176:179], v[160:163]
    ds_read_b128 v[196:199], v24 offset:29696
    buffer_load_dwordx4 v[72:75], v1, s[8:11], s34 offen offset:2048 sc1
    v_mfma_f32_16x16x32_bf16 v[148:151], v[56:59], v[180:183], v[148:151]
    ds_read_b128 v[200:203], v24 offset:30720
    v_add_u32 v211, 162816, v211
    v_mfma_f32_16x16x32_bf16 v[164:167], v[112:115], v[180:183], v[164:167]
    ds_read_b128 v[204:207], v24 offset:31744
    buffer_load_dwordx4 v[128:131], v25, s[8:11], s34 offen offset:2048 sc1
    v_mfma_f32_16x16x32_bf16 v[152:155], v[56:59], v[184:187], v[152:155]
    ds_read_b32 v248, v210 offset:0
    ds_read_b32 v249, v210 offset:64
    v_mfma_f32_16x16x32_bf16 v[168:171], v[112:115], v[184:187], v[168:171]
    ds_read_b32 v250, v210 offset:128
    ds_read_b32 v251, v210 offset:192
    v_mfma_f32_16x16x32_bf16 v[156:159], v[56:59], v[188:191], v[156:159]
    buffer_load_dwordx4 v[76:79], v1, s[8:11], s34 offen offset:3072 sc1
    ds_read_b128 v[16:19], v211 offset:256
    v_mfma_f32_16x16x32_bf16 v[172:175], v[112:115], v[188:191], v[172:175]
    s_waitcnt vmcnt(10) lgkmcnt(5)
    ds_read_b128 v[20:23], v211 offset:320
    s_nop 0
    s_barrier
    v_mfma_f32_16x16x32_bf16 v[144:147], v[60:63], v[192:195], v[144:147]
    s_nop 0
    ds_read_b128 v[176:179], v24 offset:32768
    s_nop 0
    v_mfma_f32_16x16x32_bf16 v[160:163], v[116:119], v[192:195], v[160:163]
    s_nop 0
    ds_read_b128 v[180:183], v24 offset:33792
    buffer_load_dwordx4 v[132:135], v25, s[8:11], s34 offen offset:3072 sc1
    v_mfma_f32_16x16x32_bf16 v[148:151], v[60:63], v[196:199], v[148:151]
    s_nop 0
    ds_read_b128 v[184:187], v24 offset:34816
    s_nop 0
    v_mfma_f32_16x16x32_bf16 v[164:167], v[116:119], v[196:199], v[164:167]
    ds_read_b128 v[188:191], v24 offset:35840
    buffer_load_dwordx4 v[80:83], v1, s[8:11], s35 offen offset:0 sc1
    v_mfma_f32_16x16x32_bf16 v[152:155], v[60:63], v[200:203], v[152:155]
    v_cmp_eq_u32 vcc, 14, v2
    v_mov_b32 v26, 0
    v_mfma_f32_16x16x32_bf16 v[168:171], v[116:119], v[200:203], v[168:171]
    s_nop 0
    v_cndmask_b32 v26, v26, 1.0, vcc
    v_mul_f32 v252, v252, v240
    v_mfma_f32_16x16x32_bf16 v[156:159], v[60:63], v[204:207], v[156:159]
    buffer_load_dwordx4 v[136:139], v25, s[8:11], s35 offen offset:0 sc1
    v_mul_f32 v253, v253, v241
    v_mfma_f32_16x16x32_bf16 v[172:175], v[116:119], v[204:207], v[172:175]
    s_waitcnt vmcnt(10) lgkmcnt(0)
    v_mul_f32 v254, v254, v242
    v_mul_f32 v255, v255, v243
    v_mfma_f32_16x16x32_bf16 v[144:147], v[64:67], v[176:179], v[144:147]
    ds_read_b128 v[192:195], v24 offset:36864
    v_mul_f32 v28, v28, v244
    v_mfma_f32_16x16x32_bf16 v[160:163], v[120:123], v[176:179], v[160:163]
    ds_read_b128 v[196:199], v24 offset:37888
    buffer_load_dwordx4 v[84:87], v1, s[8:11], s35 offen offset:1024 sc1
    v_mfma_f32_16x16x32_bf16 v[148:151], v[64:67], v[180:183], v[148:151]
    ds_read_b128 v[200:203], v24 offset:38912
    v_mul_f32 v29, v29, v245
    v_mfma_f32_16x16x32_bf16 v[164:167], v[120:123], v[180:183], v[164:167]
    ds_read_b128 v[204:207], v24 offset:39936
    buffer_load_dwordx4 v[140:143], v25, s[8:11], s35 offen offset:1024 sc1
    v_mfma_f32_16x16x32_bf16 v[152:155], v[64:67], v[184:187], v[152:155]
    v_mul_f32 v30, v30, v246
    v_mul_f32 v31, v31, v247
    v_mfma_f32_16x16x32_bf16 v[168:171], v[120:123], v[184:187], v[168:171]
    v_fma_f32 v208, v252, v248, s67
    v_fma_f32 v209, v253, v248, s67
    v_mfma_f32_16x16x32_bf16 v[156:159], v[64:67], v[188:191], v[156:159]
    v_fma_f32 v210, v254, v248, s67
    v_fma_f32 v211, v255, v248, s67
    v_mfma_f32_16x16x32_bf16 v[172:175], v[120:123], v[188:191], v[172:175]
    s_waitcnt vmcnt(9) lgkmcnt(0)
    v_fma_f32 v224, v28, v248, s67
    v_fma_f32 v225, v29, v248, s67
    s_waitcnt vmcnt(8)
    s_barrier
    v_mfma_f32_16x16x32_bf16 v[144:147], v[68:71], v[192:195], v[144:147]
    s_add_u32 m0, s53, 100352
    ds_read_b128 v[176:179], v24 offset:40960
    v_fma_f32 v226, v30, v248, s67
    v_mfma_f32_16x16x32_bf16 v[160:163], v[124:127], v[192:195], v[160:163]
    s_add_u32 s72, s74, 0
    ds_read_b128 v[180:183], v24 offset:41984
    buffer_load_dwordx4 v1, s[8:11], s72 offen sc1 lds
    v_mfma_f32_16x16x32_bf16 v[148:151], v[68:71], v[196:199], v[148:151]
    s_add_u32 m0, s53, 104448
    ds_read_b128 v[184:187], v24 offset:43008
    v_fma_f32 v227, v31, v248, s67
    v_mfma_f32_16x16x32_bf16 v[164:167], v[124:127], v[196:199], v[164:167]
    s_add_u32 s72, s74, 4096
    ds_read_b128 v[188:191], v24 offset:44032
    buffer_load_dwordx4 v1, s[8:11], s72 offen sc1 lds
    v_mfma_f32_16x16x32_bf16 v[152:155], v[68:71], v[200:203], v[152:155]
    s_add_u32 m0, s53, 108544
    v_fma_f32 v212, v252, v249, s67
    v_fma_f32 v213, v253, v249, s67
    v_mfma_f32_16x16x32_bf16 v[168:171], v[124:127], v[200:203], v[168:171]
    s_add_u32 s72, s74, 8192
    buffer_load_dwordx4 v1, s[8:11], s72 offen sc1 lds
    v_fma_f32 v214, v254, v249, s67
    v_mfma_f32_16x16x32_bf16 v[156:159], v[68:71], v[204:207], v[156:159]
    s_add_u32 m0, s53, 112640
    s_add_u32 s72, s74, 12288
    buffer_load_dwordx4 v1, s[8:11], s72 offen sc1 lds
    v_mfma_f32_16x16x32_bf16 v[172:175], v[124:127], v[204:207], v[172:175]
    s_waitcnt vmcnt(10) lgkmcnt(0)
    v_fma_f32 v215, v255, v249, s67
    v_fma_f32 v228, v28, v249, s67
    v_mfma_f32_16x16x32_bf16 v[144:147], v[72:75], v[176:179], v[144:147]
    s_add_u32 m0, s53, 116736
    ds_read_b128 v[192:195], v24 offset:45056
    v_fma_f32 v229, v29, v249, s67
    v_mfma_f32_16x16x32_bf16 v[160:163], v[128:131], v[176:179], v[160:163]
    s_add_u32 s72, s74, 16384
    ds_read_b128 v[196:199], v24 offset:46080
    buffer_load_dwordx4 v1, s[8:11], s72 offen sc1 lds
    v_mfma_f32_16x16x32_bf16 v[148:151], v[72:75], v[180:183], v[148:151]
    s_add_u32 m0, s53, 120832
    ds_read_b128 v[200:203], v24 offset:47104
    v_fma_f32 v230, v30, v249, s67
    v_mfma_f32_16x16x32_bf16 v[164:167], v[128:131], v[180:183], v[164:167]
    s_add_u32 s72, s74, 20480
    ds_read_b128 v[204:207], v24 offset:48128
    buffer_load_dwordx4 v1, s[8:11], s72 offen sc1 lds
    v_mfma_f32_16x16x32_bf16 v[152:155], v[72:75], v[184:187], v[152:155]
    s_add_u32 m0, s53, 124928
    v_fma_f32 v231, v31, v249, s67
    v_fma_f32 v216, v252, v250, v26
    v_mfma_f32_16x16x32_bf16 v[168:171], v[128:131], v[184:187], v[168:171]
    s_add_u32 s72, s74, 24576
    buffer_load_dwordx4 v1, s[8:11], s72 offen sc1 lds
    v_fma_f32 v217, v253, v250, v26
    v_mfma_f32_16x16x32_bf16 v[156:159], v[72:75], v[188:191], v[156:159]
    v_fma_f32 v218, v254, v250, v26
    v_fma_f32 v219, v255, v250, v26
    v_mfma_f32_16x16x32_bf16 v[172:175], v[128:131], v[188:191], v[172:175]
    s_waitcnt vmcnt(11) lgkmcnt(0)
    v_fma_f32 v232, v28, v250, v26
    v_fma_f32 v233, v29, v250, v26
    v_mfma_f32_16x16x32_bf16 v[144:147], v[76:79], v[192:195], v[144:147]
    ds_read_b128 v[176:179], v24 offset:49152
    v_fma_f32 v234, v30, v250, v26
    v_mfma_f32_16x16x32_bf16 v[160:163], v[132:135], v[192:195], v[160:163]
    ds_read_b128 v[180:183], v24 offset:50176
    v_fma_f32 v235, v31, v250, v26
    v_mfma_f32_16x16x32_bf16 v[148:151], v[76:79], v[196:199], v[148:151]
    ds_read_b128 v[184:187], v24 offset:51200
    v_mul_f32 v220, v252, v251
    v_mfma_f32_16x16x32_bf16 v[164:167], v[132:135], v[196:199], v[164:167]
    ds_read_b128 v[188:191], v24 offset:52224
    v_mul_f32 v221, v253, v251
    v_mfma_f32_16x16x32_bf16 v[152:155], v[76:79], v[200:203], v[152:155]
    v_mul_f32 v222, v254, v251
    v_mul_f32 v223, v255, v251
    v_mfma_f32_16x16x32_bf16 v[168:171], v[132:135], v[200:203], v[168:171]
    v_mul_f32 v236, v28, v251
    v_mul_f32 v237, v29, v251
    v_mfma_f32_16x16x32_bf16 v[156:159], v[76:79], v[204:207], v[156:159]
    v_mul_f32 v238, v30, v251
    v_mul_f32 v239, v31, v251
    v_mfma_f32_16x16x32_bf16 v[172:175], v[132:135], v[204:207], v[172:175]
    s_waitcnt vmcnt(9) lgkmcnt(0)
    v_mfma_f32_16x16x32_bf16 v[144:147], v[80:83], v[176:179], v[144:147]
    ds_read_b128 v[192:195], v24 offset:53248
    v_mfma_f32_16x16x32_bf16 v[160:163], v[136:139], v[176:179], v[160:163]
    ds_read_b128 v[196:199], v24 offset:54272
    v_mfma_f32_16x16x32_bf16 v[148:151], v[80:83], v[180:183], v[148:151]
    ds_read_b128 v[200:203], v24 offset:55296
    v_mfma_f32_16x16x32_bf16 v[164:167], v[136:139], v[180:183], v[164:167]
    ds_read_b128 v[204:207], v24 offset:56320
    v_mfma_f32_16x16x32_bf16 v[152:155], v[80:83], v[184:187], v[152:155]
    v_mfma_f32_16x16x32_bf16 v[168:171], v[136:139], v[184:187], v[168:171]
    v_mfma_f32_16x16x32_bf16 v[156:159], v[80:83], v[188:191], v[156:159]
    v_mfma_f32_16x16x32_bf16 v[172:175], v[136:139], v[188:191], v[172:175]
    s_waitcnt vmcnt(7) lgkmcnt(0)
    s_barrier
    v_mfma_f32_16x16x32_bf16 v[144:147], v[84:87], v[192:195], v[144:147]
    s_add_u32 m0, s53, 145408
    v_lshl_add_u32 v27, v2, 2, s86
    ds_read_b32 v248, v27 offset:0
    v_mfma_f32_16x16x32_bf16 v[160:163], v[140:143], v[192:195], v[160:163]
    s_add_u32 s72, s75, 45056
    buffer_load_dwordx4 v1, s[8:11], s72 offen sc1 lds
    ds_read_b32 v249, v27 offset:64
    v_mfma_f32_16x16x32_bf16 v[148:151], v[84:87], v[196:199], v[148:151]
    s_add_u32 m0, s53, 149504
    ds_read_b32 v250, v27 offset:128
    ds_read_b32 v251, v27 offset:192
    v_mfma_f32_16x16x32_bf16 v[164:167], v[140:143], v[196:199], v[164:167]
    s_add_u32 s72, s75, 49152
    buffer_load_dwordx4 v1, s[8:11], s72 offen sc1 lds
    s_lshl_b32 s52, s3, 12
    v_mfma_f32_16x16x32_bf16 v[152:155], v[84:87], v[200:203], v[152:155]
    s_add_u32 m0, s53, 153600
    s_add_u32 s52, s52, 129024
    v_add_u32 v26, s52, v1
    v_mfma_f32_16x16x32_bf16 v[168:171], v[140:143], v[200:203], v[168:171]
    s_add_u32 s72, s75, 53248
    buffer_load_dwordx4 v1, s[8:11], s72 offen sc1 lds
    s_add_u32 s52, s53, 129024
    v_mfma_f32_16x16x32_bf16 v[156:159], v[84:87], v[204:207], v[156:159]
    v_add_u32 v27, s52, v1
    s_lshl_b32 s87, s84, 11
    v_mfma_f32_16x16x32_bf16 v[172:175], v[140:143], v[204:207], v[172:175]
    s_add_u32 s87, s87, s83
    v_add_u32 v24, 100352, v1
    s_lshl_b32 s52, s4, 5
    s_add_u32 s52, s52, s5
    s_lshl_b32 s52, s52, 2
    s_add_u32 s52, s52, s3
    s_mul_i32 s52, s52, 1792
    s_add_u32 s52, s52, 8388608
    v_min_u32 v28, 13, v0
    v_lshlrev_b32 v28, 7, v28
    buffer_load_dword a225, v28, s[8:11], s52 offen
    v_pk_fma_f32 v[144:145], v[144:145], v[240:241], v[208:209]
    v_pk_fma_f32 v[146:147], v[146:147], v[242:243], v[210:211]
    v_pk_fma_f32 v[160:161], v[160:161], v[244:245], v[224:225]
    v_pk_fma_f32 v[162:163], v[162:163], v[246:247], v[226:227]
    v_pk_mul_f32 v[192:193], v[144:145], s[64:65]
    v_pk_mul_f32 v[194:195], v[146:147], s[64:65]
    v_pk_mul_f32 v[196:197], v[160:161], s[64:65]
    v_pk_mul_f32 v[198:199], v[162:163], s[64:65]
    v_exp_f32 v192, v192 clamp
    v_max_f32 v144, s67, v144
    v_exp_f32 v193, v193 clamp
    v_max_f32 v145, s67, v145
    v_exp_f32 v194, v194 clamp
    v_max_f32 v146, s67, v146
    v_exp_f32 v195, v195 clamp
    v_max_f32 v147, s67, v147
    v_exp_f32 v196, v196 clamp
    v_max_f32 v160, s67, v160
    v_exp_f32 v197, v197 clamp
    v_max_f32 v161, s67, v161
    v_exp_f32 v198, v198 clamp
    v_max_f32 v162, s67, v162
    v_exp_f32 v199, v199 clamp
    v_max_f32 v163, s67, v163
    v_pk_add_f32 v[144:145], v[144:145], v[192:193]
    v_pk_add_f32 v[146:147], v[146:147], v[194:195]
    v_pk_add_f32 v[160:161], v[160:161], v[196:197]
    v_pk_add_f32 v[162:163], v[162:163], v[198:199]
    v_cvt_pk_bf16_f32 v176, v144, v145
    v_cvt_pk_bf16_f32 v177, v146, v147
    v_cvt_pk_bf16_f32 v178, v160, v161
    v_cvt_pk_bf16_f32 v179, v162, v163
    v_pk_fma_f32 v[152:153], v[152:153], v[240:241], v[216:217]
    v_pk_fma_f32 v[154:155], v[154:155], v[242:243], v[218:219]
    v_pk_fma_f32 v[168:169], v[168:169], v[244:245], v[232:233]
    v_pk_fma_f32 v[170:171], v[170:171], v[246:247], v[234:235]
    v_pk_fma_f32 v[156:157], v[156:157], v[240:241], v[220:221]
    v_pk_fma_f32 v[158:159], v[158:159], v[242:243], v[222:223]
    v_pk_fma_f32 v[172:173], v[172:173], v[244:245], v[236:237]
    v_pk_fma_f32 v[174:175], v[174:175], v[246:247], v[238:239]
    v_cvt_pk_bf16_f32 v184, v152, v153
    v_cvt_pk_bf16_f32 v185, v154, v155
    v_cvt_pk_bf16_f32 v186, v168, v169
    v_cvt_pk_bf16_f32 v187, v170, v171
    v_cvt_pk_bf16_f32 v188, v156, v157
    v_cvt_pk_bf16_f32 v189, v158, v159
    v_cvt_pk_bf16_f32 v190, v172, v173
    v_cvt_pk_bf16_f32 v191, v174, v175
    v_mfma_f32_16x16x32_bf16 v[152:155], v[176:179], v[184:187], 0
    s_nop 0
    v_mfma_f32_16x16x32_bf16 v[156:159], v[176:179], v[188:191], 0
    v_pk_fma_f32 v[148:149], v[148:149], v[240:241], v[212:213]
    v_pk_fma_f32 v[150:151], v[150:151], v[242:243], v[214:215]
    v_pk_fma_f32 v[164:165], v[164:165], v[244:245], v[228:229]
    v_pk_fma_f32 v[166:167], v[166:167], v[246:247], v[230:231]
    v_pk_mul_f32 v[192:193], v[148:149], s[64:65]
    v_pk_mul_f32 v[194:195], v[150:151], s[64:65]
    v_pk_mul_f32 v[196:197], v[164:165], s[64:65]
    v_pk_mul_f32 v[198:199], v[166:167], s[64:65]
    v_exp_f32 v192, v192 clamp
    v_max_f32 v148, s67, v148
    v_exp_f32 v193, v193 clamp
    v_max_f32 v149, s67, v149
    v_exp_f32 v194, v194 clamp
    v_max_f32 v150, s67, v150
    v_exp_f32 v195, v195 clamp
    v_max_f32 v151, s67, v151
    v_exp_f32 v196, v196 clamp
    v_max_f32 v164, s67, v164
    v_exp_f32 v197, v197 clamp
    v_max_f32 v165, s67, v165
    v_exp_f32 v198, v198 clamp
    v_max_f32 v166, s67, v166
    v_exp_f32 v199, v199 clamp
    v_max_f32 v167, s67, v167
    v_pk_add_f32 v[148:149], v[148:149], v[192:193]
    v_pk_add_f32 v[150:151], v[150:151], v[194:195]
    v_pk_add_f32 v[164:165], v[164:165], v[196:197]
    v_pk_add_f32 v[166:167], v[166:167], v[198:199]
    v_cvt_pk_bf16_f32 v180, v148, v149
    v_cvt_pk_bf16_f32 v181, v150, v151
    v_cvt_pk_bf16_f32 v182, v164, v165
    v_cvt_pk_bf16_f32 v183, v166, v167
    s_nop 1
    v_mfma_f32_16x16x32_bf16 v[168:171], v[180:183], v[184:187], 0
    v_mfma_f32_16x16x32_bf16 v[172:175], v[180:183], v[188:191], 0
    ds_write_b128 v26, v[152:155] offset:0
    ds_write_b128 v26, v[156:159] offset:2048
    s_nop 4
    ds_write_b128 v26, v[168:171] offset:1024
    ds_write_b128 v26, v[172:175] offset:3072
    v_cmp_ne_u32 vcc, 3, v3
    v_lshlrev_b32 v25, 3, v0
    s_waitcnt vmcnt(4)
    s_waitcnt lgkmcnt(0)
    s_barrier
    ds_read_b128 v[160:163], v27 offset:0
    ds_read_b128 v[164:167], v27 offset:4096
    ds_read_b128 v[168:171], v27 offset:8192
    ds_read_b128 v[172:175], v27 offset:12288
    ds_read_b128 v[176:179], v24 offset:0
    ds_read_b128 v[180:183], v24 offset:1024
    s_waitcnt lgkmcnt(4)
    v_pk_add_f32 v[160:161], v[160:161], v[164:165]
    v_pk_add_f32 v[162:163], v[162:163], v[166:167]
    s_waitcnt lgkmcnt(2)
    v_pk_add_f32 v[168:169], v[168:169], v[172:173]
    v_pk_add_f32 v[170:171], v[170:171], v[174:175]
    v_pk_add_f32 v[162:163], v[162:163], v[170:171]
    v_pk_add_f32 v[160:161], v[160:161], v[168:169]
    v_cvt_pk_bf16_f32 v162, v162, v163
    v_cvt_pk_bf16_f32 v160, v160, v161
    v_cndmask_b32 v161, 0, v162, vcc
    buffer_store_dwordx2 v[160:161], v25, s[8:11], s87 offen sc1
    ds_read_b128 v[184:187], v24 offset:2048
    ds_read_b128 v[188:191], v24 offset:3072
    ds_read_b128 v[192:195], v24 offset:4096
    ds_read_b128 v[196:199], v24 offset:5120
    s_waitcnt lgkmcnt(5)
    v_mfma_f32_16x16x32_bf16 v[144:147], v[176:179], v[32:35], 0
    ds_read_b128 v[200:203], v24 offset:6144
    v_and_b32 v25, 31, v0
    v_mfma_f32_16x16x32_bf16 v[148:151], v[176:179], v[88:91], 0
    s_waitcnt lgkmcnt(5)
    ds_read_b128 v[204:207], v24 offset:7168
    v_lshlrev_b32 v25, 4, v25
    v_mfma_f32_16x16x32_bf16 v[152:155], v[180:183], v[32:35], 0
    v_lshrrev_b32 v26, 5, v0
    v_lshl_add_u32 v25, v26, 11, v25
    v_mfma_f32_16x16x32_bf16 v[156:159], v[180:183], v[88:91], 0
    s_waitcnt lgkmcnt(5)
    v_mul_f32 v248, v248, v250
    v_mul_f32 v249, v249, v251
    v_mfma_f32_16x16x32_bf16 v[144:147], v[184:187], v[36:39], v[144:147]
    ds_read_b128 v[176:179], v24 offset:8192
    v_fma_f32 v208, v248, v16, s67
    v_mfma_f32_16x16x32_bf16 v[148:151], v[184:187], v[92:95], v[148:151]
    s_waitcnt lgkmcnt(5)
    ds_read_b128 v[180:183], v24 offset:9216
    v_fma_f32 v209, v248, v17, s67
    v_mfma_f32_16x16x32_bf16 v[152:155], v[188:191], v[36:39], v[152:155]
    v_fma_f32 v210, v248, v18, s67
    v_fma_f32 v211, v248, v19, s67
    v_mfma_f32_16x16x32_bf16 v[156:159], v[188:191], v[92:95], v[156:159]
    s_waitcnt lgkmcnt(5)
    v_fma_f32 v212, v249, v16, s67
    v_fma_f32 v213, v249, v17, s67
    v_mfma_f32_16x16x32_bf16 v[144:147], v[192:195], v[40:43], v[144:147]
    ds_read_b128 v[184:187], v24 offset:10240
    v_fma_f32 v214, v249, v18, s67
    v_mfma_f32_16x16x32_bf16 v[148:151], v[192:195], v[96:99], v[148:151]
    s_waitcnt lgkmcnt(5)
    ds_read_b128 v[188:191], v24 offset:11264
    v_fma_f32 v215, v249, v19, s67
    v_mfma_f32_16x16x32_bf16 v[152:155], v[196:199], v[40:43], v[152:155]
    v_fma_f32 v216, v248, v20, s67
    v_fma_f32 v217, v248, v21, s67
    v_mfma_f32_16x16x32_bf16 v[156:159], v[196:199], v[96:99], v[156:159]
    s_waitcnt lgkmcnt(5)
    v_fma_f32 v218, v248, v22, s67
    v_fma_f32 v219, v248, v23, s67
    v_mfma_f32_16x16x32_bf16 v[144:147], v[200:203], v[44:47], v[144:147]
    ds_read_b128 v[192:195], v24 offset:12288
    v_fma_f32 v220, v249, v20, s67
    v_mfma_f32_16x16x32_bf16 v[148:151], v[200:203], v[100:103], v[148:151]
    s_waitcnt lgkmcnt(5)
    ds_read_b128 v[196:199], v24 offset:13312
    v_fma_f32 v221, v249, v21, s67
    v_mfma_f32_16x16x32_bf16 v[152:155], v[204:207], v[44:47], v[152:155]
    v_fma_f32 v222, v249, v22, s67
    v_fma_f32 v223, v249, v23, s67
    v_mfma_f32_16x16x32_bf16 v[156:159], v[204:207], v[100:103], v[156:159]
    s_waitcnt lgkmcnt(5)
    v_and_b32 v28, 1, v3
    v_lshlrev_b32 v28, 2, v28
    v_mfma_f32_16x16x32_bf16 v[144:147], v[176:179], v[48:51], v[144:147]
    ds_read_b128 v[200:203], v24 offset:14336
    v_lshrrev_b32 v29, 1, v2
    v_mfma_f32_16x16x32_bf16 v[148:151], v[176:179], v[104:107], v[148:151]
    s_waitcnt lgkmcnt(5)
    ds_read_b128 v[204:207], v24 offset:15360
    v_xor_b32 v28, v28, v29
    v_mfma_f32_16x16x32_bf16 v[152:155], v[180:183], v[48:51], v[152:155]
    v_and_b32 v29, 1, v2
    v_lshlrev_b32 v29, 4, v29
    v_mfma_f32_16x16x32_bf16 v[156:159], v[180:183], v[104:107], v[156:159]
    s_waitcnt lgkmcnt(5)
    v_mov_b32 v30, 0x3f80
    v_lshlrev_b32 v29, v29, v30
    v_mfma_f32_16x16x32_bf16 v[144:147], v[184:187], v[52:55], v[144:147]
    ds_read_b128 v[176:179], v24 offset:16384
    v_cmp_eq_u32 s[56:57], 0, v28
    v_mfma_f32_16x16x32_bf16 v[148:151], v[184:187], v[108:111], v[148:151]
    s_waitcnt lgkmcnt(5)
    ds_read_b128 v[180:183], v24 offset:17408
    s_nop 0
    v_mfma_f32_16x16x32_bf16 v[152:155], v[188:191], v[52:55], v[152:155]
    s_nop 0
    v_cndmask_b32 v252, 0, v29, s[56:57]
    v_cmp_eq_u32 s[58:59], 1, v28
    v_mfma_f32_16x16x32_bf16 v[156:159], v[188:191], v[108:111], v[156:159]
    s_waitcnt lgkmcnt(5)
    s_nop 0
    s_nop 0
    s_barrier
    v_mfma_f32_16x16x32_bf16 v[144:147], v[192:195], v[56:59], v[144:147]
    s_add_u32 m0, s53, 129024
    ds_read_b128 v[184:187], v24 offset:18432
    s_add_u32 s72, s75, 28672
    v_mfma_f32_16x16x32_bf16 v[148:151], v[192:195], v[112:115], v[148:151]
    s_waitcnt lgkmcnt(5)
    ds_read_b128 v[188:191], v24 offset:19456
    v_cndmask_b32 v253, 0, v29, s[58:59]
    v_mfma_f32_16x16x32_bf16 v[152:155], v[196:199], v[56:59], v[152:155]
    v_cmp_eq_u32 s[56:57], 2, v28
    s_nop 0
    v_mfma_f32_16x16x32_bf16 v[156:159], v[196:199], v[112:115], v[156:159]
    s_waitcnt lgkmcnt(5)
    buffer_load_dwordx4 v1, s[8:11], s72 offen sc1 lds
    s_nop 0
    v_mfma_f32_16x16x32_bf16 v[144:147], v[200:203], v[60:63], v[144:147]
    s_add_u32 m0, s53, 133120
    ds_read_b128 v[192:195], v24 offset:20480
    v_cndmask_b32 v254, 0, v29, s[56:57]
    v_mfma_f32_16x16x32_bf16 v[148:151], v[200:203], v[116:119], v[148:151]
    s_waitcnt lgkmcnt(5)
    ds_read_b128 v[196:199], v24 offset:21504
    v_cmp_eq_u32 s[58:59], 3, v28
    v_mfma_f32_16x16x32_bf16 v[152:155], v[204:207], v[60:63], v[152:155]
    s_add_u32 s72, s75, 32768
    buffer_load_dwordx4 v1, s[8:11], s72 offen sc1 lds
    s_nop 0
    v_mfma_f32_16x16x32_bf16 v[156:159], v[204:207], v[116:119], v[156:159]
    s_waitcnt lgkmcnt(5)
    s_nop 0
    v_cndmask_b32 v255, 0, v29, s[58:59]
    v_mfma_f32_16x16x32_bf16 v[144:147], v[176:179], v[64:67], v[144:147]
    s_add_u32 m0, s53, 137216
    ds_read_b128 v[200:203], v24 offset:22528
    v_mfma_f32_16x16x32_bf16 v[148:151], v[176:179], v[120:123], v[148:151]
    s_waitcnt lgkmcnt(5)
    ds_read_b128 v[204:207], v24 offset:23552
    s_add_u32 s72, s75, 36864
    v_mfma_f32_16x16x32_bf16 v[152:155], v[180:183], v[64:67], v[152:155]
    v_mfma_f32_16x16x32_bf16 v[156:159], v[180:183], v[120:123], v[156:159]
    s_waitcnt lgkmcnt(5)
    v_mfma_f32_16x16x32_bf16 v[144:147], v[184:187], v[68:71], v[144:147]
    ds_read_b128 v[176:179], v24 offset:24576
    buffer_load_dwordx4 v1, s[8:11], s72 offen sc1 lds
    v_mfma_f32_16x16x32_bf16 v[148:151], v[184:187], v[124:127], v[148:151]
    s_waitcnt lgkmcnt(5)
    ds_read_b128 v[180:183], v24 offset:25600
    v_mfma_f32_16x16x32_bf16 v[152:155], v[188:191], v[68:71], v[152:155]
    s_add_u32 m0, s53, 141312
    v_mfma_f32_16x16x32_bf16 v[156:159], v[188:191], v[124:127], v[156:159]
    s_waitcnt lgkmcnt(5)
    s_add_u32 s72, s75, 40960
    buffer_load_dwordx4 v1, s[8:11], s72 offen sc1 lds
    v_mfma_f32_16x16x32_bf16 v[144:147], v[192:195], v[72:75], v[144:147]
    s_add_u32 m0, s53, 100352
    ds_read_b128 v[184:187], v24 offset:26624
    v_mfma_f32_16x16x32_bf16 v[148:151], v[192:195], v[128:131], v[148:151]
    s_waitcnt lgkmcnt(5)
    ds_read_b128 v[188:191], v24 offset:27648
    v_mfma_f32_16x16x32_bf16 v[152:155], v[196:199], v[72:75], v[152:155]
    s_add_u32 s72, s75, 0
    buffer_load_dwordx4 v1, s[8:11], s72 offen sc1 lds
    v_mfma_f32_16x16x32_bf16 v[156:159], v[196:199], v[128:131], v[156:159]
    s_waitcnt lgkmcnt(5)
    v_mfma_f32_16x16x32_bf16 v[144:147], v[200:203], v[76:79], v[144:147]
    s_add_u32 m0, s53, 104448
    v_mfma_f32_16x16x32_bf16 v[148:151], v[200:203], v[132:135], v[148:151]
    s_waitcnt lgkmcnt(4)
    s_add_u32 s72, s75, 4096
    buffer_load_dwordx4 v1, s[8:11], s72 offen sc1 lds
    v_mfma_f32_16x16x32_bf16 v[152:155], v[204:207], v[76:79], v[152:155]
    s_add_u32 m0, s53, 108544
    v_mfma_f32_16x16x32_bf16 v[156:159], v[204:207], v[132:135], v[156:159]
    s_waitcnt lgkmcnt(3)
    v_mfma_f32_16x16x32_bf16 v[144:147], v[176:179], v[80:83], v[144:147]
    s_add_u32 s72, s75, 8192
    buffer_load_dwordx4 v1, s[8:11], s72 offen sc1 lds
    v_mfma_f32_16x16x32_bf16 v[148:151], v[176:179], v[136:139], v[148:151]
    s_waitcnt lgkmcnt(2)
    v_mfma_f32_16x16x32_bf16 v[152:155], v[180:183], v[80:83], v[152:155]
    v_mfma_f32_16x16x32_bf16 v[156:159], v[180:183], v[136:139], v[156:159]
    s_waitcnt lgkmcnt(1)
    v_mfma_f32_16x16x32_bf16 v[144:147], v[184:187], v[84:87], v[144:147]
    v_mfma_f32_16x16x32_bf16 v[148:151], v[184:187], v[140:143], v[148:151]
    s_waitcnt lgkmcnt(0)
    v_mfma_f32_16x16x32_bf16 v[152:155], v[188:191], v[84:87], v[152:155]
    v_mfma_f32_16x16x32_bf16 v[156:159], v[188:191], v[140:143], v[156:159]
    s_add_u32 s85, s83, 0
    buffer_load_dwordx4 v[224:227], v25, s[8:11], s85 offen sc1
    s_add_u32 s85, s83, 4096
    buffer_load_dwordx4 v[228:231], v25, s[8:11], s85 offen sc1
    s_add_u32 s85, s83, 8192
    buffer_load_dwordx4 v[232:235], v25, s[8:11], s85 offen sc1
    s_add_u32 s85, s83, 12288
    buffer_load_dwordx4 v[236:239], v25, s[8:11], s85 offen sc1
    s_add_u32 s85, s83, 16384
    buffer_load_dwordx4 v[240:243], v25, s[8:11], s85 offen sc1
    s_add_u32 s85, s83, 20480
    buffer_load_dwordx4 v[244:247], v25, s[8:11], s85 offen sc1
    s_add_u32 s85, s83, 24576
    buffer_load_dwordx4 v[168:171], v25, s[8:11], s85 offen sc1
    s_add_u32 s85, s83, 28672
    buffer_load_dwordx4 v[172:175], v25, s[8:11], s85 offen sc1
    v_fma_f32 v144, v144, v250, v208
    v_fma_f32 v145, v145, v250, v209
    v_fma_f32 v146, v146, v250, v210
    v_fma_f32 v147, v147, v250, v211
    v_fma_f32 v148, v148, v251, v212
    v_fma_f32 v149, v149, v251, v213
    v_fma_f32 v150, v150, v251, v214
    v_fma_f32 v151, v151, v251, v215
    v_fma_f32 v152, v152, v250, v216
    v_fma_f32 v153, v153, v250, v217
    v_fma_f32 v154, v154, v250, v218
    v_fma_f32 v155, v155, v250, v219
    v_fma_f32 v156, v156, v251, v220
    v_fma_f32 v157, v157, v251, v221
    v_fma_f32 v158, v158, v251, v222
    v_fma_f32 v159, v159, v251, v223
    v_pk_mul_f32 v[192:193], v[144:145], s[64:65]
    v_pk_mul_f32 v[194:195], v[146:147], s[64:65]
    v_pk_mul_f32 v[196:197], v[148:149], s[64:65]
    v_pk_mul_f32 v[198:199], v[150:151], s[64:65]
    v_pk_mul_f32 v[200:201], v[152:153], s[64:65]
    v_pk_mul_f32 v[202:203], v[154:155], s[64:65]
    v_pk_mul_f32 v[204:205], v[156:157], s[64:65]
    v_pk_mul_f32 v[206:207], v[158:159], s[64:65]
    v_exp_f32 v192, v192 clamp
    v_max_f32 v144, s67, v144
    v_exp_f32 v193, v193 clamp
    v_max_f32 v145, s67, v145
    v_exp_f32 v194, v194 clamp
    v_max_f32 v146, s67, v146
    v_exp_f32 v195, v195 clamp
    v_max_f32 v147, s67, v147
    v_exp_f32 v196, v196 clamp
    v_max_f32 v148, s67, v148
    v_exp_f32 v197, v197 clamp
    v_max_f32 v149, s67, v149
    v_exp_f32 v198, v198 clamp
    v_max_f32 v150, s67, v150
    v_exp_f32 v199, v199 clamp
    v_max_f32 v151, s67, v151
    v_exp_f32 v200, v200 clamp
    v_max_f32 v152, s67, v152
    v_exp_f32 v201, v201 clamp
    v_max_f32 v153, s67, v153
    v_exp_f32 v202, v202 clamp
    v_max_f32 v154, s67, v154
    v_exp_f32 v203, v203 clamp
    v_max_f32 v155, s67, v155
    v_exp_f32 v204, v204 clamp
    v_max_f32 v156, s67, v156
    v_exp_f32 v205, v205 clamp
    v_max_f32 v157, s67, v157
    v_exp_f32 v206, v206 clamp
    v_max_f32 v158, s67, v158
    v_exp_f32 v207, v207 clamp
    v_max_f32 v159, s67, v159
    v_pk_add_f32 v[144:145], v[144:145], v[192:193]
    v_pk_add_f32 v[146:147], v[146:147], v[194:195]
    v_pk_add_f32 v[148:149], v[148:149], v[196:197]
    v_pk_add_f32 v[150:151], v[150:151], v[198:199]
    v_pk_add_f32 v[152:153], v[152:153], v[200:201]
    v_pk_add_f32 v[154:155], v[154:155], v[202:203]
    v_pk_add_f32 v[156:157], v[156:157], v[204:205]
    v_pk_add_f32 v[158:159], v[158:159], v[206:207]
    v_cvt_pk_bf16_f32 v160, v144, v145
    v_cvt_pk_bf16_f32 v161, v146, v147
    v_cvt_pk_bf16_f32 v164, v148, v149
    v_cvt_pk_bf16_f32 v165, v150, v151
    v_cvt_pk_bf16_f32 v162, v152, v153
    v_cvt_pk_bf16_f32 v163, v154, v155
    v_cvt_pk_bf16_f32 v166, v156, v157
    v_cvt_pk_bf16_f32 v167, v158, v159
    s_lshr_b32 s52, s3, 1
    s_lshl_b32 s52, s52, 10
    s_and_b32 s55, s3, 1
    s_lshl_b32 s55, s55, 3
    s_add_u32 s52, s52, s55
    s_add_u32 s52, s52, 158720
    v_lshlrev_b32 v31, 5, v2
    v_lshrrev_b32 v30, 5, v0
    v_lshl_add_u32 v31, v30, 9, v31
    v_and_b32 v30, 1, v3
    v_lshl_add_u32 v31, v30, 4, v31
    v_add_u32 v31, s52, v31
    v_add_u32 v28, 158720, v1
    s_mul_i32 s52, s28, 7
    v_lshl_add_u32 v29, v3, 1, s52
    v_lshrrev_b32 v26, 1, v29
    v_lshlrev_b32 v26, 8, v26
    v_and_b32 v30, 1, v29
    v_lshl_add_u32 v26, v30, 3, v26
    v_lshl_add_u32 v26, v2, 4, v26
    v_add_u32 v29, 1, v29
    v_lshrrev_b32 v27, 1, v29
    v_lshlrev_b32 v27, 8, v27
    v_and_b32 v30, 1, v29
    v_lshl_add_u32 v27, v30, 3, v27
    v_lshl_add_u32 v27, v2, 4, v27
    v_mov_b32 v29, 0x7ffffff0
    v_cmp_ne_u32 vcc, 3, v3
    s_nop 1
    v_cndmask_b32 v27, v29, v27, vcc
    s_mul_i32 s86, s30, 28672
    s_add_u32 s86, s86, 8388608
    s_add_u32 s87, s86, 14336
    s_and_b32 s52, s30, 7
    s_lshl_b32 s52, s52, 6
    s_lshl_b32 s55, s28, 2
    s_add_u32 s52, s52, s55
    s_add_u32 s92, s52, s78
    s_barrier
    s_add_u32 m0, s53, 112640
    s_add_u32 s72, s75, 12288
    buffer_load_dwordx4 v1, s[8:11], s72 offen sc1 lds
    s_add_u32 m0, s53, 116736
    s_add_u32 s72, s75, 16384
    buffer_load_dwordx4 v1, s[8:11], s72 offen sc1 lds
    s_add_u32 m0, s53, 120832
    s_add_u32 s72, s75, 20480
    buffer_load_dwordx4 v1, s[8:11], s72 offen sc1 lds
    s_add_u32 m0, s53, 124928
    s_add_u32 s72, s75, 24576
    buffer_load_dwordx4 v1, s[8:11], s72 offen sc1 lds
g_retry1:
    s_waitcnt vmcnt(11)
    v_mfma_f32_16x16x32_bf16 v[64:67], v[252:255], v[224:227], 0
    s_waitcnt vmcnt(10)
    v_mfma_f32_16x16x32_bf16 v[64:67], v[252:255], v[228:231], v[64:67]
    s_waitcnt vmcnt(9)
    v_mfma_f32_16x16x32_bf16 v[64:67], v[252:255], v[232:235], v[64:67]
    s_waitcnt vmcnt(8)
    v_mfma_f32_16x16x32_bf16 v[64:67], v[252:255], v[236:239], v[64:67]
    s_waitcnt vmcnt(7)
    v_mfma_f32_16x16x32_bf16 v[64:67], v[252:255], v[240:243], v[64:67]
    s_waitcnt vmcnt(6)
    v_mfma_f32_16x16x32_bf16 v[64:67], v[252:255], v[244:247], v[64:67]
    s_waitcnt vmcnt(5)
    v_mfma_f32_16x16x32_bf16 v[64:67], v[252:255], v[168:171], v[64:67]
    s_waitcnt vmcnt(4)
    v_mfma_f32_16x16x32_bf16 v[64:67], v[252:255], v[172:175], v[64:67]
    s_nop 7
    v_cmp_u_f32 vcc, v64, v65
    v_cmp_u_f32 s[56:57], v66, v67
    s_nop 0
    s_or_b64 vcc, vcc, s[56:57]
    s_cbranch_vccnz g_again1
g_ok1:
    v_cvt_pk_bf16_f32 v32, v64, v65
    v_cvt_pk_bf16_f32 v33, v66, v67
    ds_write_b64 v31, v[32:33]
    s_waitcnt lgkmcnt(0)
    s_barrier
    ds_read_b128 v[96:99], v28 offset:0
    ds_read_b128 v[100:103], v28 offset:1024
    s_waitcnt lgkmcnt(1)
    v_mfma_f32_16x16x32_bf16 v[104:107], v[96:99], v[160:163], 0
    v_mfma_f32_16x16x32_bf16 v[112:115], v[96:99], v[164:167], 0
    s_waitcnt lgkmcnt(0)
    v_mfma_f32_16x16x32_bf16 v[108:111], v[100:103], v[160:163], 0
    v_mfma_f32_16x16x32_bf16 v[116:119], v[100:103], v[164:167], 0
    s_nop 3
    v_mov_b32 v120, v106
    v_mov_b32 v121, v106
    v_mov_b32 v124, v114
    v_mov_b32 v125, v114
    v_permlane32_swap_b32 v120, v121
    s_nop 0
    v_permlane32_swap_b32 v124, v125
    v_mov_b32 v120, v121
    v_mov_b32 v124, v125
    s_nop 0
    v_permlane16_swap_b32 v121, v120
    v_permlane16_swap_b32 v125, v124
    v_add_f32 v120, s67, v120
    v_add_f32 v124, s67, v124
    v_rcp_f32 v120, v120
    v_rcp_f32 v124, v124
    v_pk_mul_f32 v[104:105], v[104:105], v[120:121] op_sel_hi:[1,0]
    v_pk_mul_f32 v[106:107], v[106:107], v[120:121] op_sel_hi:[1,0]
    v_pk_mul_f32 v[108:109], v[108:109], v[120:121] op_sel_hi:[1,0]
    v_pk_mul_f32 v[110:111], v[110:111], v[120:121] op_sel_hi:[1,0]
    v_cvt_pk_bf16_f32 v104, v104, v108
    v_cvt_pk_bf16_f32 v105, v105, v109
    v_cvt_pk_bf16_f32 v106, v106, v110
    v_cvt_pk_bf16_f32 v107, v107, v111
    buffer_store_dwordx2 v[104:105], v26, s[8:11], s86 offen
    buffer_store_dwordx2 v[106:107], v27, s[8:11], s86 offen
    v_pk_mul_f32 v[112:113], v[112:113], v[124:125] op_sel_hi:[1,0]
    v_pk_mul_f32 v[114:115], v[114:115], v[124:125] op_sel_hi:[1,0]
    v_pk_mul_f32 v[116:117], v[116:117], v[124:125] op_sel_hi:[1,0]
    v_pk_mul_f32 v[118:119], v[118:119], v[124:125] op_sel_hi:[1,0]
    v_cvt_pk_bf16_f32 v112, v112, v116
    v_cvt_pk_bf16_f32 v113, v113, v117
    v_cvt_pk_bf16_f32 v114, v114, v118
    v_cvt_pk_bf16_f32 v115, v115, v119
    buffer_store_dwordx2 v[112:113], v26, s[8:11], s87 offen
    buffer_store_dwordx2 v[114:115], v27, s[8:11], s87 offen
    v_add_u32 v29, 100352, v1
    ds_read_b128 v[32:35], v29 offset:28672
    ds_read_b128 v[36:39], v29 offset:29696
    ds_read_b128 v[40:43], v29 offset:30720
    ds_read_b128 v[44:47], v29 offset:31744
    ds_read_b128 v[48:51], v29 offset:32768
    ds_read_b128 v[52:55], v29 offset:33792
    ds_read_b128 v[56:59], v29 offset:34816
    ds_read_b128 v[60:63], v29 offset:35840
    ds_read_b128 v[64:67], v29 offset:36864
    ds_read_b128 v[68:71], v29 offset:37888
    ds_read_b128 v[72:75], v29 offset:38912
    ds_read_b128 v[76:79], v29 offset:39936
    ds_read_b128 v[80:83], v29 offset:40960
    ds_read_b128 v[84:87], v29 offset:41984
    ds_read_b128 v[88:91], v29 offset:43008
    ds_read_b128 v[92:95], v29 offset:44032
    v_lshlrev_b32 v24, 2, v2
    s_bfe_u32 s52, s31, 196609
    s_lshl_b32 s52, s52, 6
    s_add_u32 s79, s52, s78
    s_mul_i32 s80, s31, 14336
    s_add_u32 s32, s80, 8388608
    s_add_u32 s33, s32, 4096
    s_add_u32 s34, s32, 8192
    s_add_u32 s35, s32, 12288
    s_waitcnt vmcnt(0)
    buffer_store_dword v4, v5, s[8:11], s92 offen
    ds_read_b128 v[96:99], v29 offset:45056
    ds_read_b128 v[100:103], v29 offset:46080
    ds_read_b128 v[104:107], v29 offset:47104
    ds_read_b128 v[108:111], v29 offset:48128
    ds_read_b128 v[112:115], v29 offset:49152
    ds_read_b128 v[116:119], v29 offset:50176
    ds_read_b128 v[120:123], v29 offset:51200
    ds_read_b128 v[124:127], v29 offset:52224
    ds_read_b128 v[128:131], v29 offset:53248
    ds_read_b128 v[132:135], v29 offset:54272
    ds_read_b128 v[136:139], v29 offset:55296
    ds_read_b128 v[140:143], v29 offset:56320
    s_barrier
    buffer_load_dword v25, v24, s[8:11], s79 offen sc1
    s_cmp_ge_u32 s5, 28
    s_cbranch_scc1 wo_idle1
    ds_read_b128 v[144:147], v29 offset:0
    ds_read_b128 v[148:151], v29 offset:1024
    ds_read_b128 v[152:155], v29 offset:2048
    ds_read_b128 v[156:159], v29 offset:3072
    ds_read_b128 v[160:163], v29 offset:4096
    ds_read_b128 v[164:167], v29 offset:5120
    ds_read_b128 v[168:171], v29 offset:6144
    ds_read_b128 v[172:175], v29 offset:7168
    v_lshlrev_b32 v30, 9, v3
    v_lshl_add_u32 v30, v2, 4, v30
    s_mul_i32 s47, s31, 14336
    s_lshl_b32 s56, s7, 11
    s_add_u32 s47, s47, s56
    s_add_u32 s47, s47, 10223616
    v_lshrrev_b32 v31, 5, v0
    v_lshlrev_b32 v31, 2, v31
    v_lshl_add_u32 v31, v2, 3, v31
    s_lshl_b32 s48, s7, 14
    s_lshl_b32 s56, s31, 7
    s_add_u32 s48, s48, s56
    s_add_u32 s48, s48, 6029312
    s_lshl_b32 s49, s6, 7
    s_lshl_b32 s56, s7, 4
    s_add_u32 s49, s49, s56
    s_lshl_b32 s56, s3, 2
    s_add_u32 s49, s49, s56
    s_add_u32 s49, s49, 512
    s_add_u32 s49, s49, s78
    s_mov_b32 s70, 0x3f803f80
    v_lshlrev_b32 v176, 16, v6
    v_and_b32 v180, 0xffff0000, v6
    v_lshlrev_b32 v184, 16, v7
    v_and_b32 v188, 0xffff0000, v7
    v_lshlrev_b32 v177, 16, v8
    v_and_b32 v181, 0xffff0000, v8
    v_lshlrev_b32 v185, 16, v9
    v_and_b32 v189, 0xffff0000, v9
    v_lshlrev_b32 v178, 16, v10
    v_and_b32 v182, 0xffff0000, v10
    v_lshlrev_b32 v186, 16, v11
    v_and_b32 v190, 0xffff0000, v11
    v_lshlrev_b32 v179, 16, v12
    v_and_b32 v183, 0xffff0000, v12
    v_lshlrev_b32 v187, 16, v13
    v_and_b32 v191, 0xffff0000, v13
    s_waitcnt vmcnt(0)
    v_cmp_gt_u32 vcc, 1, v25
    s_nop 0
    s_cbranch_vccz spin11_ok
spin11:
    buffer_load_dword v25, v24, s[8:11], s79 offen sc1
    s_waitcnt vmcnt(0)
    v_cmp_gt_u32 vcc, 1, v25
    s_nop 0
    s_cbranch_vccz spin11_ok
    s_cmp_eq_u32 s98, 0
    s_cbranch_scc1 spin11_ok
    s_sub_u32 s98, s98, 1
    s_branch spin11
spin11_ok:
    buffer_load_dwordx4 v[192:195], v1, s[8:11], s33 offen offset:3072 sc1
    buffer_load_dwordx4 v[196:199], v1, s[8:11], s34 offen offset:0 sc1
    buffer_load_dwordx4 v[200:203], v1, s[8:11], s34 offen offset:1024 sc1
    buffer_load_dwordx4 v[204:207], v1, s[8:11], s34 offen offset:2048 sc1
    buffer_load_dwordx4 v[208:211], v1, s[8:11], s34 offen offset:3072 sc1
    buffer_load_dwordx4 v[212:215], v1, s[8:11], s35 offen offset:0 sc1
    buffer_load_dwordx4 v[216:219], v1, s[8:11], s35 offen offset:1024 sc1
    s_waitcnt vmcnt(6)
    s_waitcnt lgkmcnt(15)
    v_mfma_f32_16x16x32_bf16 v[176:179], v[32:35], v[192:195], v[176:179]
    buffer_load_dwordx4 v[220:223], v1, s[8:11], s32 offen offset:0 sc1
    v_mfma_f32_16x16x32_bf16 v[180:183], v[36:39], v[192:195], v[180:183]
    v_mfma_f32_16x16x32_bf16 v[184:187], v[40:43], v[192:195], v[184:187]
    v_mfma_f32_16x16x32_bf16 v[188:191], v[44:47], v[192:195], v[188:191]
    s_waitcnt vmcnt(6)
    buffer_load_dwordx4 v[224:227], v1, s[8:11], s32 offen offset:1024 sc1
    ds_read_b128 v[32:35], v29 offset:8192
    v_mfma_f32_16x16x32_bf16 v[176:179], v[48:51], v[196:199], v[176:179]
    ds_read_b128 v[36:39], v29 offset:9216
    v_mfma_f32_16x16x32_bf16 v[180:183], v[52:55], v[196:199], v[180:183]
    ds_read_b128 v[40:43], v29 offset:10240
    v_mfma_f32_16x16x32_bf16 v[184:187], v[56:59], v[196:199], v[184:187]
    buffer_load_dwordx4 v[228:231], v1, s[8:11], s32 offen offset:2048 sc1
    ds_read_b128 v[44:47], v29 offset:11264
    v_mfma_f32_16x16x32_bf16 v[188:191], v[60:63], v[196:199], v[188:191]
    s_waitcnt vmcnt(7)
    ds_read_b128 v[48:51], v29 offset:12288
    v_mfma_f32_16x16x32_bf16 v[176:179], v[64:67], v[200:203], v[176:179]
    ds_read_b128 v[52:55], v29 offset:13312
    v_mfma_f32_16x16x32_bf16 v[180:183], v[68:71], v[200:203], v[180:183]
    buffer_load_dwordx4 v[232:235], v1, s[8:11], s32 offen offset:3072 sc1
    ds_read_b128 v[56:59], v29 offset:14336
    v_mfma_f32_16x16x32_bf16 v[184:187], v[72:75], v[200:203], v[184:187]
    ds_read_b128 v[60:63], v29 offset:15360
    v_mfma_f32_16x16x32_bf16 v[188:191], v[76:79], v[200:203], v[188:191]
    s_waitcnt vmcnt(7)
    ds_read_b128 v[64:67], v29 offset:16384
    v_mfma_f32_16x16x32_bf16 v[176:179], v[80:83], v[204:207], v[176:179]
    buffer_load_dwordx4 v[236:239], v1, s[8:11], s33 offen offset:0 sc1
    ds_read_b128 v[68:71], v29 offset:17408
    v_mfma_f32_16x16x32_bf16 v[180:183], v[84:87], v[204:207], v[180:183]
    ds_read_b128 v[72:75], v29 offset:18432
    v_mfma_f32_16x16x32_bf16 v[184:187], v[88:91], v[204:207], v[184:187]
    ds_read_b128 v[76:79], v29 offset:19456
    v_mfma_f32_16x16x32_bf16 v[188:191], v[92:95], v[204:207], v[188:191]
    s_waitcnt vmcnt(7)
    buffer_load_dwordx4 v[240:243], v1, s[8:11], s33 offen offset:1024 sc1
    ds_read_b128 v[80:83], v29 offset:20480
    v_mfma_f32_16x16x32_bf16 v[176:179], v[96:99], v[208:211], v[176:179]
    ds_read_b128 v[84:87], v29 offset:21504
    v_mfma_f32_16x16x32_bf16 v[180:183], v[100:103], v[208:211], v[180:183]
    ds_read_b128 v[88:91], v29 offset:22528
    v_mfma_f32_16x16x32_bf16 v[184:187], v[104:107], v[208:211], v[184:187]
    buffer_load_dwordx4 v[244:247], v1, s[8:11], s33 offen offset:2048 sc1
    ds_read_b128 v[92:95], v29 offset:23552
    v_mfma_f32_16x16x32_bf16 v[188:191], v[108:111], v[208:211], v[188:191]
    s_waitcnt vmcnt(8)
    ds_read_b128 v[96:99], v29 offset:24576
    v_mfma_f32_16x16x32_bf16 v[176:179], v[112:115], v[212:215], v[176:179]
    s_waitcnt lgkmcnt(15)
    ds_read_b128 v[100:103], v29 offset:25600
    v_mfma_f32_16x16x32_bf16 v[180:183], v[116:119], v[212:215], v[180:183]
    ds_read_b128 v[104:107], v29 offset:26624
    v_mfma_f32_16x16x32_bf16 v[184:187], v[120:123], v[212:215], v[184:187]
    ds_read_b128 v[108:111], v29 offset:27648
    v_mfma_f32_16x16x32_bf16 v[188:191], v[124:127], v[212:215], v[188:191]
    s_waitcnt vmcnt(7)
    v_mfma_f32_16x16x32_bf16 v[176:179], v[128:131], v[216:219], v[176:179]
    v_mfma_f32_16x16x32_bf16 v[180:183], v[132:135], v[216:219], v[180:183]
    v_mfma_f32_16x16x32_bf16 v[184:187], v[136:139], v[216:219], v[184:187]
    v_mfma_f32_16x16x32_bf16 v[188:191], v[140:143], v[216:219], v[188:191]
    s_waitcnt vmcnt(6)
    v_mfma_f32_16x16x32_bf16 v[176:179], v[144:147], v[220:223], v[176:179]
    v_mfma_f32_16x16x32_bf16 v[180:183], v[148:151], v[220:223], v[180:183]
    v_mfma_f32_16x16x32_bf16 v[184:187], v[152:155], v[220:223], v[184:187]
    v_mfma_f32_16x16x32_bf16 v[188:191], v[156:159], v[220:223], v[188:191]
    s_waitcnt vmcnt(5)
    v_mfma_f32_16x16x32_bf16 v[176:179], v[160:163], v[224:227], v[176:179]
    v_mfma_f32_16x16x32_bf16 v[180:183], v[164:167], v[224:227], v[180:183]
    v_mfma_f32_16x16x32_bf16 v[184:187], v[168:171], v[224:227], v[184:187]
    v_mfma_f32_16x16x32_bf16 v[188:191], v[172:175], v[224:227], v[188:191]
    s_waitcnt vmcnt(4)
    v_mfma_f32_16x16x32_bf16 v[176:179], v[32:35], v[228:231], v[176:179]
    v_mfma_f32_16x16x32_bf16 v[180:183], v[36:39], v[228:231], v[180:183]
    s_waitcnt lgkmcnt(15)
    v_mfma_f32_16x16x32_bf16 v[184:187], v[40:43], v[228:231], v[184:187]
    v_mfma_f32_16x16x32_bf16 v[188:191], v[44:47], v[228:231], v[188:191]
    s_waitcnt vmcnt(3)
    v_mfma_f32_16x16x32_bf16 v[176:179], v[48:51], v[232:235], v[176:179]
    s_waitcnt lgkmcnt(14)
    v_mfma_f32_16x16x32_bf16 v[180:183], v[52:55], v[232:235], v[180:183]
    s_waitcnt lgkmcnt(13)
    v_mfma_f32_16x16x32_bf16 v[184:187], v[56:59], v[232:235], v[184:187]
    s_waitcnt lgkmcnt(12)
    v_mfma_f32_16x16x32_bf16 v[188:191], v[60:63], v[232:235], v[188:191]
    s_waitcnt vmcnt(2) lgkmcnt(11)
    v_mfma_f32_16x16x32_bf16 v[176:179], v[64:67], v[236:239], v[176:179]
    s_waitcnt lgkmcnt(10)
    v_mfma_f32_16x16x32_bf16 v[180:183], v[68:71], v[236:239], v[180:183]
    s_waitcnt lgkmcnt(9)
    v_mfma_f32_16x16x32_bf16 v[184:187], v[72:75], v[236:239], v[184:187]
    s_waitcnt lgkmcnt(8)
    v_mfma_f32_16x16x32_bf16 v[188:191], v[76:79], v[236:239], v[188:191]
    s_waitcnt vmcnt(1) lgkmcnt(7)
    v_mfma_f32_16x16x32_bf16 v[176:179], v[80:83], v[240:243], v[176:179]
    s_waitcnt lgkmcnt(6)
    v_mfma_f32_16x16x32_bf16 v[180:183], v[84:87], v[240:243], v[180:183]
    s_waitcnt lgkmcnt(5)
    v_mfma_f32_16x16x32_bf16 v[184:187], v[88:91], v[240:243], v[184:187]
    s_waitcnt lgkmcnt(4)
    v_mfma_f32_16x16x32_bf16 v[188:191], v[92:95], v[240:243], v[188:191]
    s_waitcnt vmcnt(0) lgkmcnt(3)
    v_mfma_f32_16x16x32_bf16 v[176:179], v[96:99], v[244:247], v[176:179]
    s_waitcnt lgkmcnt(2)
    v_mfma_f32_16x16x32_bf16 v[180:183], v[100:103], v[244:247], v[180:183]
    s_waitcnt lgkmcnt(1)
    v_mfma_f32_16x16x32_bf16 v[184:187], v[104:107], v[244:247], v[184:187]
    s_waitcnt lgkmcnt(0)
    v_mfma_f32_16x16x32_bf16 v[188:191], v[108:111], v[244:247], v[188:191]
    s_nop 3
    v_cvt_pk_bf16_f32 v6, v176, v180
    s_nop 2
    v_cvt_pk_bf16_f32 v7, v184, v188
    v_cvt_pk_bf16_f32 v8, v177, v181
    v_cvt_pk_bf16_f32 v9, v185, v189
    buffer_store_dwordx4 v[6:9], v30, s[8:11], s47 offen offset:0
    v_cvt_pk_bf16_f32 v10, v178, v182
    v_cvt_pk_bf16_f32 v11, v186, v190
    v_cvt_pk_bf16_f32 v12, v179, v183
    v_cvt_pk_bf16_f32 v13, v187, v191
    buffer_store_dwordx4 v[10:13], v30, s[8:11], s47 offen offset:256
    v_dot2_f32_bf16 v24, v6, s70, 0
    v_dot2_f32_bf16 v25, v6, v6, 0
    v_dot2_f32_bf16 v26, v10, s70, 0
    v_dot2_f32_bf16 v27, v10, v10, 0
    v_dot2_f32_bf16 v24, v7, s70, v24
    v_dot2_f32_bf16 v25, v7, v7, v25
    v_dot2_f32_bf16 v26, v11, s70, v26
    v_dot2_f32_bf16 v27, v11, v11, v27
    v_dot2_f32_bf16 v24, v8, s70, v24
    v_dot2_f32_bf16 v25, v8, v8, v25
    v_dot2_f32_bf16 v26, v12, s70, v26
    v_dot2_f32_bf16 v27, v12, v12, v27
    v_dot2_f32_bf16 v24, v9, s70, v24
    v_dot2_f32_bf16 v25, v9, v9, v25
    v_dot2_f32_bf16 v26, v13, s70, v26
    v_dot2_f32_bf16 v27, v13, v13, v27
    s_nop 2
    v_pk_add_f32 v[24:25], v[24:25], v[26:27]
    s_nop 1
    v_permlane32_swap_b32 v24, v25
    v_add_f32 v24, v24, v25
    v_mov_b32 v25, v24
    s_nop 1
    v_permlane16_swap_b32 v24, v25
    v_add_f32 v24, v24, v25
    buffer_store_dword v24, v31, s[8:11], s48 offen
    s_waitcnt vmcnt(0)
    buffer_store_dword v4, v5, s[8:11], s49 offen
wo_done1:
    s_nop 1
    v_min_u32 v24, 27, v0
    v_lshlrev_b32 v24, 2, v24
    s_lshl_b32 s52, s3, 7
    s_add_u32 s52, s52, s78
    s_add_u32 s79, s52, 512
    buffer_load_dword v31, v24, s[8:11], s79 offen sc1
    v_add_u32 v25, 14336, v1
    v_add_u32 v26, 28672, v1
    v_add_u32 v27, 43008, v1
    s_lshl_b32 s88, s4, 2
    s_add_u32 s88, s88, s3
    s_mul_i32 s80, s88, 57344
    s_add_u32 s32, s80, 10223616
    s_add_u32 s33, s32, 4096
    s_add_u32 s34, s32, 8192
    s_add_u32 s35, s32, 12288
    s_lshl_b32 s81, s88, 9
    s_add_u32 s36, s81, 6029312
    s_add_u32 s37, s36, 16384
    s_add_u32 s38, s36, 32768
    s_add_u32 s39, s36, 49152
    s_add_u32 s40, s36, 65536
    s_add_u32 s41, s36, 81920
    s_add_u32 s42, s36, 98304
    v_lshlrev_b32 v28, 3, v0
    v_add_u32 v29, 50176, v1
    v_lshlrev_b32 v30, 4, v3
    v_add_u32 v30, 160768, v30
    s_waitcnt lgkmcnt(0)
    s_barrier
    ds_read_b128 v[224:227], v1 offset:0
    ds_read_b128 v[228:231], v1 offset:1024
    ds_read_b128 v[232:235], v1 offset:2048
    ds_read_b128 v[236:239], v1 offset:3072
    s_waitcnt vmcnt(0)
    v_cmp_gt_u32 vcc, 1, v31
    s_nop 0
    s_cbranch_vccz spin12_ok
spin12:
    buffer_load_dword v31, v24, s[8:11], s79 offen sc1
    s_waitcnt vmcnt(0)
    v_cmp_gt_u32 vcc, 1, v31
    s_nop 0
    s_cbranch_vccz spin12_ok
    s_cmp_eq_u32 s98, 0
    s_cbranch_scc1 spin12_ok
    s_sub_u32 s98, s98, 1
    s_branch spin12
spin12_ok:
    buffer_load_dwordx4 v[144:147], v1, s[8:11], s32 offen offset:0 sc1
    buffer_load_dwordx4 v[148:151], v25, s[8:11], s32 offen offset:0 sc1
    buffer_load_dwordx4 v[152:155], v26, s[8:11], s32 offen offset:0 sc1
    buffer_load_dwordx4 v[156:159], v27, s[8:11], s32 offen offset:0 sc1
    buffer_load_dwordx4 v[160:163], v1, s[8:11], s32 offen offset:1024 sc1
    buffer_load_dwordx4 v[164:167], v25, s[8:11], s32 offen offset:1024 sc1
    buffer_load_dwordx4 v[168:171], v26, s[8:11], s32 offen offset:1024 sc1
    buffer_load_dwordx4 v[172:175], v27, s[8:11], s32 offen offset:1024 sc1
    s_waitcnt vmcnt(7)
    s_waitcnt lgkmcnt(3)
    v_mfma_f32_16x16x32_bf16 v[32:35], v[224:227], v[144:147], 0
    s_waitcnt vmcnt(6)
    ds_read_b128 v[240:243], v1 offset:4096
    v_mfma_f32_16x16x32_bf16 v[36:39], v[224:227], v[148:151], 0
    s_waitcnt vmcnt(5)
    buffer_load_dwordx4 v[176:179], v1, s[8:11], s32 offen offset:2048 sc1
    v_mfma_f32_16x16x32_bf16 v[40:43], v[224:227], v[152:155], 0
    s_waitcnt vmcnt(5)
    v_mfma_f32_16x16x32_bf16 v[44:47], v[224:227], v[156:159], 0
    s_waitcnt lgkmcnt(3)
    v_mfma_f32_16x16x32_bf16 v[48:51], v[228:231], v[144:147], 0
    ds_read_b128 v[224:227], v1 offset:5120
    v_mfma_f32_16x16x32_bf16 v[52:55], v[228:231], v[148:151], 0
    buffer_load_dwordx4 v[180:183], v25, s[8:11], s32 offen offset:2048 sc1
    v_mfma_f32_16x16x32_bf16 v[56:59], v[228:231], v[152:155], 0
    v_mfma_f32_16x16x32_bf16 v[60:63], v[228:231], v[156:159], 0
    s_waitcnt lgkmcnt(3)
    v_mfma_f32_16x16x32_bf16 v[64:67], v[232:235], v[144:147], 0
    ds_read_b128 v[228:231], v1 offset:6144
    v_mfma_f32_16x16x32_bf16 v[68:71], v[232:235], v[148:151], 0
    buffer_load_dwordx4 v[184:187], v26, s[8:11], s32 offen offset:2048 sc1
    v_mfma_f32_16x16x32_bf16 v[72:75], v[232:235], v[152:155], 0
    v_mfma_f32_16x16x32_bf16 v[76:79], v[232:235], v[156:159], 0
    s_waitcnt lgkmcnt(3)
    v_mfma_f32_16x16x32_bf16 v[80:83], v[236:239], v[144:147], 0
    ds_read_b128 v[232:235], v1 offset:7168
    v_mfma_f32_16x16x32_bf16 v[84:87], v[236:239], v[148:151], 0
    buffer_load_dwordx4 v[188:191], v27, s[8:11], s32 offen offset:2048 sc1
    v_mfma_f32_16x16x32_bf16 v[88:91], v[236:239], v[152:155], 0
    v_mfma_f32_16x16x32_bf16 v[92:95], v[236:239], v[156:159], 0
    s_waitcnt lgkmcnt(3)
    v_mfma_f32_16x16x32_bf16 v[96:99], v[240:243], v[144:147], 0
    ds_read_b128 v[236:239], v1 offset:8192
    v_mfma_f32_16x16x32_bf16 v[100:103], v[240:243], v[148:151], 0
    buffer_load_dwordx2 v[208:209], v28, s[8:11], s36 offen sc1
    v_mfma_f32_16x16x32_bf16 v[104:107], v[240:243], v[152:155], 0
    v_mfma_f32_16x16x32_bf16 v[108:111], v[240:243], v[156:159], 0
    s_waitcnt lgkmcnt(3)
    v_mfma_f32_16x16x32_bf16 v[112:115], v[224:227], v[144:147], 0
    ds_read_b128 v[240:243], v1 offset:9216
    v_mfma_f32_16x16x32_bf16 v[116:119], v[224:227], v[148:151], 0
    buffer_load_dwordx2 v[210:211], v28, s[8:11], s37 offen sc1
    v_mfma_f32_16x16x32_bf16 v[120:123], v[224:227], v[152:155], 0
    v_mfma_f32_16x16x32_bf16 v[124:127], v[224:227], v[156:159], 0
    s_waitcnt lgkmcnt(3)
    v_mfma_f32_16x16x32_bf16 v[128:131], v[228:231], v[144:147], 0
    ds_read_b128 v[224:227], v1 offset:10240
    v_mfma_f32_16x16x32_bf16 v[132:135], v[228:231], v[148:151], 0
    buffer_load_dwordx2 v[212:213], v28, s[8:11], s38 offen sc1
    v_mfma_f32_16x16x32_bf16 v[136:139], v[228:231], v[152:155], 0
    v_mfma_f32_16x16x32_bf16 v[140:143], v[228:231], v[156:159], 0
    s_waitcnt vmcnt(7) lgkmcnt(3)
    v_mfma_f32_16x16x32_bf16 v[32:35], v[232:235], v[160:163], v[32:35]
    ds_read_b128 v[228:231], v1 offset:11264
    v_mfma_f32_16x16x32_bf16 v[36:39], v[232:235], v[164:167], v[36:39]
    buffer_load_dwordx2 v[214:215], v28, s[8:11], s39 offen sc1
    v_mfma_f32_16x16x32_bf16 v[40:43], v[232:235], v[168:171], v[40:43]
    v_mfma_f32_16x16x32_bf16 v[44:47], v[232:235], v[172:175], v[44:47]
    s_waitcnt lgkmcnt(3)
    v_mfma_f32_16x16x32_bf16 v[48:51], v[236:239], v[160:163], v[48:51]
    ds_read_b128 v[232:235], v1 offset:12288
    v_mfma_f32_16x16x32_bf16 v[52:55], v[236:239], v[164:167], v[52:55]
    buffer_load_dwordx2 v[216:217], v28, s[8:11], s40 offen sc1
    v_mfma_f32_16x16x32_bf16 v[56:59], v[236:239], v[168:171], v[56:59]
    v_mfma_f32_16x16x32_bf16 v[60:63], v[236:239], v[172:175], v[60:63]
    s_waitcnt lgkmcnt(3)
    v_mfma_f32_16x16x32_bf16 v[64:67], v[240:243], v[160:163], v[64:67]
    ds_read_b128 v[236:239], v1 offset:13312
    v_mfma_f32_16x16x32_bf16 v[68:71], v[240:243], v[164:167], v[68:71]
    buffer_load_dwordx2 v[218:219], v28, s[8:11], s41 offen sc1
    v_mfma_f32_16x16x32_bf16 v[72:75], v[240:243], v[168:171], v[72:75]
    v_mfma_f32_16x16x32_bf16 v[76:79], v[240:243], v[172:175], v[76:79]
    s_waitcnt lgkmcnt(3)
    v_mfma_f32_16x16x32_bf16 v[80:83], v[224:227], v[160:163], v[80:83]
    ds_read_b128 v[240:243], v1 offset:14336
    v_mfma_f32_16x16x32_bf16 v[84:87], v[224:227], v[164:167], v[84:87]
    buffer_load_dwordx2 v[220:221], v28, s[8:11], s42 offen sc1
    v_mfma_f32_16x16x32_bf16 v[88:91], v[224:227], v[168:171], v[88:91]
    v_mfma_f32_16x16x32_bf16 v[92:95], v[224:227], v[172:175], v[92:95]
    s_waitcnt lgkmcnt(3)
    v_mfma_f32_16x16x32_bf16 v[96:99], v[228:231], v[160:163], v[96:99]
    ds_read_b128 v[224:227], v1 offset:15360
    v_mfma_f32_16x16x32_bf16 v[100:103], v[228:231], v[164:167], v[100:103]
    buffer_load_dwordx4 v[192:195], v1, s[8:11], s32 offen offset:3072 sc1
    v_mfma_f32_16x16x32_bf16 v[104:107], v[228:231], v[168:171], v[104:107]
    v_mfma_f32_16x16x32_bf16 v[108:111], v[228:231], v[172:175], v[108:111]
    s_waitcnt lgkmcnt(3)
    v_mfma_f32_16x16x32_bf16 v[112:115], v[232:235], v[160:163], v[112:115]
    ds_read_b128 v[228:231], v1 offset:16384
    v_mfma_f32_16x16x32_bf16 v[116:119], v[232:235], v[164:167], v[116:119]
    buffer_load_dwordx4 v[196:199], v25, s[8:11], s32 offen offset:3072 sc1
    v_mfma_f32_16x16x32_bf16 v[120:123], v[232:235], v[168:171], v[120:123]
    v_mfma_f32_16x16x32_bf16 v[124:127], v[232:235], v[172:175], v[124:127]
    s_waitcnt lgkmcnt(3)
    v_mfma_f32_16x16x32_bf16 v[128:131], v[236:239], v[160:163], v[128:131]
    ds_read_b128 v[232:235], v1 offset:17408
    v_mfma_f32_16x16x32_bf16 v[132:135], v[236:239], v[164:167], v[132:135]
    buffer_load_dwordx4 v[200:203], v26, s[8:11], s32 offen offset:3072 sc1
    v_mfma_f32_16x16x32_bf16 v[136:139], v[236:239], v[168:171], v[136:139]
    v_mfma_f32_16x16x32_bf16 v[140:143], v[236:239], v[172:175], v[140:143]
    s_waitcnt vmcnt(10) lgkmcnt(3)
    v_mfma_f32_16x16x32_bf16 v[32:35], v[240:243], v[176:179], v[32:35]
    ds_read_b128 v[236:239], v1 offset:18432
    v_mfma_f32_16x16x32_bf16 v[36:39], v[240:243], v[180:183], v[36:39]
    buffer_load_dwordx4 v[204:207], v27, s[8:11], s32 offen offset:3072 sc1
    v_mfma_f32_16x16x32_bf16 v[40:43], v[240:243], v[184:187], v[40:43]
    v_mfma_f32_16x16x32_bf16 v[44:47], v[240:243], v[188:191], v[44:47]
    s_waitcnt lgkmcnt(3)
    v_mfma_f32_16x16x32_bf16 v[48:51], v[224:227], v[176:179], v[48:51]
    ds_read_b128 v[240:243], v1 offset:19456
    v_mfma_f32_16x16x32_bf16 v[52:55], v[224:227], v[180:183], v[52:55]
    buffer_load_dwordx4 a[224:227], v1, s[8:11], s33 offen offset:0 sc1
    v_mfma_f32_16x16x32_bf16 v[56:59], v[224:227], v[184:187], v[56:59]
    v_mfma_f32_16x16x32_bf16 v[60:63], v[224:227], v[188:191], v[60:63]
    s_waitcnt lgkmcnt(3)
    v_mfma_f32_16x16x32_bf16 v[64:67], v[228:231], v[176:179], v[64:67]
    ds_read_b128 v[224:227], v1 offset:20480
    s_waitcnt vmcnt(10)
    v_add_f32 v208, v208, v210
    v_mfma_f32_16x16x32_bf16 v[68:71], v[228:231], v[180:183], v[68:71]
    buffer_load_dwordx4 a[228:231], v25, s[8:11], s33 offen offset:0 sc1
    v_add_f32 v209, v209, v211
    v_mfma_f32_16x16x32_bf16 v[72:75], v[228:231], v[184:187], v[72:75]
    s_waitcnt vmcnt(10)
    v_add_f32 v208, v208, v212
    v_add_f32 v209, v209, v213
    v_mfma_f32_16x16x32_bf16 v[76:79], v[228:231], v[188:191], v[76:79]
    s_waitcnt lgkmcnt(3)
    s_waitcnt vmcnt(9)
    v_add_f32 v208, v208, v214
    v_add_f32 v209, v209, v215
    v_mfma_f32_16x16x32_bf16 v[80:83], v[232:235], v[176:179], v[80:83]
    ds_read_b128 v[228:231], v1 offset:21504
    s_waitcnt vmcnt(8)
    v_add_f32 v208, v208, v216
    v_mfma_f32_16x16x32_bf16 v[84:87], v[232:235], v[180:183], v[84:87]
    buffer_load_dwordx4 a[232:235], v26, s[8:11], s33 offen offset:0 sc1
    v_add_f32 v209, v209, v217
    v_mfma_f32_16x16x32_bf16 v[88:91], v[232:235], v[184:187], v[88:91]
    s_waitcnt vmcnt(8)
    v_add_f32 v208, v208, v218
    v_add_f32 v209, v209, v219
    v_mfma_f32_16x16x32_bf16 v[92:95], v[232:235], v[188:191], v[92:95]
    s_waitcnt lgkmcnt(3)
    s_waitcnt vmcnt(7)
    v_add_f32 v208, v208, v220
    v_add_f32 v209, v209, v221
    v_mfma_f32_16x16x32_bf16 v[96:99], v[236:239], v[176:179], v[96:99]
    s_add_u32 s52, s53, 100352
    ds_read_b128 v[232:235], v1 offset:22528
    v_add_u32 v28, s52, v1
    v_mfma_f32_16x16x32_bf16 v[100:103], v[236:239], v[180:183], v[100:103]
    buffer_load_dwordx4 a[236:239], v27, s[8:11], s33 offen offset:0 sc1
    v_lshl_add_u32 v31, v2, 4, s52
    v_mfma_f32_16x16x32_bf16 v[104:107], v[236:239], v[184:187], v[104:107]
    v_mul_f32 v208, 0xbb124925, v208
    v_mul_f32 v209, 0x3b124925, v209
    v_mfma_f32_16x16x32_bf16 v[108:111], v[236:239], v[188:191], v[108:111]
    s_waitcnt lgkmcnt(3)
    v_fma_f32 v209, -v208, v208, v209
    v_max_f32 v209, 0, v209
    v_mfma_f32_16x16x32_bf16 v[112:115], v[240:243], v[176:179], v[112:115]
    ds_read_b128 v[236:239], v1 offset:23552
    v_add_f32 v211, 0x3727c5ac, v209
    v_mfma_f32_16x16x32_bf16 v[116:119], v[240:243], v[180:183], v[116:119]
    buffer_load_dwordx4 a[240:243], v1, s[8:11], s33 offen offset:1024 sc1
    v_mfma_f32_16x16x32_bf16 v[120:123], v[240:243], v[184:187], v[120:123]
    v_rsq_f32 v209, v211
    v_mfma_f32_16x16x32_bf16 v[124:127], v[240:243], v[188:191], v[124:127]
    s_waitcnt lgkmcnt(3)
    v_mov_b32 v212, 0
    v_mul_f32 v210, 0xbfb8aa3b, v209
    v_mfma_f32_16x16x32_bf16 v[128:131], v[224:227], v[176:179], v[128:131]
    ds_read_b128 v[240:243], v1 offset:24576
    ds_write_b128 v28, v[208:211]
    v_mfma_f32_16x16x32_bf16 v[132:135], v[224:227], v[180:183], v[132:135]
    buffer_load_dwordx4 a[244:247], v25, s[8:11], s33 offen offset:1024 sc1
    ds_read_b32 v252, v31 offset:0
    v_mfma_f32_16x16x32_bf16 v[136:139], v[224:227], v[184:187], v[136:139]
    ds_read_b32 v253, v31 offset:256
    ds_read_b32 v254, v31 offset:512
    v_mfma_f32_16x16x32_bf16 v[140:143], v[224:227], v[188:191], v[140:143]
    s_waitcnt vmcnt(6) lgkmcnt(7)
    ds_read_b32 v255, v31 offset:768
    ds_read_b64 v[16:17], v31 offset:8
    v_mfma_f32_16x16x32_bf16 v[32:35], v[228:231], v[192:195], v[32:35]
    ds_read_b128 v[224:227], v1 offset:25600
    ds_read_b64 v[18:19], v31 offset:264
    v_mfma_f32_16x16x32_bf16 v[36:39], v[228:231], v[196:199], v[36:39]
    buffer_load_dwordx4 a[248:251], v26, s[8:11], s33 offen offset:1024 sc1
    ds_read_b64 v[20:21], v31 offset:520
    v_mfma_f32_16x16x32_bf16 v[40:43], v[228:231], v[200:203], v[40:43]
    ds_read_b64 v[22:23], v31 offset:776
    v_mul_u32_u24 v28, 57344, v3
    v_mfma_f32_16x16x32_bf16 v[44:47], v[228:231], v[204:207], v[44:47]
    s_waitcnt lgkmcnt(12)
    v_lshl_add_u32 v28, v2, 4, v28
    s_mul_i32 s81, s88, 229376
    v_mfma_f32_16x16x32_bf16 v[48:51], v[232:235], v[192:195], v[48:51]
    s_lshl_b32 s52, s5, 8
    ds_read_b128 v[228:231], v1 offset:26624
    s_add_u32 s81, s81, s52
    v_mfma_f32_16x16x32_bf16 v[52:55], v[232:235], v[196:199], v[52:55]
    s_add_u32 s81, s81, 12058624
    buffer_load_dwordx4 a[252:255], v27, s[8:11], s33 offen offset:1024 sc1
    s_lshl_b32 s52, s3, 7
    v_mfma_f32_16x16x32_bf16 v[56:59], v[232:235], v[200:203], v[56:59]
    s_lshl_b32 s55, s5, 2
    s_add_u32 s52, s52, s55
    s_add_u32 s52, s52, s78
    v_mfma_f32_16x16x32_bf16 v[60:63], v[232:235], v[204:207], v[60:63]
    s_waitcnt lgkmcnt(12)
    s_add_u32 s82, s52, 1024
    s_lshl_b32 s52, s6, 7
    v_mfma_f32_16x16x32_bf16 v[64:67], v[236:239], v[192:195], v[64:67]
    s_lshl_b32 s55, s3, 5
    ds_read_b128 v[232:235], v1 offset:27648
    s_add_u32 s52, s52, s55
    v_mfma_f32_16x16x32_bf16 v[68:71], v[236:239], v[196:199], v[68:71]
    s_add_u32 s52, s52, s78
    buffer_load_dwordx4 v[144:147], v1, s[8:11], s33 offen offset:3072 sc1
    s_add_u32 s79, s52, 1024
    v_mfma_f32_16x16x32_bf16 v[72:75], v[236:239], v[200:203], v[72:75]
    s_lshl_b32 s52, s4, 2
    s_add_u32 s52, s52, s6
    s_mul_i32 s89, s52, 229376
    v_mfma_f32_16x16x32_bf16 v[76:79], v[236:239], v[204:207], v[76:79]
    s_waitcnt lgkmcnt(12)
    s_lshl_b32 s52, s3, 11
    s_add_u32 s89, s89, s52
    v_mfma_f32_16x16x32_bf16 v[80:83], v[240:243], v[192:195], v[80:83]
    s_add_u32 s36, s89, 12058624
    ds_read_b128 v[236:239], v1 offset:28672
    s_add_u32 s37, s36, 8192
    v_mfma_f32_16x16x32_bf16 v[84:87], v[240:243], v[196:199], v[84:87]
    s_add_u32 s38, s36, 16384
    buffer_load_dwordx4 v[208:211], v1, s[8:11], s33 offen offset:2048 sc1
    s_add_u32 s39, s36, 24576
    v_mfma_f32_16x16x32_bf16 v[88:91], v[240:243], v[200:203], v[88:91]
    s_add_u32 s40, s36, 32768
    s_add_u32 s41, s36, 40960
    s_add_u32 s42, s36, 49152
    v_mfma_f32_16x16x32_bf16 v[92:95], v[240:243], v[204:207], v[92:95]
    s_waitcnt lgkmcnt(6)
    v_and_b32 v24, 7, v0
    v_lshlrev_b32 v24, 2, v24
    v_mfma_f32_16x16x32_bf16 v[96:99], v[224:227], v[192:195], v[96:99]
    ds_read_b128 v[240:243], v1 offset:29696
    v_mfma_f32_16x16x32_bf16 v[100:103], v[224:227], v[196:199], v[100:103]
    buffer_load_dwordx4 v[212:215], v25, s[8:11], s33 offen offset:2048 sc1
    v_mfma_f32_16x16x32_bf16 v[104:107], v[224:227], v[200:203], v[104:107]
    v_mfma_f32_16x16x32_bf16 v[108:111], v[224:227], v[204:207], v[108:111]
    s_waitcnt lgkmcnt(3)
    v_mfma_f32_16x16x32_bf16 v[112:115], v[228:231], v[192:195], v[112:115]
    ds_read_b128 v[224:227], v1 offset:30720
    v_mfma_f32_16x16x32_bf16 v[116:119], v[228:231], v[196:199], v[116:119]
    buffer_load_dwordx4 v[216:219], v26, s[8:11], s33 offen offset:2048 sc1
    v_mfma_f32_16x16x32_bf16 v[120:123], v[228:231], v[200:203], v[120:123]
    v_mfma_f32_16x16x32_bf16 v[124:127], v[228:231], v[204:207], v[124:127]
    s_waitcnt lgkmcnt(3)
    v_mfma_f32_16x16x32_bf16 v[128:131], v[232:235], v[192:195], v[128:131]
    ds_read_b128 v[228:231], v1 offset:31744
    v_mfma_f32_16x16x32_bf16 v[132:135], v[232:235], v[196:199], v[132:135]
    buffer_load_dwordx4 v[220:223], v27, s[8:11], s33 offen offset:2048 sc1
    v_mfma_f32_16x16x32_bf16 v[136:139], v[232:235], v[200:203], v[136:139]
    v_mfma_f32_16x16x32_bf16 v[140:143], v[232:235], v[204:207], v[140:143]
    s_waitcnt vmcnt(9) lgkmcnt(3)
    ds_read_b128 v[248:251], v30 offset:256
    v_mfma_f32_16x16x32_bf16 v[32:35], v[236:239], a[224:227], v[32:35]
    ds_read_b128 v[232:235], v1 offset:32768
    ds_read_b128 v[244:247], v30 offset:320
    v_mfma_f32_16x16x32_bf16 v[36:39], v[236:239], a[228:231], v[36:39]
    buffer_load_dwordx4 v[148:151], v25, s[8:11], s33 offen offset:3072 sc1
    s_waitcnt lgkmcnt(2)
    v_fmac_f32 v96, v252, v248
    v_mfma_f32_16x16x32_bf16 v[40:43], v[236:239], a[232:235], v[40:43]
    v_fmac_f32 v97, v252, v249
    v_fmac_f32 v98, v252, v250
    v_mfma_f32_16x16x32_bf16 v[44:47], v[236:239], a[236:239], v[44:47]
    v_fmac_f32 v99, v252, v251
    v_mfma_f32_16x16x32_bf16 v[48:51], v[240:243], a[224:227], v[48:51]
    ds_read_b128 v[236:239], v1 offset:33792
    ds_read_b128 v[248:251], v30 offset:384
    v_mfma_f32_16x16x32_bf16 v[52:55], v[240:243], a[228:231], v[52:55]
    buffer_load_dwordx4 v[152:155], v26, s[8:11], s33 offen offset:3072 sc1
    s_waitcnt lgkmcnt(2)
    v_fmac_f32 v112, v252, v244
    v_mfma_f32_16x16x32_bf16 v[56:59], v[240:243], a[232:235], v[56:59]
    v_fmac_f32 v113, v252, v245
    v_fmac_f32 v114, v252, v246
    v_mfma_f32_16x16x32_bf16 v[60:63], v[240:243], a[236:239], v[60:63]
    v_fmac_f32 v115, v252, v247
    v_mfma_f32_16x16x32_bf16 v[64:67], v[224:227], a[224:227], v[64:67]
    ds_read_b128 v[240:243], v1 offset:34816
    ds_read_b128 v[244:247], v30 offset:0
    v_mfma_f32_16x16x32_bf16 v[68:71], v[224:227], a[228:231], v[68:71]
    buffer_load_dwordx4 v[156:159], v27, s[8:11], s33 offen offset:3072 sc1
    s_waitcnt lgkmcnt(2)
    v_fmac_f32 v128, v252, v248
    v_mfma_f32_16x16x32_bf16 v[72:75], v[224:227], a[232:235], v[72:75]
    v_fmac_f32 v129, v252, v249
    v_fmac_f32 v130, v252, v250
    v_mfma_f32_16x16x32_bf16 v[76:79], v[224:227], a[236:239], v[76:79]
    v_fmac_f32 v131, v252, v251
    v_mfma_f32_16x16x32_bf16 v[80:83], v[228:231], a[224:227], v[80:83]
    ds_read_b128 v[224:227], v1 offset:35840
    ds_read_b128 v[248:251], v30 offset:64
    v_mfma_f32_16x16x32_bf16 v[84:87], v[228:231], a[228:231], v[84:87]
    buffer_load_dwordx4 v[160:163], v1, s[8:11], s34 offen offset:0 sc1
    s_waitcnt lgkmcnt(2)
    v_fmac_f32 v32, v252, v244
    v_mfma_f32_16x16x32_bf16 v[88:91], v[228:231], a[232:235], v[88:91]
    v_fmac_f32 v33, v252, v245
    v_fmac_f32 v34, v252, v246
    v_mfma_f32_16x16x32_bf16 v[92:95], v[228:231], a[236:239], v[92:95]
    v_fmac_f32 v35, v252, v247
    v_mfma_f32_16x16x32_bf16 v[96:99], v[232:235], a[224:227], v[96:99]
    ds_read_b128 v[228:231], v1 offset:36864
    ds_read_b128 v[244:247], v30 offset:128
    v_mfma_f32_16x16x32_bf16 v[100:103], v[232:235], a[228:231], v[100:103]
    buffer_load_dwordx4 v[164:167], v25, s[8:11], s34 offen offset:0 sc1
    s_waitcnt lgkmcnt(2)
    v_fmac_f32 v48, v252, v248
    v_mfma_f32_16x16x32_bf16 v[104:107], v[232:235], a[232:235], v[104:107]
    v_fmac_f32 v49, v252, v249
    v_fmac_f32 v50, v252, v250
    v_mfma_f32_16x16x32_bf16 v[108:111], v[232:235], a[236:239], v[108:111]
    v_fmac_f32 v51, v252, v251
    v_mfma_f32_16x16x32_bf16 v[112:115], v[236:239], a[224:227], v[112:115]
    ds_read_b128 v[232:235], v1 offset:37888
    ds_read_b128 v[248:251], v30 offset:192
    v_mfma_f32_16x16x32_bf16 v[116:119], v[236:239], a[228:231], v[116:119]
    buffer_load_dwordx4 v[168:171], v26, s[8:11], s34 offen offset:0 sc1
    s_waitcnt lgkmcnt(2)
    v_fmac_f32 v64, v252, v244
    v_mfma_f32_16x16x32_bf16 v[120:123], v[236:239], a[232:235], v[120:123]
    v_fmac_f32 v65, v252, v245
    v_fmac_f32 v66, v252, v246
    v_mfma_f32_16x16x32_bf16 v[124:127], v[236:239], a[236:239], v[124:127]
    v_fmac_f32 v67, v252, v247
    v_mfma_f32_16x16x32_bf16 v[128:131], v[240:243], a[224:227], v[128:131]
    ds_read_b128 v[236:239], v1 offset:38912
    ds_read_b128 v[244:247], v30 offset:256
    v_mfma_f32_16x16x32_bf16 v[132:135], v[240:243], a[228:231], v[132:135]
    buffer_load_dwordx4 v[172:175], v27, s[8:11], s34 offen offset:0 sc1
    s_waitcnt lgkmcnt(2)
    v_fmac_f32 v80, v252, v248
    v_mfma_f32_16x16x32_bf16 v[136:139], v[240:243], a[232:235], v[136:139]
    v_fmac_f32 v81, v252, v249
    v_fmac_f32 v82, v252, v250
    v_mfma_f32_16x16x32_bf16 v[140:143], v[240:243], a[236:239], v[140:143]
    s_waitcnt vmcnt(12)
    v_fmac_f32 v83, v252, v251
    v_mfma_f32_16x16x32_bf16 v[32:35], v[224:227], a[240:243], v[32:35]
    ds_read_b128 v[240:243], v1 offset:39936
    ds_read_b128 v[248:251], v30 offset:320
    v_mfma_f32_16x16x32_bf16 v[36:39], v[224:227], a[244:247], v[36:39]
    buffer_load_dwordx4 v[176:179], v1, s[8:11], s34 offen offset:1024 sc1
    s_waitcnt lgkmcnt(2)
    v_fmac_f32 v100, v253, v244
    v_mfma_f32_16x16x32_bf16 v[40:43], v[224:227], a[248:251], v[40:43]
    v_fmac_f32 v101, v253, v245
    v_fmac_f32 v102, v253, v246
    v_mfma_f32_16x16x32_bf16 v[44:47], v[224:227], a[252:255], v[44:47]
    v_fmac_f32 v103, v253, v247
    v_mfma_f32_16x16x32_bf16 v[48:51], v[228:231], a[240:243], v[48:51]
    ds_read_b128 v[224:227], v1 offset:40960
    ds_read_b128 v[244:247], v30 offset:384
    v_mfma_f32_16x16x32_bf16 v[52:55], v[228:231], a[244:247], v[52:55]
    buffer_load_dwordx4 v[180:183], v25, s[8:11], s34 offen offset:1024 sc1
    s_waitcnt lgkmcnt(2)
    v_fmac_f32 v116, v253, v248
    v_mfma_f32_16x16x32_bf16 v[56:59], v[228:231], a[248:251], v[56:59]
    v_fmac_f32 v117, v253, v249
    v_fmac_f32 v118, v253, v250
    v_mfma_f32_16x16x32_bf16 v[60:63], v[228:231], a[252:255], v[60:63]
    v_fmac_f32 v119, v253, v251
    v_mfma_f32_16x16x32_bf16 v[64:67], v[232:235], a[240:243], v[64:67]
    ds_read_b128 v[228:231], v1 offset:41984
    ds_read_b128 v[248:251], v30 offset:0
    v_mfma_f32_16x16x32_bf16 v[68:71], v[232:235], a[244:247], v[68:71]
    buffer_load_dwordx4 v[184:187], v26, s[8:11], s34 offen offset:1024 sc1
    s_waitcnt lgkmcnt(2)
    v_fmac_f32 v132, v253, v244
    v_mfma_f32_16x16x32_bf16 v[72:75], v[232:235], a[248:251], v[72:75]
    v_fmac_f32 v133, v253, v245
    v_fmac_f32 v134, v253, v246
    v_mfma_f32_16x16x32_bf16 v[76:79], v[232:235], a[252:255], v[76:79]
    v_fmac_f32 v135, v253, v247
    v_mfma_f32_16x16x32_bf16 v[80:83], v[236:239], a[240:243], v[80:83]
    ds_read_b128 v[232:235], v1 offset:43008
    ds_read_b128 v[244:247], v30 offset:64
    v_mfma_f32_16x16x32_bf16 v[84:87], v[236:239], a[244:247], v[84:87]
    buffer_load_dwordx4 v[188:191], v27, s[8:11], s34 offen offset:1024 sc1
    s_waitcnt lgkmcnt(2)
    v_fmac_f32 v36, v253, v248
    v_mfma_f32_16x16x32_bf16 v[88:91], v[236:239], a[248:251], v[88:91]
    v_fmac_f32 v37, v253, v249
    v_fmac_f32 v38, v253, v250
    v_mfma_f32_16x16x32_bf16 v[92:95], v[236:239], a[252:255], v[92:95]
    v_fmac_f32 v39, v253, v251
    v_mfma_f32_16x16x32_bf16 v[96:99], v[240:243], a[240:243], v[96:99]
    ds_read_b128 v[236:239], v1 offset:44032
    ds_read_b128 v[248:251], v30 offset:128
    v_mfma_f32_16x16x32_bf16 v[100:103], v[240:243], a[244:247], v[100:103]
    buffer_load_dwordx4 v[192:195], v1, s[8:11], s34 offen offset:2048 sc1
    s_waitcnt lgkmcnt(2)
    v_fmac_f32 v52, v253, v244
    v_mfma_f32_16x16x32_bf16 v[104:107], v[240:243], a[248:251], v[104:107]
    v_fmac_f32 v53, v253, v245
    v_fmac_f32 v54, v253, v246
    v_mfma_f32_16x16x32_bf16 v[108:111], v[240:243], a[252:255], v[108:111]
    v_fmac_f32 v55, v253, v247
    v_mfma_f32_16x16x32_bf16 v[112:115], v[224:227], a[240:243], v[112:115]
    ds_read_b128 v[240:243], v1 offset:45056
    ds_read_b128 v[244:247], v30 offset:192
    v_mfma_f32_16x16x32_bf16 v[116:119], v[224:227], a[244:247], v[116:119]
    buffer_load_dwordx4 v[196:199], v25, s[8:11], s34 offen offset:2048 sc1
    s_waitcnt lgkmcnt(2)
    v_fmac_f32 v68, v253, v248
    v_mfma_f32_16x16x32_bf16 v[120:123], v[224:227], a[248:251], v[120:123]
    v_fmac_f32 v69, v253, v249
    v_fmac_f32 v70, v253, v250
    v_mfma_f32_16x16x32_bf16 v[124:127], v[224:227], a[252:255], v[124:127]
    v_fmac_f32 v71, v253, v251
    v_mfma_f32_16x16x32_bf16 v[128:131], v[228:231], a[240:243], v[128:131]
    ds_read_b128 v[224:227], v1 offset:46080
    ds_read_b128 v[248:251], v30 offset:256
    v_mfma_f32_16x16x32_bf16 v[132:135], v[228:231], a[244:247], v[132:135]
    buffer_load_dwordx4 v[200:203], v26, s[8:11], s34 offen offset:2048 sc1
    s_waitcnt lgkmcnt(2)
    v_fmac_f32 v84, v253, v244
    v_mfma_f32_16x16x32_bf16 v[136:139], v[228:231], a[248:251], v[136:139]
    v_fmac_f32 v85, v253, v245
    v_fmac_f32 v86, v253, v246
    v_mfma_f32_16x16x32_bf16 v[140:143], v[228:231], a[252:255], v[140:143]
    s_waitcnt vmcnt(14)
    v_fmac_f32 v87, v253, v247
    v_mfma_f32_16x16x32_bf16 v[32:35], v[232:235], v[208:211], v[32:35]
    ds_read_b128 v[228:231], v1 offset:47104
    ds_read_b128 v[244:247], v30 offset:320
    v_mfma_f32_16x16x32_bf16 v[36:39], v[232:235], v[212:215], v[36:39]
    buffer_load_dwordx4 v[204:207], v27, s[8:11], s34 offen offset:2048 sc1
    s_waitcnt lgkmcnt(2)
    v_fmac_f32 v104, v254, v248
    v_mfma_f32_16x16x32_bf16 v[40:43], v[232:235], v[216:219], v[40:43]
    v_fmac_f32 v105, v254, v249
    v_fmac_f32 v106, v254, v250
    v_mfma_f32_16x16x32_bf16 v[44:47], v[232:235], v[220:223], v[44:47]
    v_fmac_f32 v107, v254, v251
    v_mfma_f32_16x16x32_bf16 v[48:51], v[236:239], v[208:211], v[48:51]
    ds_read_b128 v[232:235], v1 offset:48128
    ds_read_b128 v[248:251], v30 offset:384
    v_mfma_f32_16x16x32_bf16 v[52:55], v[236:239], v[212:215], v[52:55]
    buffer_load_dwordx4 a[224:227], v1, s[8:11], s34 offen offset:3072 sc1
    s_waitcnt lgkmcnt(2)
    v_fmac_f32 v120, v254, v244
    v_mfma_f32_16x16x32_bf16 v[56:59], v[236:239], v[216:219], v[56:59]
    v_fmac_f32 v121, v254, v245
    v_fmac_f32 v122, v254, v246
    v_mfma_f32_16x16x32_bf16 v[60:63], v[236:239], v[220:223], v[60:63]
    v_fmac_f32 v123, v254, v247
    v_mfma_f32_16x16x32_bf16 v[64:67], v[240:243], v[208:211], v[64:67]
    ds_read_b128 v[236:239], v1 offset:49152
    ds_read_b128 v[244:247], v30 offset:0
    v_mfma_f32_16x16x32_bf16 v[68:71], v[240:243], v[212:215], v[68:71]
    buffer_load_dwordx4 a[228:231], v25, s[8:11], s34 offen offset:3072 sc1
    s_waitcnt lgkmcnt(2)
    v_fmac_f32 v136, v254, v248
    v_mfma_f32_16x16x32_bf16 v[72:75], v[240:243], v[216:219], v[72:75]
    v_fmac_f32 v137, v254, v249
    v_fmac_f32 v138, v254, v250
    v_mfma_f32_16x16x32_bf16 v[76:79], v[240:243], v[220:223], v[76:79]
    v_fmac_f32 v139, v254, v251
    v_mfma_f32_16x16x32_bf16 v[80:83], v[224:227], v[208:211], v[80:83]
    ds_read_b128 v[240:243], v29 offset:0
    ds_read_b128 v[248:251], v30 offset:64
    v_mfma_f32_16x16x32_bf16 v[84:87], v[224:227], v[212:215], v[84:87]
    buffer_load_dwordx4 a[232:235], v26, s[8:11], s34 offen offset:3072 sc1
    s_waitcnt lgkmcnt(2)
    v_fmac_f32 v40, v254, v244
    v_mfma_f32_16x16x32_bf16 v[88:91], v[224:227], v[216:219], v[88:91]
    v_fmac_f32 v41, v254, v245
    v_fmac_f32 v42, v254, v246
    v_mfma_f32_16x16x32_bf16 v[92:95], v[224:227], v[220:223], v[92:95]
    v_fmac_f32 v43, v254, v247
    v_mfma_f32_16x16x32_bf16 v[96:99], v[228:231], v[208:211], v[96:99]
    ds_read_b128 v[224:227], v29 offset:1024
    ds_read_b128 v[244:247], v30 offset:128
    v_mfma_f32_16x16x32_bf16 v[100:103], v[228:231], v[212:215], v[100:103]
    buffer_load_dwordx4 a[236:239], v27, s[8:11], s34 offen offset:3072 sc1
    s_waitcnt lgkmcnt(2)
    v_fmac_f32 v56, v254, v248
    v_mfma_f32_16x16x32_bf16 v[104:107], v[228:231], v[216:219], v[104:107]
    v_fmac_f32 v57, v254, v249
    v_fmac_f32 v58, v254, v250
    v_mfma_f32_16x16x32_bf16 v[108:111], v[228:231], v[220:223], v[108:111]
    v_fmac_f32 v59, v254, v251
    v_mfma_f32_16x16x32_bf16 v[112:115], v[232:235], v[208:211], v[112:115]
    ds_read_b128 v[228:231], v29 offset:2048
    ds_read_b128 v[248:251], v30 offset:192
    v_mfma_f32_16x16x32_bf16 v[116:119], v[232:235], v[212:215], v[116:119]
    buffer_load_dwordx4 a[240:243], v1, s[8:11], s35 offen offset:0 sc1
    s_waitcnt lgkmcnt(2)
    v_fmac_f32 v72, v254, v244
    v_mfma_f32_16x16x32_bf16 v[120:123], v[232:235], v[216:219], v[120:123]
    v_fmac_f32 v73, v254, v245
    v_fmac_f32 v74, v254, v246
    v_mfma_f32_16x16x32_bf16 v[124:127], v[232:235], v[220:223], v[124:127]
    v_fmac_f32 v75, v254, v247
    v_mfma_f32_16x16x32_bf16 v[128:131], v[236:239], v[208:211], v[128:131]
    ds_read_b128 v[232:235], v29 offset:3072
    ds_read_b128 v[244:247], v30 offset:256
    v_mfma_f32_16x16x32_bf16 v[132:135], v[236:239], v[212:215], v[132:135]
    buffer_load_dwordx4 a[244:247], v25, s[8:11], s35 offen offset:0 sc1
    s_waitcnt lgkmcnt(2)
    v_fmac_f32 v88, v254, v248
    v_mfma_f32_16x16x32_bf16 v[136:139], v[236:239], v[216:219], v[136:139]
    v_fmac_f32 v89, v254, v249
    v_fmac_f32 v90, v254, v250
    v_mfma_f32_16x16x32_bf16 v[140:143], v[236:239], v[220:223], v[140:143]
    s_waitcnt vmcnt(18)
    v_fmac_f32 v91, v254, v251
    v_mfma_f32_16x16x32_bf16 v[32:35], v[240:243], v[144:147], v[32:35]
    ds_read_b128 v[236:239], v29 offset:4096
    ds_read_b128 v[248:251], v30 offset:320
    v_mfma_f32_16x16x32_bf16 v[36:39], v[240:243], v[148:151], v[36:39]
    buffer_load_dwordx4 a[248:251], v26, s[8:11], s35 offen offset:0 sc1
    s_waitcnt lgkmcnt(2)
    v_fmac_f32 v108, v255, v244
    v_mfma_f32_16x16x32_bf16 v[40:43], v[240:243], v[152:155], v[40:43]
    v_fmac_f32 v109, v255, v245
    v_fmac_f32 v110, v255, v246
    v_mfma_f32_16x16x32_bf16 v[44:47], v[240:243], v[156:159], v[44:47]
    v_fmac_f32 v111, v255, v247
    v_mfma_f32_16x16x32_bf16 v[48:51], v[224:227], v[144:147], v[48:51]
    ds_read_b128 v[240:243], v29 offset:5120
    ds_read_b128 v[244:247], v30 offset:384
    v_mfma_f32_16x16x32_bf16 v[52:55], v[224:227], v[148:151], v[52:55]
    buffer_load_dwordx4 a[252:255], v27, s[8:11], s35 offen offset:0 sc1
    s_waitcnt lgkmcnt(2)
    v_fmac_f32 v124, v255, v248
    v_mfma_f32_16x16x32_bf16 v[56:59], v[224:227], v[152:155], v[56:59]
    v_fmac_f32 v125, v255, v249
    v_fmac_f32 v126, v255, v250
    v_mfma_f32_16x16x32_bf16 v[60:63], v[224:227], v[156:159], v[60:63]
    v_fmac_f32 v127, v255, v251
    v_mfma_f32_16x16x32_bf16 v[64:67], v[228:231], v[144:147], v[64:67]
    ds_read_b128 v[224:227], v29 offset:6144
    ds_read_b128 v[248:251], v30 offset:0
    v_mfma_f32_16x16x32_bf16 v[68:71], v[228:231], v[148:151], v[68:71]
    buffer_load_dwordx4 v[208:211], v1, s[8:11], s35 offen offset:1024 sc1
    s_waitcnt lgkmcnt(2)
    v_fmac_f32 v140, v255, v244
    v_mfma_f32_16x16x32_bf16 v[72:75], v[228:231], v[152:155], v[72:75]
    v_fmac_f32 v141, v255, v245
    v_fmac_f32 v142, v255, v246
    v_mfma_f32_16x16x32_bf16 v[76:79], v[228:231], v[156:159], v[76:79]
    v_fmac_f32 v143, v255, v247
    v_mfma_f32_16x16x32_bf16 v[80:83], v[232:235], v[144:147], v[80:83]
    ds_read_b128 v[228:231], v29 offset:7168
    ds_read_b128 v[244:247], v30 offset:64
    v_mfma_f32_16x16x32_bf16 v[84:87], v[232:235], v[148:151], v[84:87]
    buffer_load_dwordx4 v[212:215], v25, s[8:11], s35 offen offset:1024 sc1
    s_waitcnt lgkmcnt(2)
    v_fmac_f32 v44, v255, v248
    v_mfma_f32_16x16x32_bf16 v[88:91], v[232:235], v[152:155], v[88:91]
    v_fmac_f32 v45, v255, v249
    v_fmac_f32 v46, v255, v250
    v_mfma_f32_16x16x32_bf16 v[92:95], v[232:235], v[156:159], v[92:95]
    v_fmac_f32 v47, v255, v251
    v_mfma_f32_16x16x32_bf16 v[96:99], v[236:239], v[144:147], v[96:99]
    ds_read_b128 v[232:235], v29 offset:8192
    ds_read_b128 v[248:251], v30 offset:128
    v_mfma_f32_16x16x32_bf16 v[100:103], v[236:239], v[148:151], v[100:103]
    buffer_load_dwordx4 v[216:219], v26, s[8:11], s35 offen offset:1024 sc1
    s_waitcnt lgkmcnt(2)
    v_fmac_f32 v60, v255, v244
    v_mfma_f32_16x16x32_bf16 v[104:107], v[236:239], v[152:155], v[104:107]
    v_fmac_f32 v61, v255, v245
    v_fmac_f32 v62, v255, v246
    v_mfma_f32_16x16x32_bf16 v[108:111], v[236:239], v[156:159], v[108:111]
    v_fmac_f32 v63, v255, v247
    v_mfma_f32_16x16x32_bf16 v[112:115], v[240:243], v[144:147], v[112:115]
    ds_read_b128 v[236:239], v29 offset:9216
    ds_read_b128 v[244:247], v30 offset:192
    v_mfma_f32_16x16x32_bf16 v[116:119], v[240:243], v[148:151], v[116:119]
    buffer_load_dwordx4 v[220:223], v27, s[8:11], s35 offen offset:1024 sc1
    s_waitcnt lgkmcnt(2)
    v_fmac_f32 v76, v255, v248
    v_mfma_f32_16x16x32_bf16 v[120:123], v[240:243], v[152:155], v[120:123]
    v_fmac_f32 v77, v255, v249
    v_fmac_f32 v78, v255, v250
    v_mfma_f32_16x16x32_bf16 v[124:127], v[240:243], v[156:159], v[124:127]
    v_fmac_f32 v79, v255, v251
    v_mfma_f32_16x16x32_bf16 v[128:131], v[224:227], v[144:147], v[128:131]
    ds_read_b128 v[240:243], v29 offset:10240
    ds_read_b128 v[248:251], v30 offset:256
    v_mfma_f32_16x16x32_bf16 v[132:135], v[224:227], v[148:151], v[132:135]
    s_waitcnt lgkmcnt(2)
    v_fmac_f32 v92, v255, v244
    v_fmac_f32 v93, v255, v245
    v_mfma_f32_16x16x32_bf16 v[136:139], v[224:227], v[152:155], v[136:139]
    v_fmac_f32 v94, v255, v246
    v_fmac_f32 v95, v255, v247
    v_mfma_f32_16x16x32_bf16 v[140:143], v[224:227], v[156:159], v[140:143]
    s_waitcnt vmcnt(20)
    v_mfma_f32_16x16x32_bf16 v[32:35], v[228:231], v[160:163], v[32:35]
    s_add_u32 s52, s3, 1
    ds_read_b128 v[224:227], v29 offset:11264
    s_and_b32 s52, s52, 3
    s_mul_i32 s55, s52, 57344
    v_mfma_f32_16x16x32_bf16 v[36:39], v[228:231], v[164:167], v[36:39]
    v_add_u32 v25, s55, v1
    s_mul_i32 s55, s52, 12288
    s_add_u32 s44, s55, 116736
    v_mfma_f32_16x16x32_bf16 v[40:43], v[228:231], v[168:171], v[40:43]
    s_add_u32 s52, s3, 2
    s_and_b32 s52, s52, 3
    s_mul_i32 s55, s52, 57344
    v_add_u32 v26, s55, v1
    v_mfma_f32_16x16x32_bf16 v[44:47], v[228:231], v[172:175], v[44:47]
    s_waitcnt vmcnt(16)
    s_mul_i32 s55, s52, 12288
    s_add_u32 s45, s55, 112640
    s_add_u32 s52, s3, 3
    v_mfma_f32_16x16x32_bf16 v[32:35], v[232:235], v[176:179], v[32:35]
    s_and_b32 s52, s52, 3
    ds_read_b128 v[228:231], v29 offset:12288
    s_mul_i32 s55, s52, 57344
    v_add_u32 v27, s55, v1
    v_mfma_f32_16x16x32_bf16 v[36:39], v[232:235], v[180:183], v[36:39]
    s_mul_i32 s55, s52, 12288
    s_add_u32 s46, s55, 108544
    s_add_u32 s52, s3, 4
    s_and_b32 s52, s52, 3
    v_mfma_f32_16x16x32_bf16 v[40:43], v[232:235], v[184:187], v[40:43]
    s_mul_i32 s55, s52, 57344
    v_add_u32 v244, s55, v1
    v_mfma_f32_16x16x32_bf16 v[44:47], v[232:235], v[188:191], v[44:47]
    s_waitcnt vmcnt(12)
    v_mfma_f32_16x16x32_bf16 v[32:35], v[236:239], v[192:195], v[32:35]
    ds_read_b128 v[232:235], v29 offset:13312
    v_mfma_f32_16x16x32_bf16 v[36:39], v[236:239], v[196:199], v[36:39]
    v_mfma_f32_16x16x32_bf16 v[40:43], v[236:239], v[200:203], v[40:43]
    v_mfma_f32_16x16x32_bf16 v[44:47], v[236:239], v[204:207], v[44:47]
    s_waitcnt vmcnt(8) lgkmcnt(4)
    v_mfma_f32_16x16x32_bf16 v[32:35], v[240:243], a[224:227], v[32:35]
    ds_read_b128 v[236:239], v29 offset:14336
    v_mfma_f32_16x16x32_bf16 v[36:39], v[240:243], a[228:231], v[36:39]
    v_mfma_f32_16x16x32_bf16 v[40:43], v[240:243], a[232:235], v[40:43]
    v_mfma_f32_16x16x32_bf16 v[44:47], v[240:243], a[236:239], v[44:47]
    s_waitcnt vmcnt(4) lgkmcnt(3)
    v_mfma_f32_16x16x32_bf16 v[32:35], v[224:227], a[240:243], v[32:35]
    ds_read_b128 v[240:243], v29 offset:15360
    v_mfma_f32_16x16x32_bf16 v[36:39], v[224:227], a[244:247], v[36:39]
    v_mfma_f32_16x16x32_bf16 v[40:43], v[224:227], a[248:251], v[40:43]
    v_mfma_f32_16x16x32_bf16 v[44:47], v[224:227], a[252:255], v[44:47]
    s_waitcnt vmcnt(0) lgkmcnt(3)
    v_mfma_f32_16x16x32_bf16 v[32:35], v[228:231], v[208:211], v[32:35]
    ds_read_b128 v[224:227], v29 offset:16384
    v_mfma_f32_16x16x32_bf16 v[36:39], v[228:231], v[212:215], v[36:39]
    v_mfma_f32_16x16x32_bf16 v[40:43], v[228:231], v[216:219], v[40:43]
    v_mfma_f32_16x16x32_bf16 v[44:47], v[228:231], v[220:223], v[44:47]
    s_waitcnt lgkmcnt(3)
    s_nop 2
    v_mul_f32 v144, v32, v16
    v_mul_f32 v145, v33, v16
    v_mul_f32 v146, v36, v18
    v_mfma_f32_16x16x32_bf16 v[48:51], v[232:235], v[160:163], v[48:51]
    ds_read_b128 v[228:231], v29 offset:17408
    v_mul_f32 v147, v37, v18
    v_mul_f32 v148, v40, v20
    v_mfma_f32_16x16x32_bf16 v[52:55], v[232:235], v[164:167], v[52:55]
    v_mul_f32 v149, v41, v20
    v_mul_f32 v150, v44, v22
    v_mul_f32 v151, v45, v22
    v_mfma_f32_16x16x32_bf16 v[56:59], v[232:235], v[168:171], v[56:59]
    v_exp_f32 v144, v144
    v_mul_f32 v32, v32, v34
    v_mfma_f32_16x16x32_bf16 v[60:63], v[232:235], v[172:175], v[60:63]
    s_waitcnt lgkmcnt(3)
    v_exp_f32 v145, v145
    v_mul_f32 v33, v33, v35
    v_mfma_f32_16x16x32_bf16 v[48:51], v[236:239], v[176:179], v[48:51]
    ds_read_b128 v[232:235], v29 offset:18432
    v_exp_f32 v146, v146
    v_mfma_f32_16x16x32_bf16 v[52:55], v[236:239], v[180:183], v[52:55]
    v_mul_f32 v36, v36, v38
    v_exp_f32 v147, v147
    v_mfma_f32_16x16x32_bf16 v[56:59], v[236:239], v[184:187], v[56:59]
    v_mul_f32 v37, v37, v39
    v_exp_f32 v148, v148
    v_mfma_f32_16x16x32_bf16 v[60:63], v[236:239], v[188:191], v[60:63]
    s_waitcnt lgkmcnt(3)
    v_mul_f32 v40, v40, v42
    v_exp_f32 v149, v149
    v_mfma_f32_16x16x32_bf16 v[48:51], v[240:243], v[192:195], v[48:51]
    ds_read_b128 v[236:239], v29 offset:19456
    v_mul_f32 v41, v41, v43
    v_mfma_f32_16x16x32_bf16 v[52:55], v[240:243], v[196:199], v[52:55]
    v_exp_f32 v150, v150
    v_mul_f32 v44, v44, v46
    v_mfma_f32_16x16x32_bf16 v[56:59], v[240:243], v[200:203], v[56:59]
    v_exp_f32 v151, v151
    v_mul_f32 v45, v45, v47
    v_mfma_f32_16x16x32_bf16 v[60:63], v[240:243], v[204:207], v[60:63]
    s_waitcnt lgkmcnt(3)
    v_fma_f32 v144, v144, v17, v17
    v_fma_f32 v145, v145, v17, v17
    v_fma_f32 v146, v146, v19, v19
    v_mfma_f32_16x16x32_bf16 v[48:51], v[224:227], a[224:227], v[48:51]
    ds_read_b128 v[240:243], v29 offset:20480
    v_fma_f32 v147, v147, v19, v19
    v_fma_f32 v148, v148, v21, v21
    v_mfma_f32_16x16x32_bf16 v[52:55], v[224:227], a[228:231], v[52:55]
    v_fma_f32 v149, v149, v21, v21
    v_fma_f32 v150, v150, v23, v23
    v_fma_f32 v151, v151, v23, v23
    v_mfma_f32_16x16x32_bf16 v[56:59], v[224:227], a[232:235], v[56:59]
    v_rcp_f32 v144, v144
    v_mfma_f32_16x16x32_bf16 v[60:63], v[224:227], a[236:239], v[60:63]
    s_waitcnt lgkmcnt(3)
    v_rcp_f32 v145, v145
    v_mul_f32 v32, v32, v144
    v_mfma_f32_16x16x32_bf16 v[48:51], v[228:231], a[240:243], v[48:51]
    ds_read_b128 v[224:227], v29 offset:21504
    v_rcp_f32 v146, v146
    v_mfma_f32_16x16x32_bf16 v[52:55], v[228:231], a[244:247], v[52:55]
    v_mul_f32 v33, v33, v145
    v_rcp_f32 v147, v147
    v_mfma_f32_16x16x32_bf16 v[56:59], v[228:231], a[248:251], v[56:59]
    v_mul_f32 v36, v36, v146
    v_rcp_f32 v148, v148
    v_mfma_f32_16x16x32_bf16 v[60:63], v[228:231], a[252:255], v[60:63]
    s_waitcnt lgkmcnt(3)
    v_mul_f32 v37, v37, v147
    v_rcp_f32 v149, v149
    v_mfma_f32_16x16x32_bf16 v[48:51], v[232:235], v[208:211], v[48:51]
    ds_read_b128 v[228:231], v29 offset:22528
    v_mul_f32 v40, v40, v148
    v_mfma_f32_16x16x32_bf16 v[52:55], v[232:235], v[212:215], v[52:55]
    v_rcp_f32 v150, v150
    v_mul_f32 v41, v41, v149
    v_mfma_f32_16x16x32_bf16 v[56:59], v[232:235], v[216:219], v[56:59]
    v_rcp_f32 v151, v151
    v_mul_f32 v44, v44, v150
    v_mfma_f32_16x16x32_bf16 v[60:63], v[232:235], v[220:223], v[60:63]
    s_waitcnt lgkmcnt(3)
    v_cvt_pk_bf16_f32 v152, v32, v33
    v_cvt_pk_bf16_f32 v154, v40, v41
    v_mul_f32 v45, v45, v151
    v_mfma_f32_16x16x32_bf16 v[64:67], v[236:239], v[160:163], v[64:67]
    ds_read_b128 v[232:235], v29 offset:23552
    v_cvt_pk_bf16_f32 v153, v36, v37
    v_cvt_pk_bf16_f32 v155, v44, v45
    v_mfma_f32_16x16x32_bf16 v[68:71], v[236:239], v[164:167], v[68:71]
    v_permlane32_swap_b32 v152, v154
    v_mfma_f32_16x16x32_bf16 v[72:75], v[236:239], v[168:171], v[72:75]
    v_permlane32_swap_b32 v153, v155
    s_add_u32 s91, s81, 0
    v_mfma_f32_16x16x32_bf16 v[76:79], v[236:239], v[172:175], v[76:79]
    s_waitcnt lgkmcnt(3)
    v_permlane16_swap_b32 v152, v153
    v_mfma_f32_16x16x32_bf16 v[64:67], v[240:243], v[176:179], v[64:67]
    ds_read_b128 v[236:239], v29 offset:24576
    v_permlane16_swap_b32 v154, v155
    v_mfma_f32_16x16x32_bf16 v[68:71], v[240:243], v[180:183], v[68:71]
    buffer_store_dwordx4 v[152:155], v28, s[8:11], s91 offen nt
    v_mul_f32 v144, v48, v16
    v_mul_f32 v145, v49, v16
    v_mfma_f32_16x16x32_bf16 v[72:75], v[240:243], v[184:187], v[72:75]
    v_mul_f32 v146, v52, v18
    v_mul_f32 v147, v53, v18
    v_mul_f32 v148, v56, v20
    v_mfma_f32_16x16x32_bf16 v[76:79], v[240:243], v[188:191], v[76:79]
    s_waitcnt lgkmcnt(3)
    v_mul_f32 v149, v57, v20
    v_mul_f32 v150, v60, v22
    v_mul_f32 v151, v61, v22
    v_mfma_f32_16x16x32_bf16 v[64:67], v[224:227], v[192:195], v[64:67]
    ds_read_b128 v[240:243], v29 offset:25600
    v_exp_f32 v144, v144
    v_mfma_f32_16x16x32_bf16 v[68:71], v[224:227], v[196:199], v[68:71]
    v_mul_f32 v48, v48, v50
    v_exp_f32 v145, v145
    v_mfma_f32_16x16x32_bf16 v[72:75], v[224:227], v[200:203], v[72:75]
    v_mul_f32 v49, v49, v51
    v_exp_f32 v146, v146
    v_mfma_f32_16x16x32_bf16 v[76:79], v[224:227], v[204:207], v[76:79]
    s_waitcnt lgkmcnt(3)
    v_mul_f32 v52, v52, v54
    v_exp_f32 v147, v147
    v_mfma_f32_16x16x32_bf16 v[64:67], v[228:231], a[224:227], v[64:67]
    ds_read_b128 v[224:227], v29 offset:26624
    v_mul_f32 v53, v53, v55
    v_mfma_f32_16x16x32_bf16 v[68:71], v[228:231], a[228:231], v[68:71]
    v_exp_f32 v148, v148
    v_mul_f32 v56, v56, v58
    v_mfma_f32_16x16x32_bf16 v[72:75], v[228:231], a[232:235], v[72:75]
    v_exp_f32 v149, v149
    v_mul_f32 v57, v57, v59
    v_mfma_f32_16x16x32_bf16 v[76:79], v[228:231], a[236:239], v[76:79]
    s_waitcnt lgkmcnt(3)
    v_exp_f32 v150, v150
    v_mul_f32 v60, v60, v62
    v_mfma_f32_16x16x32_bf16 v[64:67], v[232:235], a[240:243], v[64:67]
    ds_read_b128 v[228:231], v29 offset:27648
    v_exp_f32 v151, v151
    v_mfma_f32_16x16x32_bf16 v[68:71], v[232:235], a[244:247], v[68:71]
    v_mul_f32 v61, v61, v63
    v_fma_f32 v144, v144, v17, v17
    v_fma_f32 v145, v145, v17, v17
    v_mfma_f32_16x16x32_bf16 v[72:75], v[232:235], a[248:251], v[72:75]
    v_fma_f32 v146, v146, v19, v19
    v_fma_f32 v147, v147, v19, v19
    v_fma_f32 v148, v148, v21, v21
    v_mfma_f32_16x16x32_bf16 v[76:79], v[232:235], a[252:255], v[76:79]
    s_waitcnt lgkmcnt(3)
    v_fma_f32 v149, v149, v21, v21
    v_fma_f32 v150, v150, v23, v23
    v_fma_f32 v151, v151, v23, v23
    v_mfma_f32_16x16x32_bf16 v[64:67], v[236:239], v[208:211], v[64:67]
    ds_read_b128 v[232:235], v29 offset:28672
    v_rcp_f32 v144, v144
    v_mfma_f32_16x16x32_bf16 v[68:71], v[236:239], v[212:215], v[68:71]
    v_rcp_f32 v145, v145
    v_mul_f32 v48, v48, v144
    v_mfma_f32_16x16x32_bf16 v[72:75], v[236:239], v[216:219], v[72:75]
    v_rcp_f32 v146, v146
    v_mul_f32 v49, v49, v145
    v_mfma_f32_16x16x32_bf16 v[76:79], v[236:239], v[220:223], v[76:79]
    s_waitcnt lgkmcnt(3)
    v_rcp_f32 v147, v147
    v_mul_f32 v52, v52, v146
    v_mfma_f32_16x16x32_bf16 v[80:83], v[240:243], v[160:163], v[80:83]
    ds_read_b128 v[236:239], v29 offset:29696
    v_mov_b32 v31, 1
    s_waitcnt vmcnt(0)
    v_mfma_f32_16x16x32_bf16 v[84:87], v[240:243], v[164:167], v[84:87]
    buffer_store_dword v31, v5, s[8:11], s82 offen
    v_rcp_f32 v148, v148
    v_mfma_f32_16x16x32_bf16 v[88:91], v[240:243], v[168:171], v[88:91]
    v_mul_f32 v53, v53, v147
    v_rcp_f32 v149, v149
    v_mfma_f32_16x16x32_bf16 v[92:95], v[240:243], v[172:175], v[92:95]
    s_waitcnt lgkmcnt(3)
    v_mul_f32 v56, v56, v148
    v_rcp_f32 v150, v150
    v_mfma_f32_16x16x32_bf16 v[80:83], v[224:227], v[176:179], v[80:83]
    ds_read_b128 v[240:243], v29 offset:30720
    v_mul_f32 v57, v57, v149
    v_mfma_f32_16x16x32_bf16 v[84:87], v[224:227], v[180:183], v[84:87]
    v_rcp_f32 v151, v151
    v_mul_f32 v60, v60, v150
    v_mfma_f32_16x16x32_bf16 v[88:91], v[224:227], v[184:187], v[88:91]
    v_cvt_pk_bf16_f32 v156, v48, v49
    v_cvt_pk_bf16_f32 v158, v56, v57
    v_mul_f32 v61, v61, v151
    v_mfma_f32_16x16x32_bf16 v[92:95], v[224:227], v[188:191], v[92:95]
    s_waitcnt lgkmcnt(3)
    v_cvt_pk_bf16_f32 v157, v52, v53
    v_cvt_pk_bf16_f32 v159, v60, v61
    v_mfma_f32_16x16x32_bf16 v[80:83], v[228:231], v[192:195], v[80:83]
    ds_read_b128 v[224:227], v29 offset:31744
    v_permlane32_swap_b32 v156, v158
    v_mfma_f32_16x16x32_bf16 v[84:87], v[228:231], v[196:199], v[84:87]
    v_permlane32_swap_b32 v157, v159
    s_add_u32 s91, s81, 8192
    v_mfma_f32_16x16x32_bf16 v[88:91], v[228:231], v[200:203], v[88:91]
    v_permlane16_swap_b32 v156, v157
    v_mfma_f32_16x16x32_bf16 v[92:95], v[228:231], v[204:207], v[92:95]
    s_waitcnt lgkmcnt(3)
    v_permlane16_swap_b32 v158, v159
    buffer_store_dwordx4 v[156:159], v28, s[8:11], s91 offen nt
    v_mfma_f32_16x16x32_bf16 v[80:83], v[232:235], a[224:227], v[80:83]
    ds_read_b128 v[228:231], v29 offset:32768
    v_mul_f32 v144, v64, v16
    v_mul_f32 v145, v65, v16
    v_mfma_f32_16x16x32_bf16 v[84:87], v[232:235], a[228:231], v[84:87]
    v_mul_f32 v146, v68, v18
    v_mul_f32 v147, v69, v18
    v_mul_f32 v148, v72, v20
    v_mfma_f32_16x16x32_bf16 v[88:91], v[232:235], a[232:235], v[88:91]
    v_mul_f32 v149, v73, v20
    v_mul_f32 v150, v76, v22
    v_mul_f32 v151, v77, v22
    v_mfma_f32_16x16x32_bf16 v[92:95], v[232:235], a[236:239], v[92:95]
    s_waitcnt lgkmcnt(3)
    v_exp_f32 v144, v144
    v_mul_f32 v64, v64, v66
    v_mfma_f32_16x16x32_bf16 v[80:83], v[236:239], a[240:243], v[80:83]
    ds_read_b128 v[232:235], v29 offset:33792
    v_exp_f32 v145, v145
    v_mfma_f32_16x16x32_bf16 v[84:87], v[236:239], a[244:247], v[84:87]
    v_mul_f32 v65, v65, v67
    v_exp_f32 v146, v146
    v_mfma_f32_16x16x32_bf16 v[88:91], v[236:239], a[248:251], v[88:91]
    v_mul_f32 v68, v68, v70
    v_exp_f32 v147, v147
    v_mfma_f32_16x16x32_bf16 v[92:95], v[236:239], a[252:255], v[92:95]
    s_waitcnt lgkmcnt(3)
    v_mul_f32 v69, v69, v71
    v_exp_f32 v148, v148
    v_mfma_f32_16x16x32_bf16 v[80:83], v[240:243], v[208:211], v[80:83]
    ds_read_b128 v[236:239], v29 offset:34816
    v_mul_f32 v72, v72, v74
    v_mfma_f32_16x16x32_bf16 v[84:87], v[240:243], v[212:215], v[84:87]
    v_exp_f32 v149, v149
    v_mul_f32 v73, v73, v75
    v_mfma_f32_16x16x32_bf16 v[88:91], v[240:243], v[216:219], v[88:91]
    v_exp_f32 v150, v150
    v_mul_f32 v76, v76, v78
    v_mfma_f32_16x16x32_bf16 v[92:95], v[240:243], v[220:223], v[92:95]
    s_waitcnt lgkmcnt(3)
    v_exp_f32 v151, v151
    v_mul_f32 v77, v77, v79
    v_mfma_f32_16x16x32_bf16 v[96:99], v[224:227], v[160:163], v[96:99]
    ds_read_b128 v[240:243], v29 offset:35840
    v_fma_f32 v144, v144, v17, v17
    v_fma_f32 v145, v145, v17, v17
    v_mfma_f32_16x16x32_bf16 v[100:103], v[224:227], v[164:167], v[100:103]
    v_fma_f32 v146, v146, v19, v19
    v_fma_f32 v147, v147, v19, v19
    v_fma_f32 v148, v148, v21, v21
    v_mfma_f32_16x16x32_bf16 v[104:107], v[224:227], v[168:171], v[104:107]
    v_fma_f32 v149, v149, v21, v21
    v_fma_f32 v150, v150, v23, v23
    v_fma_f32 v151, v151, v23, v23
    v_mfma_f32_16x16x32_bf16 v[108:111], v[224:227], v[172:175], v[108:111]
    s_waitcnt lgkmcnt(3)
    v_rcp_f32 v144, v144
    v_mfma_f32_16x16x32_bf16 v[96:99], v[228:231], v[176:179], v[96:99]
    ds_read_b128 v[224:227], v29 offset:36864
    v_rcp_f32 v145, v145
    v_mfma_f32_16x16x32_bf16 v[100:103], v[228:231], v[180:183], v[100:103]
    v_mul_f32 v64, v64, v144
    v_rcp_f32 v146, v146
    v_mfma_f32_16x16x32_bf16 v[104:107], v[228:231], v[184:187], v[104:107]
    v_mul_f32 v65, v65, v145
    v_rcp_f32 v147, v147
    v_mfma_f32_16x16x32_bf16 v[108:111], v[228:231], v[188:191], v[108:111]
    s_waitcnt lgkmcnt(3)
    v_mul_f32 v68, v68, v146
    v_mov_b32 v31, 2
    s_waitcnt vmcnt(0)
    v_mfma_f32_16x16x32_bf16 v[96:99], v[232:235], v[192:195], v[96:99]
    ds_read_b128 v[228:231], v29 offset:37888
    buffer_store_dword v31, v5, s[8:11], s82 offen
    v_mfma_f32_16x16x32_bf16 v[100:103], v[232:235], v[196:199], v[100:103]
    v_rcp_f32 v148, v148
    v_mul_f32 v69, v69, v147
    v_mfma_f32_16x16x32_bf16 v[104:107], v[232:235], v[200:203], v[104:107]
    v_rcp_f32 v149, v149
    v_mul_f32 v72, v72, v148
    v_mfma_f32_16x16x32_bf16 v[108:111], v[232:235], v[204:207], v[108:111]
    s_waitcnt lgkmcnt(3)
    v_rcp_f32 v150, v150
    v_mul_f32 v73, v73, v149
    v_mfma_f32_16x16x32_bf16 v[96:99], v[236:239], a[224:227], v[96:99]
    ds_read_b128 v[232:235], v29 offset:38912
    buffer_load_dword v30, v24, s[8:11], s79 offen sc1
    v_mfma_f32_16x16x32_bf16 v[100:103], v[236:239], a[228:231], v[100:103]
    v_rcp_f32 v151, v151
    v_mul_f32 v76, v76, v150
    v_mfma_f32_16x16x32_bf16 v[104:107], v[236:239], a[232:235], v[104:107]
    v_cvt_pk_bf16_f32 v152, v64, v65
    v_cvt_pk_bf16_f32 v154, v72, v73
    v_mul_f32 v77, v77, v151
    v_mfma_f32_16x16x32_bf16 v[108:111], v[236:239], a[236:239], v[108:111]
    s_waitcnt lgkmcnt(3)
    v_cvt_pk_bf16_f32 v153, v68, v69
    v_cvt_pk_bf16_f32 v155, v76, v77
    v_mfma_f32_16x16x32_bf16 v[96:99], v[240:243], a[240:243], v[96:99]
    ds_read_b128 v[236:239], v29 offset:39936
    v_permlane32_swap_b32 v152, v154
    v_mfma_f32_16x16x32_bf16 v[100:103], v[240:243], a[244:247], v[100:103]
    v_permlane32_swap_b32 v153, v155
    s_add_u32 s91, s81, 16384
    v_mfma_f32_16x16x32_bf16 v[104:107], v[240:243], a[248:251], v[104:107]
    v_permlane16_swap_b32 v152, v153
    v_mfma_f32_16x16x32_bf16 v[108:111], v[240:243], a[252:255], v[108:111]
    s_waitcnt lgkmcnt(3)
    v_permlane16_swap_b32 v154, v155
    buffer_store_dwordx4 v[152:155], v28, s[8:11], s91 offen nt
    v_mfma_f32_16x16x32_bf16 v[96:99], v[224:227], v[208:211], v[96:99]
    ds_read_b128 v[240:243], v29 offset:40960
    v_mul_f32 v144, v80, v16
    v_mul_f32 v145, v81, v16
    v_mfma_f32_16x16x32_bf16 v[100:103], v[224:227], v[212:215], v[100:103]
    v_mul_f32 v146, v84, v18
    v_mul_f32 v147, v85, v18
    v_mul_f32 v148, v88, v20
    v_mfma_f32_16x16x32_bf16 v[104:107], v[224:227], v[216:219], v[104:107]
    v_mul_f32 v149, v89, v20
    v_mul_f32 v150, v92, v22
    v_mul_f32 v151, v93, v22
    v_mfma_f32_16x16x32_bf16 v[108:111], v[224:227], v[220:223], v[108:111]
    s_waitcnt lgkmcnt(3)
    v_exp_f32 v144, v144
    v_mul_f32 v80, v80, v82
    v_mfma_f32_16x16x32_bf16 v[112:115], v[228:231], v[160:163], v[112:115]
    ds_read_b128 v[224:227], v29 offset:41984
    v_exp_f32 v145, v145
    v_mfma_f32_16x16x32_bf16 v[116:119], v[228:231], v[164:167], v[116:119]
    v_mul_f32 v81, v81, v83
    v_exp_f32 v146, v146
    v_mfma_f32_16x16x32_bf16 v[120:123], v[228:231], v[168:171], v[120:123]
    v_mul_f32 v84, v84, v86
    v_exp_f32 v147, v147
    v_mfma_f32_16x16x32_bf16 v[124:127], v[228:231], v[172:175], v[124:127]
    s_waitcnt lgkmcnt(3)
    v_mul_f32 v85, v85, v87
    v_exp_f32 v148, v148
    v_mfma_f32_16x16x32_bf16 v[112:115], v[232:235], v[176:179], v[112:115]
    ds_read_b128 v[228:231], v29 offset:43008
    v_mul_f32 v88, v88, v90
    v_mfma_f32_16x16x32_bf16 v[116:119], v[232:235], v[180:183], v[116:119]
    v_exp_f32 v149, v149
    v_mul_f32 v89, v89, v91
    v_mfma_f32_16x16x32_bf16 v[120:123], v[232:235], v[184:187], v[120:123]
    v_exp_f32 v150, v150
    v_mul_f32 v92, v92, v94
    v_mfma_f32_16x16x32_bf16 v[124:127], v[232:235], v[188:191], v[124:127]
    s_waitcnt lgkmcnt(3)
    v_exp_f32 v151, v151
    v_mul_f32 v93, v93, v95
    v_mfma_f32_16x16x32_bf16 v[112:115], v[236:239], v[192:195], v[112:115]
    ds_read_b128 v[232:235], v29 offset:44032
    v_fma_f32 v144, v144, v17, v17
    v_fma_f32 v145, v145, v17, v17
    v_mfma_f32_16x16x32_bf16 v[116:119], v[236:239], v[196:199], v[116:119]
    v_fma_f32 v146, v146, v19, v19
    v_fma_f32 v147, v147, v19, v19
    v_fma_f32 v148, v148, v21, v21
    v_mfma_f32_16x16x32_bf16 v[120:123], v[236:239], v[200:203], v[120:123]
    v_fma_f32 v149, v149, v21, v21
    v_fma_f32 v150, v150, v23, v23
    v_fma_f32 v151, v151, v23, v23
    v_mfma_f32_16x16x32_bf16 v[124:127], v[236:239], v[204:207], v[124:127]
    s_waitcnt lgkmcnt(3)
    v_rcp_f32 v144, v144
    v_mfma_f32_16x16x32_bf16 v[112:115], v[240:243], a[224:227], v[112:115]
    ds_read_b128 v[236:239], v29 offset:45056
    v_rcp_f32 v145, v145
    v_mfma_f32_16x16x32_bf16 v[116:119], v[240:243], a[228:231], v[116:119]
    v_mul_f32 v80, v80, v144
    v_rcp_f32 v146, v146
    v_mfma_f32_16x16x32_bf16 v[120:123], v[240:243], a[232:235], v[120:123]
    v_mul_f32 v81, v81, v145
    v_rcp_f32 v147, v147
    v_mfma_f32_16x16x32_bf16 v[124:127], v[240:243], a[236:239], v[124:127]
    s_waitcnt lgkmcnt(3)
    v_mul_f32 v84, v84, v146
    v_mov_b32 v31, 3
    s_waitcnt vmcnt(0)
    v_cmp_gt_u32 vcc, 1, v30
    s_nop 0
    s_cbranch_vccnz poll13
poll13_ok:
    v_mfma_f32_16x16x32_bf16 v[112:115], v[224:227], a[240:243], v[112:115]
    ds_read_b128 v[240:243], v29 offset:46080
    buffer_store_dword v31, v5, s[8:11], s82 offen
    v_mfma_f32_16x16x32_bf16 v[116:119], v[224:227], a[244:247], v[116:119]
    buffer_load_dwordx4 v[32:35], v25, s[8:11], s36 offen offset:0 sc1
    v_rcp_f32 v148, v148
    v_mfma_f32_16x16x32_bf16 v[120:123], v[224:227], a[248:251], v[120:123]
    v_mul_f32 v85, v85, v147
    v_rcp_f32 v149, v149
    v_mfma_f32_16x16x32_bf16 v[124:127], v[224:227], a[252:255], v[124:127]
    s_waitcnt lgkmcnt(3)
    v_mul_f32 v88, v88, v148
    v_rcp_f32 v150, v150
    v_mfma_f32_16x16x32_bf16 v[112:115], v[228:231], v[208:211], v[112:115]
    ds_read_b128 v[224:227], v29 offset:47104
    buffer_load_dwordx4 v[36:39], v26, s[8:11], s36 offen offset:0 sc1
    v_mul_f32 v89, v89, v149
    v_mfma_f32_16x16x32_bf16 v[116:119], v[228:231], v[212:215], v[116:119]
    buffer_load_dword v30, v24, s[8:11], s79 offen sc1
    v_rcp_f32 v151, v151
    v_mfma_f32_16x16x32_bf16 v[120:123], v[228:231], v[216:219], v[120:123]
    v_mul_f32 v92, v92, v150
    v_cvt_pk_bf16_f32 v156, v80, v81
    v_cvt_pk_bf16_f32 v158, v88, v89
    v_mfma_f32_16x16x32_bf16 v[124:127], v[228:231], v[220:223], v[124:127]
    s_waitcnt lgkmcnt(3)
    buffer_load_dwordx4 v[40:43], v27, s[8:11], s36 offen offset:0 sc1
    v_mul_f32 v93, v93, v151
    v_cvt_pk_bf16_f32 v157, v84, v85
    v_mfma_f32_16x16x32_bf16 v[128:131], v[232:235], v[160:163], v[128:131]
    ds_read_b128 v[228:231], v29 offset:48128
    v_cvt_pk_bf16_f32 v159, v92, v93
    v_mfma_f32_16x16x32_bf16 v[132:135], v[232:235], v[164:167], v[132:135]
    v_permlane32_swap_b32 v156, v158
    v_mfma_f32_16x16x32_bf16 v[136:139], v[232:235], v[168:171], v[136:139]
    buffer_load_dwordx4 v[44:47], v244, s[8:11], s36 offen offset:0 sc1
    v_permlane32_swap_b32 v157, v159
    v_mfma_f32_16x16x32_bf16 v[140:143], v[232:235], v[172:175], v[140:143]
    s_waitcnt lgkmcnt(3)
    s_add_u32 s91, s81, 24576
    v_permlane16_swap_b32 v156, v157
    v_mfma_f32_16x16x32_bf16 v[128:131], v[236:239], v[176:179], v[128:131]
    ds_read_b128 v[232:235], v29 offset:49152
    v_permlane16_swap_b32 v158, v159
    v_mfma_f32_16x16x32_bf16 v[132:135], v[236:239], v[180:183], v[132:135]
    buffer_load_dwordx4 v[48:51], v25, s[8:11], s36 offen offset:1024 sc1
    buffer_store_dwordx4 v[156:159], v28, s[8:11], s91 offen nt
    v_mul_f32 v144, v96, v16
    v_mfma_f32_16x16x32_bf16 v[136:139], v[236:239], v[184:187], v[136:139]
    v_mul_f32 v145, v97, v16
    v_mul_f32 v146, v100, v18
    v_mul_f32 v147, v101, v18
    v_mfma_f32_16x16x32_bf16 v[140:143], v[236:239], v[188:191], v[140:143]
    s_waitcnt lgkmcnt(3)
    v_mul_f32 v148, v104, v20
    v_mul_f32 v149, v105, v20
    v_mul_f32 v150, v108, v22
    v_mfma_f32_16x16x32_bf16 v[128:131], v[240:243], v[192:195], v[128:131]
    buffer_load_dwordx4 v[52:55], v26, s[8:11], s36 offen offset:1024 sc1
    v_mul_f32 v151, v109, v22
    v_mfma_f32_16x16x32_bf16 v[132:135], v[240:243], v[196:199], v[132:135]
    v_exp_f32 v144, v144
    v_mul_f32 v96, v96, v98
    v_mfma_f32_16x16x32_bf16 v[136:139], v[240:243], v[200:203], v[136:139]
    v_exp_f32 v145, v145
    v_mul_f32 v97, v97, v99
    v_mfma_f32_16x16x32_bf16 v[140:143], v[240:243], v[204:207], v[140:143]
    s_waitcnt lgkmcnt(2)
    buffer_load_dwordx4 v[56:59], v27, s[8:11], s36 offen offset:1024 sc1
    v_exp_f32 v146, v146
    v_mfma_f32_16x16x32_bf16 v[128:131], v[224:227], a[224:227], v[128:131]
    v_mul_f32 v100, v100, v102
    v_exp_f32 v147, v147
    v_mfma_f32_16x16x32_bf16 v[132:135], v[224:227], a[228:231], v[132:135]
    v_mul_f32 v101, v101, v103
    v_exp_f32 v148, v148
    v_mfma_f32_16x16x32_bf16 v[136:139], v[224:227], a[232:235], v[136:139]
    buffer_load_dwordx4 v[60:63], v244, s[8:11], s36 offen offset:1024 sc1
    v_mul_f32 v104, v104, v106
    v_mfma_f32_16x16x32_bf16 v[140:143], v[224:227], a[236:239], v[140:143]
    s_waitcnt lgkmcnt(1)
    v_exp_f32 v149, v149
    v_mul_f32 v105, v105, v107
    v_mfma_f32_16x16x32_bf16 v[128:131], v[228:231], a[240:243], v[128:131]
    v_exp_f32 v150, v150
    v_mul_f32 v108, v108, v110
    v_mfma_f32_16x16x32_bf16 v[132:135], v[228:231], a[244:247], v[132:135]
    v_exp_f32 v151, v151
    v_mul_f32 v109, v109, v111
    v_mfma_f32_16x16x32_bf16 v[136:139], v[228:231], a[248:251], v[136:139]
    v_fma_f32 v144, v144, v17, v17
    v_fma_f32 v145, v145, v17, v17
    v_fma_f32 v146, v146, v19, v19
    v_mfma_f32_16x16x32_bf16 v[140:143], v[228:231], a[252:255], v[140:143]
    s_waitcnt lgkmcnt(0)
    v_fma_f32 v147, v147, v19, v19
    v_fma_f32 v148, v148, v21, v21
    v_fma_f32 v149, v149, v21, v21
    v_mfma_f32_16x16x32_bf16 v[128:131], v[232:235], v[208:211], v[128:131]
    v_fma_f32 v150, v150, v23, v23
    v_fma_f32 v151, v151, v23, v23
    v_mfma_f32_16x16x32_bf16 v[132:135], v[232:235], v[212:215], v[132:135]
    v_rcp_f32 v144, v144
    v_mfma_f32_16x16x32_bf16 v[136:139], v[232:235], v[216:219], v[136:139]
    v_rcp_f32 v145, v145
    v_mul_f32 v96, v96, v144
    v_mfma_f32_16x16x32_bf16 v[140:143], v[232:235], v[220:223], v[140:143]
    v_rcp_f32 v146, v146
    v_mul_f32 v97, v97, v145
    s_cmp_ge_u32 s5, 28
    s_cbranch_scc1 dn_idle1
    s_waitcnt vmcnt(7)
    v_cmp_gt_u32 vcc, 2, v30
    s_nop 0
    s_cbranch_vccnz poll14
poll14_ok:
    v_mfma_f32_16x16x32_bf16 v[160:163], a[0:3], v[32:35], 0
    v_rcp_f32 v147, v147
    v_mul_f32 v100, v100, v146
    v_mfma_f32_16x16x32_bf16 v[164:167], a[4:7], v[32:35], 0
    buffer_load_dwordx4 v[64:67], v25, s[8:11], s37 offen offset:0 sc1
    v_mov_b32 v31, 4
    s_waitcnt vmcnt(4)
    v_mfma_f32_16x16x32_bf16 v[168:171], a[8:11], v[32:35], 0
    buffer_store_dword v31, v5, s[8:11], s82 offen
    v_rcp_f32 v148, v148
    v_mfma_f32_16x16x32_bf16 v[172:175], a[12:15], v[32:35], 0
    v_mul_f32 v101, v101, v147
    v_rcp_f32 v149, v149
    v_mfma_f32_16x16x32_bf16 v[176:179], a[0:3], v[36:39], 0
    buffer_load_dwordx4 v[68:71], v26, s[8:11], s37 offen offset:0 sc1
    v_mul_f32 v104, v104, v148
    v_mfma_f32_16x16x32_bf16 v[180:183], a[4:7], v[36:39], 0
    buffer_load_dword v30, v24, s[8:11], s79 offen sc1
    v_rcp_f32 v150, v150
    v_mfma_f32_16x16x32_bf16 v[184:187], a[8:11], v[36:39], 0
    v_mul_f32 v105, v105, v149
    v_rcp_f32 v151, v151
    v_mfma_f32_16x16x32_bf16 v[188:191], a[12:15], v[36:39], 0
    buffer_load_dwordx4 v[72:75], v27, s[8:11], s37 offen offset:0 sc1
    v_mul_f32 v108, v108, v150
    v_cvt_pk_bf16_f32 v152, v96, v97
    v_mfma_f32_16x16x32_bf16 v[192:195], a[0:3], v[40:43], 0
    v_cvt_pk_bf16_f32 v154, v104, v105
    v_mul_f32 v109, v109, v151
    v_cvt_pk_bf16_f32 v153, v100, v101
    v_mfma_f32_16x16x32_bf16 v[196:199], a[4:7], v[40:43], 0
    v_cvt_pk_bf16_f32 v155, v108, v109
    v_permlane32_swap_b32 v152, v154
    v_mfma_f32_16x16x32_bf16 v[200:203], a[8:11], v[40:43], 0
    buffer_load_dwordx4 v[76:79], v244, s[8:11], s37 offen offset:0 sc1
    v_permlane32_swap_b32 v153, v155
    v_mfma_f32_16x16x32_bf16 v[204:207], a[12:15], v[40:43], 0
    s_add_u32 s91, s81, 32768
    v_permlane16_swap_b32 v152, v153
    v_mfma_f32_16x16x32_bf16 v[208:211], a[0:3], v[44:47], 0
    v_permlane16_swap_b32 v154, v155
    buffer_store_dwordx4 v[152:155], v28, s[8:11], s91 offen nt
    v_mfma_f32_16x16x32_bf16 v[212:215], a[4:7], v[44:47], 0
    buffer_load_dwordx4 v[80:83], v25, s[8:11], s37 offen offset:1024 sc1
    v_mul_f32 v144, v112, v16
    v_mul_f32 v145, v113, v16
    v_mfma_f32_16x16x32_bf16 v[216:219], a[8:11], v[44:47], 0
    v_mul_f32 v146, v116, v18
    v_mul_f32 v147, v117, v18
    v_mul_f32 v148, v120, v20
    v_mfma_f32_16x16x32_bf16 v[220:223], a[12:15], v[44:47], 0
    v_mul_f32 v149, v121, v20
    v_mul_f32 v150, v124, v22
    v_mul_f32 v151, v125, v22
    v_mfma_f32_16x16x32_bf16 v[160:163], a[16:19], v[48:51], v[160:163]
    buffer_load_dwordx4 v[84:87], v26, s[8:11], s37 offen offset:1024 sc1
    v_exp_f32 v144, v144
    v_mfma_f32_16x16x32_bf16 v[164:167], a[20:23], v[48:51], v[164:167]
    v_mul_f32 v112, v112, v114
    v_exp_f32 v145, v145
    v_mfma_f32_16x16x32_bf16 v[168:171], a[24:27], v[48:51], v[168:171]
    v_mul_f32 v113, v113, v115
    v_exp_f32 v146, v146
    v_mfma_f32_16x16x32_bf16 v[172:175], a[28:31], v[48:51], v[172:175]
    s_waitcnt vmcnt(11)
    buffer_load_dwordx4 v[88:91], v27, s[8:11], s37 offen offset:1024 sc1
    v_mul_f32 v116, v116, v118
    v_mfma_f32_16x16x32_bf16 v[176:179], a[16:19], v[52:55], v[176:179]
    v_exp_f32 v147, v147
    v_mul_f32 v117, v117, v119
    v_mfma_f32_16x16x32_bf16 v[180:183], a[20:23], v[52:55], v[180:183]
    v_exp_f32 v148, v148
    v_mul_f32 v120, v120, v122
    v_mfma_f32_16x16x32_bf16 v[184:187], a[24:27], v[52:55], v[184:187]
    buffer_load_dwordx4 v[92:95], v244, s[8:11], s37 offen offset:1024 sc1
    v_exp_f32 v149, v149
    v_mfma_f32_16x16x32_bf16 v[188:191], a[28:31], v[52:55], v[188:191]
    s_waitcnt vmcnt(12)
    v_mul_f32 v121, v121, v123
    v_exp_f32 v150, v150
    v_mfma_f32_16x16x32_bf16 v[192:195], a[16:19], v[56:59], v[192:195]
    v_mul_f32 v124, v124, v126
    v_exp_f32 v151, v151
    v_mfma_f32_16x16x32_bf16 v[196:199], a[20:23], v[56:59], v[196:199]
    v_mul_f32 v125, v125, v127
    v_fma_f32 v144, v144, v17, v17
    v_fma_f32 v145, v145, v17, v17
    v_mfma_f32_16x16x32_bf16 v[200:203], a[24:27], v[56:59], v[200:203]
    v_fma_f32 v146, v146, v19, v19
    v_fma_f32 v147, v147, v19, v19
    v_fma_f32 v148, v148, v21, v21
    v_mfma_f32_16x16x32_bf16 v[204:207], a[28:31], v[56:59], v[204:207]
    s_waitcnt vmcnt(11)
    v_fma_f32 v149, v149, v21, v21
    v_fma_f32 v150, v150, v23, v23
    v_fma_f32 v151, v151, v23, v23
    v_mfma_f32_16x16x32_bf16 v[208:211], a[16:19], v[60:63], v[208:211]
    v_rcp_f32 v144, v144
    v_mfma_f32_16x16x32_bf16 v[212:215], a[20:23], v[60:63], v[212:215]
    v_rcp_f32 v145, v145
    v_mul_f32 v112, v112, v144
    v_mfma_f32_16x16x32_bf16 v[216:219], a[24:27], v[60:63], v[216:219]
    v_rcp_f32 v146, v146
    v_mul_f32 v113, v113, v145
    v_mfma_f32_16x16x32_bf16 v[220:223], a[28:31], v[60:63], v[220:223]
    s_waitcnt vmcnt(10)
    v_rcp_f32 v147, v147
    v_mul_f32 v116, v116, v146
    s_waitcnt vmcnt(7)
    v_cmp_gt_u32 vcc, 3, v30
    s_nop 0
    s_cbranch_vccnz poll15
poll15_ok:
    v_mfma_f32_16x16x32_bf16 v[160:163], a[32:35], v[64:67], v[160:163]
    v_mov_b32 v31, 5
    s_waitcnt vmcnt(4)
    buffer_store_dword v31, v5, s[8:11], s82 offen
    v_mfma_f32_16x16x32_bf16 v[164:167], a[36:39], v[64:67], v[164:167]
    v_rcp_f32 v148, v148
    v_mul_f32 v117, v117, v147
    v_mfma_f32_16x16x32_bf16 v[168:171], a[40:43], v[64:67], v[168:171]
    buffer_load_dwordx4 a[224:227], v25, s[8:11], s38 offen offset:0 sc1
    v_rcp_f32 v149, v149
    v_mfma_f32_16x16x32_bf16 v[172:175], a[44:47], v[64:67], v[172:175]
    v_mul_f32 v120, v120, v148
    v_rcp_f32 v150, v150
    v_mfma_f32_16x16x32_bf16 v[176:179], a[32:35], v[68:71], v[176:179]
    buffer_load_dword v30, v24, s[8:11], s79 offen sc1
    v_mul_f32 v121, v121, v149
    v_mfma_f32_16x16x32_bf16 v[180:183], a[36:39], v[68:71], v[180:183]
    buffer_load_dwordx4 a[228:231], v26, s[8:11], s38 offen offset:0 sc1
    v_rcp_f32 v151, v151
    v_mfma_f32_16x16x32_bf16 v[184:187], a[40:43], v[68:71], v[184:187]
    v_mul_f32 v124, v124, v150
    v_cvt_pk_bf16_f32 v156, v112, v113
    v_cvt_pk_bf16_f32 v158, v120, v121
    v_mfma_f32_16x16x32_bf16 v[188:191], a[44:47], v[68:71], v[188:191]
    v_mul_f32 v125, v125, v151
    v_cvt_pk_bf16_f32 v157, v116, v117
    v_cvt_pk_bf16_f32 v159, v124, v125
    v_mfma_f32_16x16x32_bf16 v[192:195], a[32:35], v[72:75], v[192:195]
    buffer_load_dwordx4 a[232:235], v27, s[8:11], s38 offen offset:0 sc1
    v_permlane32_swap_b32 v156, v158
    v_mfma_f32_16x16x32_bf16 v[196:199], a[36:39], v[72:75], v[196:199]
    v_permlane32_swap_b32 v157, v159
    s_add_u32 s91, s81, 40960
    v_mfma_f32_16x16x32_bf16 v[200:203], a[40:43], v[72:75], v[200:203]
    v_permlane16_swap_b32 v156, v157
    v_mfma_f32_16x16x32_bf16 v[204:207], a[44:47], v[72:75], v[204:207]
    buffer_load_dwordx4 a[236:239], v244, s[8:11], s38 offen offset:0 sc1
    v_permlane16_swap_b32 v158, v159
    v_mfma_f32_16x16x32_bf16 v[208:211], a[32:35], v[76:79], v[208:211]
    buffer_store_dwordx4 v[156:159], v28, s[8:11], s91 offen nt
    v_mul_f32 v144, v128, v16
    v_mul_f32 v145, v129, v16
    v_mfma_f32_16x16x32_bf16 v[212:215], a[36:39], v[76:79], v[212:215]
    v_mul_f32 v146, v132, v18
    v_mul_f32 v147, v133, v18
    v_mul_f32 v148, v136, v20
    v_mfma_f32_16x16x32_bf16 v[216:219], a[40:43], v[76:79], v[216:219]
    buffer_load_dwordx4 a[240:243], v25, s[8:11], s38 offen offset:1024 sc1
    v_mul_f32 v149, v137, v20
    v_mul_f32 v150, v140, v22
    v_mfma_f32_16x16x32_bf16 v[220:223], a[44:47], v[76:79], v[220:223]
    s_waitcnt vmcnt(11)
    v_mul_f32 v151, v141, v22
    v_exp_f32 v144, v144
    v_mfma_f32_16x16x32_bf16 v[160:163], a[48:51], v[80:83], v[160:163]
    v_mul_f32 v128, v128, v130
    v_exp_f32 v145, v145
    v_mfma_f32_16x16x32_bf16 v[164:167], a[52:55], v[80:83], v[164:167]
    buffer_load_dwordx4 a[244:247], v26, s[8:11], s38 offen offset:1024 sc1
    v_mul_f32 v129, v129, v131
    v_mfma_f32_16x16x32_bf16 v[168:171], a[56:59], v[80:83], v[168:171]
    v_exp_f32 v146, v146
    v_mul_f32 v132, v132, v134
    v_mfma_f32_16x16x32_bf16 v[172:175], a[60:63], v[80:83], v[172:175]
    s_waitcnt vmcnt(11)
    v_exp_f32 v147, v147
    v_mul_f32 v133, v133, v135
    v_mfma_f32_16x16x32_bf16 v[176:179], a[48:51], v[84:87], v[176:179]
    buffer_load_dwordx4 a[248:251], v27, s[8:11], s38 offen offset:1024 sc1
    v_exp_f32 v148, v148
    v_mfma_f32_16x16x32_bf16 v[180:183], a[52:55], v[84:87], v[180:183]
    v_mul_f32 v136, v136, v138
    v_exp_f32 v149, v149
    v_mfma_f32_16x16x32_bf16 v[184:187], a[56:59], v[84:87], v[184:187]
    v_mul_f32 v137, v137, v139
    v_exp_f32 v150, v150
    v_mfma_f32_16x16x32_bf16 v[188:191], a[60:63], v[84:87], v[188:191]
    s_waitcnt vmcnt(11)
    buffer_load_dwordx4 a[252:255], v244, s[8:11], s38 offen offset:1024 sc1
    v_mul_f32 v140, v140, v142
    v_mfma_f32_16x16x32_bf16 v[192:195], a[48:51], v[88:91], v[192:195]
    v_exp_f32 v151, v151
    v_mul_f32 v141, v141, v143
    v_mfma_f32_16x16x32_bf16 v[196:199], a[52:55], v[88:91], v[196:199]
    v_fma_f32 v144, v144, v17, v17
    v_fma_f32 v145, v145, v17, v17
    v_fma_f32 v146, v146, v19, v19
    v_mfma_f32_16x16x32_bf16 v[200:203], a[56:59], v[88:91], v[200:203]
    v_fma_f32 v147, v147, v19, v19
    v_fma_f32 v148, v148, v21, v21
    v_fma_f32 v149, v149, v21, v21
    v_mfma_f32_16x16x32_bf16 v[204:207], a[60:63], v[88:91], v[204:207]
    s_waitcnt vmcnt(11)
    v_fma_f32 v150, v150, v23, v23
    v_fma_f32 v151, v151, v23, v23
    v_mfma_f32_16x16x32_bf16 v[208:211], a[48:51], v[92:95], v[208:211]
    v_rcp_f32 v144, v144
    v_mfma_f32_16x16x32_bf16 v[212:215], a[52:55], v[92:95], v[212:215]
    v_rcp_f32 v145, v145
    v_mul_f32 v128, v128, v144
    v_mfma_f32_16x16x32_bf16 v[216:219], a[56:59], v[92:95], v[216:219]
    v_rcp_f32 v146, v146
    v_mul_f32 v129, v129, v145
    v_mfma_f32_16x16x32_bf16 v[220:223], a[60:63], v[92:95], v[220:223]
    s_waitcnt vmcnt(9)
    v_rcp_f32 v147, v147
    v_mul_f32 v132, v132, v146
    s_waitcnt vmcnt(8)
    v_cmp_gt_u32 vcc, 4, v30
    s_nop 0
    s_cbranch_vccnz poll16
poll16_ok:
    v_mfma_f32_16x16x32_bf16 v[160:163], a[64:67], a[224:227], v[160:163]
    buffer_load_dwordx4 v[96:99], v25, s[8:11], s39 offen offset:0 sc1
    v_mov_b32 v31, 6
    s_waitcnt vmcnt(5)
    v_mfma_f32_16x16x32_bf16 v[164:167], a[68:71], a[224:227], v[164:167]
    buffer_store_dword v31, v5, s[8:11], s82 offen
    v_rcp_f32 v148, v148
    v_mfma_f32_16x16x32_bf16 v[168:171], a[72:75], a[224:227], v[168:171]
    v_mul_f32 v133, v133, v147
    v_rcp_f32 v149, v149
    v_mfma_f32_16x16x32_bf16 v[172:175], a[76:79], a[224:227], v[172:175]
    buffer_load_dwordx4 v[100:103], v26, s[8:11], s39 offen offset:0 sc1
    v_mul_f32 v136, v136, v148
    v_mfma_f32_16x16x32_bf16 v[176:179], a[64:67], a[228:231], v[176:179]
    buffer_load_dword v30, v24, s[8:11], s79 offen sc1
    v_rcp_f32 v150, v150
    v_mfma_f32_16x16x32_bf16 v[180:183], a[68:71], a[228:231], v[180:183]
    v_mul_f32 v137, v137, v149
    v_rcp_f32 v151, v151
    v_mfma_f32_16x16x32_bf16 v[184:187], a[72:75], a[228:231], v[184:187]
    buffer_load_dwordx4 v[104:107], v27, s[8:11], s39 offen offset:0 sc1
    v_mul_f32 v140, v140, v150
    v_cvt_pk_bf16_f32 v152, v128, v129
    v_mfma_f32_16x16x32_bf16 v[188:191], a[76:79], a[228:231], v[188:191]
    v_cvt_pk_bf16_f32 v154, v136, v137
    v_mul_f32 v141, v141, v151
    v_cvt_pk_bf16_f32 v153, v132, v133
    v_mfma_f32_16x16x32_bf16 v[192:195], a[64:67], a[232:235], v[192:195]
    v_cvt_pk_bf16_f32 v155, v140, v141
    v_permlane32_swap_b32 v152, v154
    v_mfma_f32_16x16x32_bf16 v[196:199], a[68:71], a[232:235], v[196:199]
    buffer_load_dwordx4 v[108:111], v244, s[8:11], s39 offen offset:0 sc1
    v_permlane32_swap_b32 v153, v155
    v_mfma_f32_16x16x32_bf16 v[200:203], a[72:75], a[232:235], v[200:203]
    s_add_u32 s91, s81, 49152
    v_permlane16_swap_b32 v152, v153
    v_mfma_f32_16x16x32_bf16 v[204:207], a[76:79], a[232:235], v[204:207]
    v_permlane16_swap_b32 v154, v155
    buffer_store_dwordx4 v[152:155], v28, s[8:11], s91 offen nt
    v_mfma_f32_16x16x32_bf16 v[208:211], a[64:67], a[236:239], v[208:211]
    buffer_load_dwordx4 v[112:115], v25, s[8:11], s39 offen offset:1024 sc1
    v_mfma_f32_16x16x32_bf16 v[212:215], a[68:71], a[236:239], v[212:215]
    v_mfma_f32_16x16x32_bf16 v[216:219], a[72:75], a[236:239], v[216:219]
    v_mfma_f32_16x16x32_bf16 v[220:223], a[76:79], a[236:239], v[220:223]
    s_waitcnt vmcnt(11)
    buffer_load_dwordx4 v[116:119], v26, s[8:11], s39 offen offset:1024 sc1
    v_mfma_f32_16x16x32_bf16 v[160:163], a[80:83], a[240:243], v[160:163]
    v_mfma_f32_16x16x32_bf16 v[164:167], a[84:87], a[240:243], v[164:167]
    v_mfma_f32_16x16x32_bf16 v[168:171], a[88:91], a[240:243], v[168:171]
    buffer_load_dwordx4 v[120:123], v27, s[8:11], s39 offen offset:1024 sc1
    v_mfma_f32_16x16x32_bf16 v[172:175], a[92:95], a[240:243], v[172:175]
    s_waitcnt vmcnt(12)
    v_mfma_f32_16x16x32_bf16 v[176:179], a[80:83], a[244:247], v[176:179]
    v_mfma_f32_16x16x32_bf16 v[180:183], a[84:87], a[244:247], v[180:183]
    buffer_load_dwordx4 v[124:127], v244, s[8:11], s39 offen offset:1024 sc1
    v_mfma_f32_16x16x32_bf16 v[184:187], a[88:91], a[244:247], v[184:187]
    v_mfma_f32_16x16x32_bf16 v[188:191], a[92:95], a[244:247], v[188:191]
    s_waitcnt vmcnt(12)
    v_mfma_f32_16x16x32_bf16 v[192:195], a[80:83], a[248:251], v[192:195]
    v_mfma_f32_16x16x32_bf16 v[196:199], a[84:87], a[248:251], v[196:199]
    v_mfma_f32_16x16x32_bf16 v[200:203], a[88:91], a[248:251], v[200:203]
    v_mfma_f32_16x16x32_bf16 v[204:207], a[92:95], a[248:251], v[204:207]
    s_waitcnt vmcnt(11)
    v_mfma_f32_16x16x32_bf16 v[208:211], a[80:83], a[252:255], v[208:211]
    v_mfma_f32_16x16x32_bf16 v[212:215], a[84:87], a[252:255], v[212:215]
    v_mfma_f32_16x16x32_bf16 v[216:219], a[88:91], a[252:255], v[216:219]
    v_mfma_f32_16x16x32_bf16 v[220:223], a[92:95], a[252:255], v[220:223]
    s_waitcnt vmcnt(10)
    s_waitcnt vmcnt(7)
    v_cmp_gt_u32 vcc, 5, v30
    s_nop 0
    s_cbranch_vccnz poll17
poll17_ok:
    v_mfma_f32_16x16x32_bf16 v[160:163], a[96:99], v[96:99], v[160:163]
    v_mfma_f32_16x16x32_bf16 v[164:167], a[100:103], v[96:99], v[164:167]
    buffer_load_dwordx4 v[32:35], v25, s[8:11], s40 offen offset:0 sc1
    v_mfma_f32_16x16x32_bf16 v[168:171], a[104:107], v[96:99], v[168:171]
    v_mfma_f32_16x16x32_bf16 v[172:175], a[108:111], v[96:99], v[172:175]
    v_mfma_f32_16x16x32_bf16 v[176:179], a[96:99], v[100:103], v[176:179]
    buffer_load_dwordx4 v[36:39], v26, s[8:11], s40 offen offset:0 sc1
    v_mfma_f32_16x16x32_bf16 v[180:183], a[100:103], v[100:103], v[180:183]
    buffer_load_dword v30, v24, s[8:11], s79 offen sc1
    v_mfma_f32_16x16x32_bf16 v[184:187], a[104:107], v[100:103], v[184:187]
    v_mfma_f32_16x16x32_bf16 v[188:191], a[108:111], v[100:103], v[188:191]
    s_waitcnt vmcnt(9)
    buffer_load_dwordx4 v[40:43], v27, s[8:11], s40 offen offset:0 sc1
    v_mfma_f32_16x16x32_bf16 v[192:195], a[96:99], v[104:107], v[192:195]
    v_mov_b32 v31, 7
    s_waitcnt vmcnt(8)
    buffer_store_dword v31, v5, s[8:11], s82 offen
    v_mfma_f32_16x16x32_bf16 v[196:199], a[100:103], v[104:107], v[196:199]
    v_mfma_f32_16x16x32_bf16 v[200:203], a[104:107], v[104:107], v[200:203]
    buffer_load_dwordx4 v[44:47], v244, s[8:11], s40 offen offset:0 sc1
    v_mfma_f32_16x16x32_bf16 v[204:207], a[108:111], v[104:107], v[204:207]
    v_mfma_f32_16x16x32_bf16 v[208:211], a[96:99], v[108:111], v[208:211]
    v_mfma_f32_16x16x32_bf16 v[212:215], a[100:103], v[108:111], v[212:215]
    buffer_load_dwordx4 v[48:51], v25, s[8:11], s40 offen offset:1024 sc1
    v_mfma_f32_16x16x32_bf16 v[216:219], a[104:107], v[108:111], v[216:219]
    v_mfma_f32_16x16x32_bf16 v[220:223], a[108:111], v[108:111], v[220:223]
    s_waitcnt vmcnt(10)
    v_mfma_f32_16x16x32_bf16 v[160:163], a[112:115], v[112:115], v[160:163]
    buffer_load_dwordx4 v[52:55], v26, s[8:11], s40 offen offset:1024 sc1
    v_mfma_f32_16x16x32_bf16 v[164:167], a[116:119], v[112:115], v[164:167]
    v_mfma_f32_16x16x32_bf16 v[168:171], a[120:123], v[112:115], v[168:171]
    v_mfma_f32_16x16x32_bf16 v[172:175], a[124:127], v[112:115], v[172:175]
    s_waitcnt vmcnt(10)
    buffer_load_dwordx4 v[56:59], v27, s[8:11], s40 offen offset:1024 sc1
    v_mfma_f32_16x16x32_bf16 v[176:179], a[112:115], v[116:119], v[176:179]
    v_mfma_f32_16x16x32_bf16 v[180:183], a[116:119], v[116:119], v[180:183]
    v_mfma_f32_16x16x32_bf16 v[184:187], a[120:123], v[116:119], v[184:187]
    buffer_load_dwordx4 v[60:63], v244, s[8:11], s40 offen offset:1024 sc1
    v_mfma_f32_16x16x32_bf16 v[188:191], a[124:127], v[116:119], v[188:191]
    s_waitcnt vmcnt(11)
    v_mfma_f32_16x16x32_bf16 v[192:195], a[112:115], v[120:123], v[192:195]
    v_mfma_f32_16x16x32_bf16 v[196:199], a[116:119], v[120:123], v[196:199]
    v_mfma_f32_16x16x32_bf16 v[200:203], a[120:123], v[120:123], v[200:203]
    v_mfma_f32_16x16x32_bf16 v[204:207], a[124:127], v[120:123], v[204:207]
    s_waitcnt vmcnt(10)
    v_mfma_f32_16x16x32_bf16 v[208:211], a[112:115], v[124:127], v[208:211]
    v_mfma_f32_16x16x32_bf16 v[212:215], a[116:119], v[124:127], v[212:215]
    v_mfma_f32_16x16x32_bf16 v[216:219], a[120:123], v[124:127], v[216:219]
    v_mfma_f32_16x16x32_bf16 v[220:223], a[124:127], v[124:127], v[220:223]
    s_waitcnt vmcnt(9)
    s_waitcnt vmcnt(7)
    v_cmp_gt_u32 vcc, 6, v30
    s_nop 0
    s_cbranch_vccnz poll18
poll18_ok:
    v_mfma_f32_16x16x32_bf16 v[160:163], a[128:131], v[32:35], v[160:163]
    v_mfma_f32_16x16x32_bf16 v[164:167], a[132:135], v[32:35], v[164:167]
    v_mfma_f32_16x16x32_bf16 v[168:171], a[136:139], v[32:35], v[168:171]
    buffer_load_dwordx4 v[64:67], v25, s[8:11], s41 offen offset:0 sc1
    v_mfma_f32_16x16x32_bf16 v[172:175], a[140:143], v[32:35], v[172:175]
    v_mfma_f32_16x16x32_bf16 v[176:179], a[128:131], v[36:39], v[176:179]
    buffer_load_dword v30, v24, s[8:11], s79 offen sc1
    v_mfma_f32_16x16x32_bf16 v[180:183], a[132:135], v[36:39], v[180:183]
    buffer_load_dwordx4 v[68:71], v26, s[8:11], s41 offen offset:0 sc1
    v_mfma_f32_16x16x32_bf16 v[184:187], a[136:139], v[36:39], v[184:187]
    v_mfma_f32_16x16x32_bf16 v[188:191], a[140:143], v[36:39], v[188:191]
    s_waitcnt vmcnt(9)
    v_mfma_f32_16x16x32_bf16 v[192:195], a[128:131], v[40:43], v[192:195]
    buffer_load_dwordx4 v[72:75], v27, s[8:11], s41 offen offset:0 sc1
    v_mfma_f32_16x16x32_bf16 v[196:199], a[132:135], v[40:43], v[196:199]
    v_mfma_f32_16x16x32_bf16 v[200:203], a[136:139], v[40:43], v[200:203]
    v_mfma_f32_16x16x32_bf16 v[204:207], a[140:143], v[40:43], v[204:207]
    s_waitcnt vmcnt(8)
    buffer_load_dwordx4 v[76:79], v244, s[8:11], s41 offen offset:0 sc1
    v_mfma_f32_16x16x32_bf16 v[208:211], a[128:131], v[44:47], v[208:211]
    v_mfma_f32_16x16x32_bf16 v[212:215], a[132:135], v[44:47], v[212:215]
    v_mfma_f32_16x16x32_bf16 v[216:219], a[136:139], v[44:47], v[216:219]
    buffer_load_dwordx4 v[80:83], v25, s[8:11], s41 offen offset:1024 sc1
    v_mfma_f32_16x16x32_bf16 v[220:223], a[140:143], v[44:47], v[220:223]
    s_waitcnt vmcnt(9)
    v_mfma_f32_16x16x32_bf16 v[160:163], a[144:147], v[48:51], v[160:163]
    v_mul_u32_u24 v29, 896, v2
    v_lshl_add_u32 v29, v3, 5, v29
    v_mfma_f32_16x16x32_bf16 v[164:167], a[148:151], v[48:51], v[164:167]
    s_mul_i32 s47, s31, 14336
    buffer_load_dwordx4 v[84:87], v26, s[8:11], s41 offen offset:1024 sc1
    s_lshl_b32 s56, s7, 7
    v_mfma_f32_16x16x32_bf16 v[168:171], a[152:155], v[48:51], v[168:171]
    s_add_u32 s47, s47, s56
    v_lshlrev_b32 v144, 16, v6
    v_and_b32 v148, 0xffff0000, v6
    v_mfma_f32_16x16x32_bf16 v[172:175], a[156:159], v[48:51], v[172:175]
    s_waitcnt vmcnt(9)
    v_lshlrev_b32 v152, 16, v7
    v_and_b32 v156, 0xffff0000, v7
    v_mfma_f32_16x16x32_bf16 v[176:179], a[144:147], v[52:55], v[176:179]
    buffer_load_dwordx4 v[88:91], v27, s[8:11], s41 offen offset:1024 sc1
    v_lshlrev_b32 v145, 16, v8
    v_mfma_f32_16x16x32_bf16 v[180:183], a[148:151], v[52:55], v[180:183]
    v_and_b32 v149, 0xffff0000, v8
    v_lshlrev_b32 v153, 16, v9
    v_mfma_f32_16x16x32_bf16 v[184:187], a[152:155], v[52:55], v[184:187]
    v_and_b32 v157, 0xffff0000, v9
    v_lshlrev_b32 v146, 16, v10
    v_mfma_f32_16x16x32_bf16 v[188:191], a[156:159], v[52:55], v[188:191]
    s_waitcnt vmcnt(9)
    buffer_load_dwordx4 v[92:95], v244, s[8:11], s41 offen offset:1024 sc1
    v_and_b32 v150, 0xffff0000, v10
    v_mfma_f32_16x16x32_bf16 v[192:195], a[144:147], v[56:59], v[192:195]
    v_lshlrev_b32 v154, 16, v11
    v_and_b32 v158, 0xffff0000, v11
    v_mfma_f32_16x16x32_bf16 v[196:199], a[148:151], v[56:59], v[196:199]
    v_lshlrev_b32 v147, 16, v12
    v_and_b32 v151, 0xffff0000, v12
    v_mfma_f32_16x16x32_bf16 v[200:203], a[152:155], v[56:59], v[200:203]
    v_lshlrev_b32 v155, 16, v13
    v_and_b32 v159, 0xffff0000, v13
    v_mfma_f32_16x16x32_bf16 v[204:207], a[156:159], v[56:59], v[204:207]
    s_waitcnt vmcnt(9)
    v_mfma_f32_16x16x32_bf16 v[208:211], a[144:147], v[60:63], v[208:211]
    v_mfma_f32_16x16x32_bf16 v[212:215], a[148:151], v[60:63], v[212:215]
    v_mfma_f32_16x16x32_bf16 v[216:219], a[152:155], v[60:63], v[216:219]
    v_mfma_f32_16x16x32_bf16 v[220:223], a[156:159], v[60:63], v[220:223]
    s_waitcnt vmcnt(8)
    s_waitcnt vmcnt(7)
    v_cmp_gt_u32 vcc, 7, v30
    s_nop 0
    s_cbranch_vccnz poll19
poll19_ok:
    v_mfma_f32_16x16x32_bf16 v[160:163], a[160:163], v[64:67], v[160:163]
    buffer_load_dwordx4 a[224:227], v25, s[8:11], s42 offen offset:0 sc1
    v_mfma_f32_16x16x32_bf16 v[164:167], a[164:167], v[64:67], v[164:167]
    v_mfma_f32_16x16x32_bf16 v[168:171], a[168:171], v[64:67], v[168:171]
    v_mfma_f32_16x16x32_bf16 v[172:175], a[172:175], v[64:67], v[172:175]
    s_waitcnt vmcnt(7)
    buffer_load_dwordx4 a[228:231], v26, s[8:11], s42 offen offset:0 sc1
    v_mfma_f32_16x16x32_bf16 v[176:179], a[160:163], v[68:71], v[176:179]
    v_mfma_f32_16x16x32_bf16 v[180:183], a[164:167], v[68:71], v[180:183]
    v_mfma_f32_16x16x32_bf16 v[184:187], a[168:171], v[68:71], v[184:187]
    buffer_load_dwordx4 a[232:235], v27, s[8:11], s42 offen offset:0 sc1
    v_mfma_f32_16x16x32_bf16 v[188:191], a[172:175], v[68:71], v[188:191]
    s_waitcnt vmcnt(8)
    v_mfma_f32_16x16x32_bf16 v[192:195], a[160:163], v[72:75], v[192:195]
    v_mfma_f32_16x16x32_bf16 v[196:199], a[164:167], v[72:75], v[196:199]
    buffer_load_dwordx4 a[236:239], v244, s[8:11], s42 offen offset:0 sc1
    v_mfma_f32_16x16x32_bf16 v[200:203], a[168:171], v[72:75], v[200:203]
    v_mfma_f32_16x16x32_bf16 v[204:207], a[172:175], v[72:75], v[204:207]
    s_waitcnt vmcnt(8)
    v_mfma_f32_16x16x32_bf16 v[208:211], a[160:163], v[76:79], v[208:211]
    buffer_load_dwordx4 a[240:243], v25, s[8:11], s42 offen offset:1024 sc1
    v_mfma_f32_16x16x32_bf16 v[212:215], a[164:167], v[76:79], v[212:215]
    v_mfma_f32_16x16x32_bf16 v[216:219], a[168:171], v[76:79], v[216:219]
    v_mfma_f32_16x16x32_bf16 v[220:223], a[172:175], v[76:79], v[220:223]
    s_waitcnt vmcnt(8)
    buffer_load_dwordx4 a[244:247], v26, s[8:11], s42 offen offset:1024 sc1
    v_mfma_f32_16x16x32_bf16 v[160:163], a[176:179], v[80:83], v[160:163]
    v_mfma_f32_16x16x32_bf16 v[164:167], a[180:183], v[80:83], v[164:167]
    v_mfma_f32_16x16x32_bf16 v[168:171], a[184:187], v[80:83], v[168:171]
    buffer_load_dwordx4 a[248:251], v27, s[8:11], s42 offen offset:1024 sc1
    v_mfma_f32_16x16x32_bf16 v[172:175], a[188:191], v[80:83], v[172:175]
    s_waitcnt vmcnt(9)
    v_mfma_f32_16x16x32_bf16 v[176:179], a[176:179], v[84:87], v[176:179]
    v_mfma_f32_16x16x32_bf16 v[180:183], a[180:183], v[84:87], v[180:183]
    buffer_load_dwordx4 a[252:255], v244, s[8:11], s42 offen offset:1024 sc1
    v_mfma_f32_16x16x32_bf16 v[184:187], a[184:187], v[84:87], v[184:187]
    v_mfma_f32_16x16x32_bf16 v[188:191], a[188:191], v[84:87], v[188:191]
    s_waitcnt vmcnt(9)
    v_mfma_f32_16x16x32_bf16 v[192:195], a[176:179], v[88:91], v[192:195]
    v_mfma_f32_16x16x32_bf16 v[196:199], a[180:183], v[88:91], v[196:199]
    v_mfma_f32_16x16x32_bf16 v[200:203], a[184:187], v[88:91], v[200:203]
    v_mfma_f32_16x16x32_bf16 v[204:207], a[188:191], v[88:91], v[204:207]
    s_waitcnt vmcnt(8)
    v_mfma_f32_16x16x32_bf16 v[208:211], a[176:179], v[92:95], v[208:211]
    v_mfma_f32_16x16x32_bf16 v[212:215], a[180:183], v[92:95], v[212:215]
    v_mfma_f32_16x16x32_bf16 v[216:219], a[184:187], v[92:95], v[216:219]
    v_mfma_f32_16x16x32_bf16 v[220:223], a[188:191], v[92:95], v[220:223]
    s_waitcnt vmcnt(7)
    v_mfma_f32_16x16x32_bf16 v[160:163], a[192:195], a[224:227], v[160:163]
    v_add_u32 v245, s44, v1
    v_add_u32 v246, s45, v1
    v_mfma_f32_16x16x32_bf16 v[164:167], a[196:199], a[224:227], v[164:167]
    v_add_u32 v247, s46, v1
    s_mul_i32 s52, s3, 12288
    v_mfma_f32_16x16x32_bf16 v[168:171], a[200:203], a[224:227], v[168:171]
    s_add_u32 s52, s52, 108544
    v_add_u32 v28, s52, v1
    v_mfma_f32_16x16x32_bf16 v[172:175], a[204:207], a[224:227], v[172:175]
    s_waitcnt vmcnt(3)
    v_mfma_f32_16x16x32_bf16 v[160:163], a[208:211], a[240:243], v[160:163]
    v_mfma_f32_16x16x32_bf16 v[164:167], a[212:215], a[240:243], v[164:167]
    v_mfma_f32_16x16x32_bf16 v[168:171], a[216:219], a[240:243], v[168:171]
    v_mfma_f32_16x16x32_bf16 v[172:175], a[220:223], a[240:243], v[172:175]
    v_mfma_f32_16x16x32_bf16 v[176:179], a[192:195], a[228:231], v[176:179]
    v_mfma_f32_16x16x32_bf16 v[180:183], a[196:199], a[228:231], v[180:183]
    v_mfma_f32_16x16x32_bf16 v[184:187], a[200:203], a[228:231], v[184:187]
    s_nop 1
    ds_write_b128 v245, v[160:163] offset:0
    v_mfma_f32_16x16x32_bf16 v[188:191], a[204:207], a[228:231], v[188:191]
    s_waitcnt vmcnt(2)
    ds_write_b128 v245, v[164:167] offset:1024
    v_mfma_f32_16x16x32_bf16 v[176:179], a[208:211], a[244:247], v[176:179]
    ds_write_b128 v245, v[168:171] offset:2048
    v_mfma_f32_16x16x32_bf16 v[180:183], a[212:215], a[244:247], v[180:183]
    ds_write_b128 v245, v[172:175] offset:3072
    v_mfma_f32_16x16x32_bf16 v[184:187], a[216:219], a[244:247], v[184:187]
    v_mfma_f32_16x16x32_bf16 v[188:191], a[220:223], a[244:247], v[188:191]
    v_mfma_f32_16x16x32_bf16 v[192:195], a[192:195], a[232:235], v[192:195]
    v_mfma_f32_16x16x32_bf16 v[196:199], a[196:199], a[232:235], v[196:199]
    v_mfma_f32_16x16x32_bf16 v[200:203], a[200:203], a[232:235], v[200:203]
    ds_write_b128 v246, v[176:179] offset:0
    v_mfma_f32_16x16x32_bf16 v[204:207], a[204:207], a[232:235], v[204:207]
    s_waitcnt vmcnt(1)
    ds_write_b128 v246, v[180:183] offset:1024
    v_mfma_f32_16x16x32_bf16 v[192:195], a[208:211], a[248:251], v[192:195]
    ds_write_b128 v246, v[184:187] offset:2048
    v_mfma_f32_16x16x32_bf16 v[196:199], a[212:215], a[248:251], v[196:199]
    ds_write_b128 v246, v[188:191] offset:3072
    v_mfma_f32_16x16x32_bf16 v[200:203], a[216:219], a[248:251], v[200:203]
    v_mfma_f32_16x16x32_bf16 v[204:207], a[220:223], a[248:251], v[204:207]
    v_mfma_f32_16x16x32_bf16 v[208:211], a[192:195], a[236:239], v[208:211]
    v_mfma_f32_16x16x32_bf16 v[212:215], a[196:199], a[236:239], v[212:215]
    v_mfma_f32_16x16x32_bf16 v[216:219], a[200:203], a[236:239], v[216:219]
    ds_write_b128 v247, v[192:195] offset:0
    v_mfma_f32_16x16x32_bf16 v[220:223], a[204:207], a[236:239], v[220:223]
    s_waitcnt vmcnt(0)
    ds_write_b128 v247, v[196:199] offset:1024
    v_mfma_f32_16x16x32_bf16 v[208:211], a[208:211], a[252:255], v[208:211]
    ds_write_b128 v247, v[200:203] offset:2048
    v_mfma_f32_16x16x32_bf16 v[212:215], a[212:215], a[252:255], v[212:215]
    ds_write_b128 v247, v[204:207] offset:3072
    v_mfma_f32_16x16x32_bf16 v[216:219], a[216:219], a[252:255], v[216:219]
    v_mfma_f32_16x16x32_bf16 v[220:223], a[220:223], a[252:255], v[220:223]
    s_nop 2
    v_pk_add_f32 v[208:209], v[208:209], v[144:145]
    v_pk_add_f32 v[210:211], v[210:211], v[146:147]
    v_pk_add_f32 v[212:213], v[212:213], v[148:149]
    v_pk_add_f32 v[214:215], v[214:215], v[150:151]
    v_pk_add_f32 v[216:217], v[216:217], v[152:153]
    v_pk_add_f32 v[218:219], v[218:219], v[154:155]
    v_pk_add_f32 v[220:221], v[220:221], v[156:157]
    v_pk_add_f32 v[222:223], v[222:223], v[158:159]
    s_waitcnt lgkmcnt(0)
    s_barrier
    ds_read_b128 v[48:51], v28 offset:0
    ds_read_b128 v[52:55], v28 offset:1024
    ds_read_b128 v[56:59], v28 offset:2048
    ds_read_b128 v[60:63], v28 offset:3072
    ds_read_b128 v[64:67], v28 offset:4096
    ds_read_b128 v[68:71], v28 offset:5120
    ds_read_b128 v[72:75], v28 offset:6144
    ds_read_b128 v[76:79], v28 offset:7168
    ds_read_b128 v[80:83], v28 offset:8192
    ds_read_b128 v[84:87], v28 offset:9216
    ds_read_b128 v[88:91], v28 offset:10240
    ds_read_b128 v[92:95], v28 offset:11264
    s_waitcnt lgkmcnt(11)
    v_pk_add_f32 v[208:209], v[208:209], v[48:49]
    v_pk_add_f32 v[210:211], v[210:211], v[50:51]
    s_waitcnt lgkmcnt(10)
    v_pk_add_f32 v[212:213], v[212:213], v[52:53]
    v_pk_add_f32 v[214:215], v[214:215], v[54:55]
    s_waitcnt lgkmcnt(9)
    v_pk_add_f32 v[216:217], v[216:217], v[56:57]
    v_pk_add_f32 v[218:219], v[218:219], v[58:59]
    s_waitcnt lgkmcnt(8)
    v_pk_add_f32 v[220:221], v[220:221], v[60:61]
    v_pk_add_f32 v[222:223], v[222:223], v[62:63]
    s_waitcnt lgkmcnt(7)
    v_pk_add_f32 v[208:209], v[208:209], v[64:65]
    v_pk_add_f32 v[210:211], v[210:211], v[66:67]
    s_waitcnt lgkmcnt(6)
    v_pk_add_f32 v[212:213], v[212:213], v[68:69]
    v_pk_add_f32 v[214:215], v[214:215], v[70:71]
    s_waitcnt lgkmcnt(5)
    v_pk_add_f32 v[216:217], v[216:217], v[72:73]
    v_pk_add_f32 v[218:219], v[218:219], v[74:75]
    s_waitcnt lgkmcnt(4)
    v_pk_add_f32 v[220:221], v[220:221], v[76:77]
    v_pk_add_f32 v[222:223], v[222:223], v[78:79]
    s_waitcnt lgkmcnt(3)
    v_pk_add_f32 v[208:209], v[208:209], v[80:81]
    v_pk_add_f32 v[210:211], v[210:211], v[82:83]
    s_waitcnt lgkmcnt(2)
    v_pk_add_f32 v[212:213], v[212:213], v[84:85]
    v_pk_add_f32 v[214:215], v[214:215], v[86:87]
    s_waitcnt lgkmcnt(1)
    v_pk_add_f32 v[216:217], v[216:217], v[88:89]
    v_pk_add_f32 v[218:219], v[218:219], v[90:91]
    s_waitcnt lgkmcnt(0)
    v_pk_add_f32 v[220:221], v[220:221], v[92:93]
    v_pk_add_f32 v[222:223], v[222:223], v[94:95]
    v_cvt_pk_bf16_f32 v6, v208, v212
    v_cvt_pk_bf16_f32 v7, v216, v220
    v_cvt_pk_bf16_f32 v8, v209, v213
    v_cvt_pk_bf16_f32 v9, v217, v221
    buffer_store_dwordx4 v[6:9], v29, s[20:23], s47 offen offset:0 nt
    v_cvt_pk_bf16_f32 v10, v210, v214
    v_cvt_pk_bf16_f32 v11, v218, v222
    v_cvt_pk_bf16_f32 v12, v211, v215
    v_cvt_pk_bf16_f32 v13, v219, v223
    buffer_store_dwordx4 v[10:13], v29, s[20:23], s47 offen offset:16 nt
    s_branch dn_done1
dn_idle1:
    v_rcp_f32 v147, v147
    v_mul_f32 v100, v100, v146
    v_mov_b32 v31, 4
    s_waitcnt vmcnt(3)
    buffer_store_dword v31, v5, s[8:11], s82 offen
    v_rcp_f32 v148, v148
    v_mul_f32 v101, v101, v147
    v_rcp_f32 v149, v149
    v_mul_f32 v104, v104, v148
    v_rcp_f32 v150, v150
    v_mul_f32 v105, v105, v149
    v_rcp_f32 v151, v151
    v_mul_f32 v108, v108, v150
    v_cvt_pk_bf16_f32 v152, v96, v97
    v_cvt_pk_bf16_f32 v154, v104, v105
    v_mul_f32 v109, v109, v151
    v_cvt_pk_bf16_f32 v153, v100, v101
    v_cvt_pk_bf16_f32 v155, v108, v109
    v_permlane32_swap_b32 v152, v154
    s_nop 0
    v_permlane32_swap_b32 v153, v155
    s_add_u32 s91, s81, 32768
    s_nop 0
    v_permlane16_swap_b32 v152, v153
    v_permlane16_swap_b32 v154, v155
    buffer_store_dwordx4 v[152:155], v28, s[8:11], s91 offen nt
    v_mul_f32 v144, v112, v16
    v_mul_f32 v145, v113, v16
    v_mul_f32 v146, v116, v18
    v_mul_f32 v147, v117, v18
    v_mul_f32 v148, v120, v20
    v_mul_f32 v149, v121, v20
    v_mul_f32 v150, v124, v22
    v_mul_f32 v151, v125, v22
    v_exp_f32 v144, v144
    v_mul_f32 v112, v112, v114
    v_exp_f32 v145, v145
    v_mul_f32 v113, v113, v115
    v_exp_f32 v146, v146
    v_mul_f32 v116, v116, v118
    v_exp_f32 v147, v147
    v_mul_f32 v117, v117, v119
    v_exp_f32 v148, v148
    v_mul_f32 v120, v120, v122
    v_exp_f32 v149, v149
    v_mul_f32 v121, v121, v123
    v_exp_f32 v150, v150
    v_mul_f32 v124, v124, v126
    v_exp_f32 v151, v151
    v_mul_f32 v125, v125, v127
    v_fma_f32 v144, v144, v17, v17
    v_fma_f32 v145, v145, v17, v17
    v_fma_f32 v146, v146, v19, v19
    v_fma_f32 v147, v147, v19, v19
    v_fma_f32 v148, v148, v21, v21
    v_fma_f32 v149, v149, v21, v21
    v_fma_f32 v150, v150, v23, v23
    v_fma_f32 v151, v151, v23, v23
    v_rcp_f32 v144, v144
    v_rcp_f32 v145, v145
    v_mul_f32 v112, v112, v144
    v_rcp_f32 v146, v146
    v_mul_f32 v113, v113, v145
    v_rcp_f32 v147, v147
    v_mul_f32 v116, v116, v146
    v_mov_b32 v31, 5
    s_waitcnt vmcnt(0)
    buffer_store_dword v31, v5, s[8:11], s82 offen
    v_rcp_f32 v148, v148
    v_mul_f32 v117, v117, v147
    v_rcp_f32 v149, v149
    v_mul_f32 v120, v120, v148
    v_rcp_f32 v150, v150
    v_mul_f32 v121, v121, v149
    v_rcp_f32 v151, v151
    v_mul_f32 v124, v124, v150
    v_cvt_pk_bf16_f32 v156, v112, v113
    v_cvt_pk_bf16_f32 v158, v120, v121
    v_mul_f32 v125, v125, v151
    v_cvt_pk_bf16_f32 v157, v116, v117
    v_cvt_pk_bf16_f32 v159, v124, v125
    v_permlane32_swap_b32 v156, v158
    s_nop 0
    v_permlane32_swap_b32 v157, v159
    s_add_u32 s91, s81, 40960
    s_nop 0
    v_permlane16_swap_b32 v156, v157
    v_permlane16_swap_b32 v158, v159
    buffer_store_dwordx4 v[156:159], v28, s[8:11], s91 offen nt
    v_mul_f32 v144, v128, v16
    v_mul_f32 v145, v129, v16
    v_mul_f32 v146, v132, v18
    v_mul_f32 v147, v133, v18
    v_mul_f32 v148, v136, v20
    v_mul_f32 v149, v137, v20
    v_mul_f32 v150, v140, v22
    v_mul_f32 v151, v141, v22
    v_exp_f32 v144, v144
    v_mul_f32 v128, v128, v130
    v_exp_f32 v145, v145
    v_mul_f32 v129, v129, v131
    v_exp_f32 v146, v146
    v_mul_f32 v132, v132, v134
    v_exp_f32 v147, v147
    v_mul_f32 v133, v133, v135
    v_exp_f32 v148, v148
    v_mul_f32 v136, v136, v138
    v_exp_f32 v149, v149
    v_mul_f32 v137, v137, v139
    v_exp_f32 v150, v150
    v_mul_f32 v140, v140, v142
    v_exp_f32 v151, v151
    v_mul_f32 v141, v141, v143
    v_fma_f32 v144, v144, v17, v17
    v_fma_f32 v145, v145, v17, v17
    v_fma_f32 v146, v146, v19, v19
    v_fma_f32 v147, v147, v19, v19
    v_fma_f32 v148, v148, v21, v21
    v_fma_f32 v149, v149, v21, v21
    v_fma_f32 v150, v150, v23, v23
    v_fma_f32 v151, v151, v23, v23
    v_rcp_f32 v144, v144
    v_rcp_f32 v145, v145
    v_mul_f32 v128, v128, v144
    v_rcp_f32 v146, v146
    v_mul_f32 v129, v129, v145
    v_rcp_f32 v147, v147
    v_mul_f32 v132, v132, v146
    v_mov_b32 v31, 6
    s_waitcnt vmcnt(0)
    buffer_store_dword v31, v5, s[8:11], s82 offen
    v_rcp_f32 v148, v148
    v_mul_f32 v133, v133, v147
    v_rcp_f32 v149, v149
    v_mul_f32 v136, v136, v148
    v_rcp_f32 v150, v150
    v_mul_f32 v137, v137, v149
    v_rcp_f32 v151, v151
    v_mul_f32 v140, v140, v150
    v_cvt_pk_bf16_f32 v152, v128, v129
    v_cvt_pk_bf16_f32 v154, v136, v137
    v_mul_f32 v141, v141, v151
    v_cvt_pk_bf16_f32 v153, v132, v133
    v_cvt_pk_bf16_f32 v155, v140, v141
    v_permlane32_swap_b32 v152, v154
    s_nop 0
    v_permlane32_swap_b32 v153, v155
    s_add_u32 s91, s81, 49152
    s_nop 0
    v_permlane16_swap_b32 v152, v153
    v_permlane16_swap_b32 v154, v155
    buffer_store_dwordx4 v[152:155], v28, s[8:11], s91 offen nt
    v_mov_b32 v31, 7
    s_waitcnt vmcnt(0)
    buffer_store_dword v31, v5, s[8:11], s82 offen
    s_barrier
dn_done1:
    s_nop 1
the_end:
    s_endpgm
tab_again:
    s_cmp_eq_u32 s98, 0
    s_cbranch_scc1 the_end
    s_sub_u32 s98, s98, 1
    buffer_load_dword v13, v12, s[8:11], s90 offen sc1
    s_waitcnt vmcnt(0)
    s_branch tab_chk
role_bad:
    s_cmp_ge_u32 s55, 32
    s_cbranch_scc1 the_end
    s_mov_b32 s5, s55
    s_and_b32 s6, s5, 3
    s_lshr_b32 s7, s5, 2
    s_and_b32 s28, s5, 15
    s_lshr_b32 s29, s5, 4
    s_lshl_b32 s30, s4, 3
    s_lshl_b32 s52, s29, 2
    s_add_u32 s30, s30, s52
    s_add_u32 s30, s30, s3
    s_lshl_b32 s31, s4, 4
    s_lshl_b32 s52, s6, 2
    s_add_u32 s31, s31, s52
    s_add_u32 s31, s31, s3
    s_lshl_b32 s53, s3, 10
    s_lshl_b32 s83, s28, 15
    s_add_u32 s83, s83, 6291456
    s_lshl_b32 s52, s3, 9
    s_add_u32 s83, s83, s52
    s_mul_i32 s71, s28, 86016
    s_add_u32 s71, s71, s53
    s_add_u32 s71, s71, 19398656
    s_add_u32 s74, s71, 57344
    s_min_u32 s77, s7, 6
    s_mul_i32 s75, s77, 57344
    s_add_u32 s75, s75, s53
    s_add_u32 s75, s75, 0
    s_mul_i32 s76, s5, 100352
    s_add_u32 s76, s76, 2228224
    s_and_b32 s69, s53, 1024
    s_add_u32 s68, s76, s69
    s_add_u32 s76, s76, s53
    s_mul_i32 s77, s77, 229376
    s_mul_i32 s52, s3, 57344
    s_add_u32 s77, s77, s52
    s_add_u32 s77, s77, 524288
    s_lshl_b32 s78, s4, 11
    s_add_u32 s78, s78, 5767168
    s_lshr_b32 s84, s30, 2
    s_waitcnt vmcnt(0) lgkmcnt(0)
    s_nop 11
    s_barrier
    s_branch restart
g_again0:
    s_cmp_eq_u32 s98, 0
    s_cbranch_scc1 g_ok0
    s_sub_u32 s98, s98, 1
    s_add_u32 s85, s83, 0
    buffer_load_dwordx4 v[224:227], v25, s[8:11], s85 offen sc1
    s_add_u32 s85, s83, 4096
    buffer_load_dwordx4 v[228:231], v25, s[8:11], s85 offen sc1
    s_add_u32 s85, s83, 8192
    buffer_load_dwordx4 v[232:235], v25, s[8:11], s85 offen sc1
    s_add_u32 s85, s83, 12288
    buffer_load_dwordx4 v[236:239], v25, s[8:11], s85 offen sc1
    s_add_u32 s85, s83, 16384
    buffer_load_dwordx4 v[240:243], v25, s[8:11], s85 offen sc1
    s_add_u32 s85, s83, 20480
    buffer_load_dwordx4 v[244:247], v25, s[8:11], s85 offen sc1
    s_add_u32 s85, s83, 24576
    buffer_load_dwordx4 v[168:171], v25, s[8:11], s85 offen sc1
    s_add_u32 s85, s83, 28672
    buffer_load_dwordx4 v[172:175], v25, s[8:11], s85 offen sc1
    s_waitcnt vmcnt(0)
    s_branch g_retry0
wo_idle0:
    s_waitcnt vmcnt(0) lgkmcnt(0)
    s_branch wo_done0
poll3:
    s_cmp_eq_u32 s98, 0
    s_cbranch_scc1 poll3_ok
    s_sub_u32 s98, s98, 1
    buffer_load_dword v30, v24, s[8:11], s79 offen sc1
    s_waitcnt vmcnt(0)
    v_cmp_gt_u32 vcc, 1, v30
    s_nop 0
    s_cbranch_vccnz poll3
    s_branch poll3_ok
poll4:
    s_cmp_eq_u32 s98, 0
    s_cbranch_scc1 poll4_ok
    s_sub_u32 s98, s98, 1
    buffer_load_dword v30, v24, s[8:11], s79 offen sc1
    s_waitcnt vmcnt(0)
    v_cmp_gt_u32 vcc, 2, v30
    s_nop 0
    s_cbranch_vccnz poll4
    s_branch poll4_ok
poll5:
    s_cmp_eq_u32 s98, 0
    s_cbranch_scc1 poll5_ok
    s_sub_u32 s98, s98, 1
    buffer_load_dword v30, v24, s[8:11], s79 offen sc1
    s_waitcnt vmcnt(0)
    v_cmp_gt_u32 vcc, 3, v30
    s_nop 0
    s_cbranch_vccnz poll5
    s_branch poll5_ok
poll6:
    s_cmp_eq_u32 s98, 0
    s_cbranch_scc1 poll6_ok
    s_sub_u32 s98, s98, 1
    buffer_load_dword v30, v24, s[8:11], s79 offen sc1
    s_waitcnt vmcnt(0)
    v_cmp_gt_u32 vcc, 4, v30
    s_nop 0
    s_cbranch_vccnz poll6
    s_branch poll6_ok
poll7:
    s_cmp_eq_u32 s98, 0
    s_cbranch_scc1 poll7_ok
    s_sub_u32 s98, s98, 1
    buffer_load_dword v30, v24, s[8:11], s79 offen sc1
    s_waitcnt vmcnt(0)
    v_cmp_gt_u32 vcc, 5, v30
    s_nop 0
    s_cbranch_vccnz poll7
    s_branch poll7_ok
poll8:
    s_cmp_eq_u32 s98, 0
    s_cbranch_scc1 poll8_ok
    s_sub_u32 s98, s98, 1
    buffer_load_dword v30, v24, s[8:11], s79 offen sc1
    s_waitcnt vmcnt(0)
    v_cmp_gt_u32 vcc, 6, v30
    s_nop 0
    s_cbranch_vccnz poll8
    s_branch poll8_ok
poll9:
    s_cmp_eq_u32 s98, 0
    s_cbranch_scc1 poll9_ok
    s_sub_u32 s98, s98, 1
    buffer_load_dword v30, v24, s[8:11], s79 offen sc1
    s_waitcnt vmcnt(0)
    v_cmp_gt_u32 vcc, 7, v30
    s_nop 0
    s_cbranch_vccnz poll9
    s_branch poll9_ok
g_again1:
    s_cmp_eq_u32 s98, 0
    s_cbranch_scc1 g_ok1
    s_sub_u32 s98, s98, 1
    s_add_u32 s85, s83, 0
    buffer_load_dwordx4 v[224:227], v25, s[8:11], s85 offen sc1
    s_add_u32 s85, s83, 4096
    buffer_load_dwordx4 v[228:231], v25, s[8:11], s85 offen sc1
    s_add_u32 s85, s83, 8192
    buffer_load_dwordx4 v[232:235], v25, s[8:11], s85 offen sc1
    s_add_u32 s85, s83, 12288
    buffer_load_dwordx4 v[236:239], v25, s[8:11], s85 offen sc1
    s_add_u32 s85, s83, 16384
    buffer_load_dwordx4 v[240:243], v25, s[8:11], s85 offen sc1
    s_add_u32 s85, s83, 20480
    buffer_load_dwordx4 v[244:247], v25, s[8:11], s85 offen sc1
    s_add_u32 s85, s83, 24576
    buffer_load_dwordx4 v[168:171], v25, s[8:11], s85 offen sc1
    s_add_u32 s85, s83, 28672
    buffer_load_dwordx4 v[172:175], v25, s[8:11], s85 offen sc1
    s_waitcnt vmcnt(0)
    s_branch g_retry1
wo_idle1:
    s_waitcnt vmcnt(0) lgkmcnt(0)
    s_branch wo_done1
poll13:
    s_cmp_eq_u32 s98, 0
    s_cbranch_scc1 poll13_ok
    s_sub_u32 s98, s98, 1
    buffer_load_dword v30, v24, s[8:11], s79 offen sc1
    s_waitcnt vmcnt(0)
    v_cmp_gt_u32 vcc, 1, v30
    s_nop 0
    s_cbranch_vccnz poll13
    s_branch poll13_ok
poll14:
    s_cmp_eq_u32 s98, 0
    s_cbranch_scc1 poll14_ok
    s_sub_u32 s98, s98, 1
    buffer_load_dword v30, v24, s[8:11], s79 offen sc1
    s_waitcnt vmcnt(0)
    v_cmp_gt_u32 vcc, 2, v30
    s_nop 0
    s_cbranch_vccnz poll14
    s_branch poll14_ok
poll15:
    s_cmp_eq_u32 s98, 0
    s_cbranch_scc1 poll15_ok
    s_sub_u32 s98, s98, 1
    buffer_load_dword v30, v24, s[8:11], s79 offen sc1
    s_waitcnt vmcnt(0)
    v_cmp_gt_u32 vcc, 3, v30
    s_nop 0
    s_cbranch_vccnz poll15
    s_branch poll15_ok
poll16:
    s_cmp_eq_u32 s98, 0
    s_cbranch_scc1 poll16_ok
    s_sub_u32 s98, s98, 1
    buffer_load_dword v30, v24, s[8:11], s79 offen sc1
    s_waitcnt vmcnt(0)
    v_cmp_gt_u32 vcc, 4, v30
    s_nop 0
    s_cbranch_vccnz poll16
    s_branch poll16_ok
poll17:
    s_cmp_eq_u32 s98, 0
    s_cbranch_scc1 poll17_ok
    s_sub_u32 s98, s98, 1
    buffer_load_dword v30, v24, s[8:11], s79 offen sc1
    s_waitcnt vmcnt(0)
    v_cmp_gt_u32 vcc, 5, v30
    s_nop 0
    s_cbranch_vccnz poll17
    s_branch poll17_ok
poll18:
    s_cmp_eq_u32 s98, 0
    s_cbranch_scc1 poll18_ok
    s_sub_u32 s98, s98, 1
    buffer_load_dword v30, v24, s[8:11], s79 offen sc1
    s_waitcnt vmcnt(0)
    v_cmp_gt_u32 vcc, 6, v30
    s_nop 0
    s_cbranch_vccnz poll18
    s_branch poll18_ok
poll19:
    s_cmp_eq_u32 s98, 0
    s_cbranch_scc1 poll19_ok
    s_sub_u32 s98, s98, 1
    buffer_load_dword v30, v24, s[8:11], s79 offen sc1
    s_waitcnt vmcnt(0)
    v_cmp_gt_u32 vcc, 7, v30
    s_nop 0
    s_cbranch_vccnz poll19
    s_branch poll19_ok
code_end:
.section .rodata,"a"
.p2align 6
.amdhsa_kernel k0_kernel
  .amdhsa_next_free_vgpr 128
  .amdhsa_next_free_sgpr 102
  .amdhsa_accum_offset 128
  .amdhsa_group_segment_fixed_size 0
  .amdhsa_kernarg_size 80
  .amdhsa_user_sgpr_count 2
  .amdhsa_user_sgpr_kernarg_segment_ptr 1
  .amdhsa_system_sgpr_workgroup_id_x 1
  .amdhsa_float_denorm_mode_32 3
.end_amdhsa_kernel
.p2align 6
.amdhsa_kernel interleave_layers__linear_attn_block__glu_gated_swiglu__prompt_kernel
  .amdhsa_next_free_vgpr 512
  .amdhsa_next_free_sgpr 102
  .amdhsa_accum_offset 256
  .amdhsa_group_segment_fixed_size 0
  .amdhsa_kernarg_size 80
  .amdhsa_user_sgpr_count 2
  .amdhsa_user_sgpr_kernarg_segment_ptr 1
  .amdhsa_system_sgpr_workgroup_id_x 1
  .amdhsa_float_denorm_mode_32 3
.end_amdhsa_kernel
```
